```python
import torch

def _softmax(x, axis=-1):
    return torch.softmax(x, dim=axis)
def _gelu(x):
    return torch.nn.functional.gelu(x, approximate="tanh")
def _silu(x):
    return torch.nn.functional.silu(x)
def _sigmoid(x):
    return torch.sigmoid(x)
def _layernorm(x, axis=-1, eps=1e-5):
    m = x.mean(dim=axis, keepdim=True)
    v = x.var(dim=axis, keepdim=True, unbiased=False)
    return (x - m) / torch.sqrt(v + eps)
def _scatter_add(tgt, idx, src, axis=0):
    return tgt.clone().index_add_(axis, idx, src)
def _segment_sum(src, seg, n):
    out = torch.zeros((n,) + src.shape[1:], dtype=src.dtype)
    return out.index_add_(0, seg, src)
def _pad(x, pw):
    flat = tuple(v for pair in reversed(pw) for v in pair)
    return torch.nn.functional.pad(x, flat)

kernel_name = 'recurrent_scan__spectral_fnet__mixer_channel_mlp__prompt'

def setup_inputs():

    _w = (lambda a: (lambda t: t.to(torch.bfloat16) if t.is_floating_point() else t)(torch.as_tensor(a)))
    def _A_setup():
        B, S, D = 1, 2048, 576
        ns = torch.arange(S)[:, None] * torch.arange(S)[None, :]
        nd = torch.arange(D)[:, None] * torch.arange(D)[None, :]
        Ws_re = torch.cos(-2.0 * torch.pi * ns / S).to(float)
        Ws_im = torch.sin(-2.0 * torch.pi * ns / S).to(float)
        Wd_re = torch.cos(-2.0 * torch.pi * nd / D).to(float)
        Wd_im = torch.sin(-2.0 * torch.pi * nd / D).to(float)
        return {
            "x": _w((lambda *s: torch.randn(*s, dtype=torch.bfloat16) * 0.05)(B, S, D)),
            "dft_seq_re": _w(Ws_re),
            "dft_seq_im": _w(Ws_im),
            "dft_hid_re": _w(Wd_re),
            "dft_hid_im": _w(Wd_im),
        }
    _A_in = _A_setup()

    def _B_setup():
        B, S, D, F = 1, 2048, 576, 4608
        return {
            "x": _w((lambda *s: torch.randn(*s, dtype=torch.bfloat16) * 0.05)(B, S, D)),
            "w1": _w((lambda *s: torch.randn(*s, dtype=torch.bfloat16) * 0.8)(D, F) * (D ** -0.5)),
            "b1": _w((lambda *s: torch.randn(*s, dtype=torch.bfloat16) * 0.8)(F)),
            "w2": _w((lambda *s: torch.randn(*s, dtype=torch.bfloat16) * 0.05)(F, D) * (F ** -0.5)),
            "b2": _w((lambda *s: torch.randn(*s, dtype=torch.bfloat16) * 0.05)(D)),
        }
    _B_in = _B_setup()

    return {
        "A_x": _A_in["x"],
        "A_dft_seq_re": _A_in["dft_seq_re"],
        "A_dft_seq_im": _A_in["dft_seq_im"],
        "A_dft_hid_re": _A_in["dft_hid_re"],
        "A_dft_hid_im": _A_in["dft_hid_im"],
        "B_x": _B_in["x"],
        "B_w1": _B_in["w1"],
        "B_b1": _B_in["b1"],
        "B_w2": _B_in["w2"],
        "B_b2": _B_in["b2"],
    }

def reference(A_x, A_dft_seq_re, A_dft_seq_im, A_dft_hid_re, A_dft_hid_im, B_x, B_w1, B_b1, B_w2, B_b2):
    def _A_ref(x, dft_seq_re, dft_seq_im, dft_hid_re, dft_hid_im):
        a = torch.einsum("bsd,ed->bse", x, dft_hid_re)
        b = torch.einsum("bsd,ed->bse", x, dft_hid_im)
        y = torch.einsum("ts,bse->bte", dft_seq_re, a) - torch.einsum("ts,bse->bte", dft_seq_im, b)
        return y

    def _B_ref(x, w1, b1, w2, b2):
        y = _layernorm(x, axis=-1)
        h = _gelu(torch.einsum("bsd,df->bsf", y, w1) + b1)
        return torch.einsum("bsf,fd->bsd", h, w2) + b2

    x = A_x
    xn = _layernorm(x, axis=-1)
    s = _A_ref(xn, A_dft_seq_re, A_dft_seq_im, A_dft_hid_re, A_dft_hid_im)
    g = _silu(_B_ref(xn, B_w1, B_b1, B_w2, B_b2))
    return x + s * g
```

```asm
; @launch kernel=ka_kernel grid=(256,1,1) block=(512,1,1) lds=163840
; @launch kernel=kb_kernel grid=(256,1,1) block=(512,1,1) lds=139264
.amdgcn_target "amdgcn-amd-amdhsa--gfx950"
.text
.globl ka_kernel
.p2align 8
.type ka_kernel,@function
ka_kernel:
    s_cmp_ge_u32 s2, 256
    s_cbranch_scc1 KA_END
    s_lshr_b32 s26, s2, 3
    s_cmp_ge_u32 s26, 30
    s_cbranch_scc1 KA_W2T
    s_and_b32 s24, s2, 1
    s_mul_i32 s24, s24, 15
    s_lshr_b32 s25, s26, 1
    s_add_u32 s24, s24, s25
    s_and_b32 s25, s2, 6
    s_and_b32 s26, s26, 1
    s_add_u32 s25, s25, s26
    s_load_dwordx2 s[4:5], s[0:1], 0
    s_load_dwordx4 s[28:31], s[0:1], 24
    s_load_dwordx4 s[32:35], s[0:1], 48
    s_load_dwordx2 s[6:7], s[0:1], 96
    s_load_dwordx4 s[52:55], s[0:1], 8
    v_lshrrev_b32 v1, 6, v0
    v_and_b32 v2, 63, v0
    s_nop 0
    v_readfirstlane_b32 s26, v1
    v_and_b32 v3, 31, v2
    v_lshrrev_b32 v4, 5, v2
    s_nop 1
    s_lshl_b32 s27, s25, 3
    s_add_u32 s27, s27, s26
    s_lshl_b32 s27, s27, 5
    s_mul_i32 s37, s26, 3072
    s_lshl_b32 s49, s26, 13
    s_add_u32 s49, s49, 98304
    v_lshrrev_b32 v9, 3, v2
    v_add_u32 v17, 0, v9
    v_lshrrev_b32 v18, 1, v17
    v_xor_b32 v18, v18, v2
    v_and_b32 v18, 7, v18
    v_add_u32 v17, s27, v17
    v_mul_u32_u24 v17, 1152, v17
    v_lshl_add_u32 v5, v18, 4, v17
    v_add_u32 v17, 8, v9
    v_lshrrev_b32 v18, 1, v17
    v_xor_b32 v18, v18, v2
    v_and_b32 v18, 7, v18
    v_add_u32 v17, s27, v17
    v_mul_u32_u24 v17, 1152, v17
    v_lshl_add_u32 v6, v18, 4, v17
    v_add_u32 v17, 16, v9
    v_lshrrev_b32 v18, 1, v17
    v_xor_b32 v18, v18, v2
    v_and_b32 v18, 7, v18
    v_add_u32 v17, s27, v17
    v_mul_u32_u24 v17, 1152, v17
    v_lshl_add_u32 v7, v18, 4, v17
    v_add_u32 v17, 24, v9
    v_lshrrev_b32 v18, 1, v17
    v_xor_b32 v18, v18, v2
    v_and_b32 v18, 7, v18
    v_add_u32 v17, s27, v17
    v_mul_u32_u24 v17, 1152, v17
    v_lshl_add_u32 v8, v18, 4, v17
    v_lshrrev_b32 v9, 1, v3
    v_and_b32 v9, 7, v9
    v_xor_b32 v9, v9, v4
    v_lshlrev_b32 v9, 4, v9
    v_lshl_add_u32 v19, v3, 7, v9
    v_add_u32 v13, s49, v19
    v_xor_b32 v14, 32, v13
    v_xor_b32 v15, 64, v13
    v_xor_b32 v16, 96, v13
    v_mov_b32 v25, 0x3f803f80
    v_mov_b32 v28, 0
    v_mov_b32 v29, 0
    v_mov_b32 v30, 0
    v_mov_b32 v31, 0
    v_mov_b32 v238, 0
    v_mov_b32 v239, 0
    v_mov_b32 v240, 0x3f803f80
    v_mov_b32 v241, 0x3f803f80
    v_mov_b32 v242, 0x3f803f80
    v_mov_b32 v243, 0x3f803f80
    s_waitcnt lgkmcnt(0)
    s_mov_b32 s8, s4
    s_mov_b32 s9, s5
    s_mov_b32 s10, 0x240000
    s_mov_b32 s11, 0x00020000
    s_cmp_ge_u32 s24, 6
    s_cbranch_scc1 KA_G3
    s_cmp_ge_u32 s24, 3
    s_cselect_b32 s38, s30, s28
    s_cselect_b32 s39, s31, s29
    s_mov_b32 s12, s38
    s_mov_b32 s13, s39
    s_mov_b32 s14, 0xa2000
    s_mov_b32 s15, 0x00020000
    s_add_u32 s16, s6, 0x800000
    s_addc_u32 s17, s7, 0
    s_mov_b32 s18, 0x480000
    s_mov_b32 s19, 0x00020000
    s_sub_u32 s40, s24, 3
    s_cselect_b32 s40, s24, s40
    s_mul_i32 s40, s40, 221184
    s_mul_i32 s42, s26, 192
    v_add_u32 v9, s42, v2
    v_lshrrev_b32 v17, 3, v9
    v_lshrrev_b32 v18, 1, v17
    v_xor_b32 v18, v18, v9
    v_and_b32 v18, 7, v18
    v_mul_u32_u24 v17, 1152, v17
    v_lshl_add_u32 v10, v18, 4, v17
    v_add_u32 v9, s42, v2
    v_add_u32 v9, 64, v9
    v_lshrrev_b32 v17, 3, v9
    v_lshrrev_b32 v18, 1, v17
    v_xor_b32 v18, v18, v9
    v_and_b32 v18, 7, v18
    v_mul_u32_u24 v17, 1152, v17
    v_lshl_add_u32 v11, v18, 4, v17
    v_add_u32 v9, s42, v2
    v_add_u32 v9, 128, v9
    v_lshrrev_b32 v17, 3, v9
    v_lshrrev_b32 v18, 1, v17
    v_xor_b32 v18, v18, v9
    v_and_b32 v18, 7, v18
    v_mul_u32_u24 v17, 1152, v17
    v_lshl_add_u32 v12, v18, 4, v17
    s_mov_b32 s48, 0
    s_add_u32 m0, s49, 0x0
    s_nop 0
    buffer_load_dwordx4 v5, s[8:11], s48 offen lds
    s_add_u32 m0, s49, 0x400
    s_nop 0
    buffer_load_dwordx4 v6, s[8:11], s48 offen lds
    s_add_u32 m0, s49, 0x800
    s_nop 0
    buffer_load_dwordx4 v7, s[8:11], s48 offen lds
    s_add_u32 m0, s49, 0xc00
    s_nop 0
    buffer_load_dwordx4 v8, s[8:11], s48 offen lds
    s_add_u32 s46, s40, 0x0
    s_add_u32 m0, s37, 0x0
    s_nop 0
    buffer_load_dwordx4 v10, s[12:15], s46 offen lds
    s_add_u32 m0, s37, 0x400
    s_nop 0
    buffer_load_dwordx4 v11, s[12:15], s46 offen lds
    s_add_u32 m0, s37, 0x800
    s_nop 0
    buffer_load_dwordx4 v12, s[12:15], s46 offen lds
    s_mov_b32 s48, 128
    s_add_u32 m0, s49, 0x1000
    s_nop 0
    buffer_load_dwordx4 v5, s[8:11], s48 offen lds
    s_add_u32 m0, s49, 0x1400
    s_nop 0
    buffer_load_dwordx4 v6, s[8:11], s48 offen lds
    s_add_u32 m0, s49, 0x1800
    s_nop 0
    buffer_load_dwordx4 v7, s[8:11], s48 offen lds
    s_add_u32 m0, s49, 0x1c00
    s_nop 0
    buffer_load_dwordx4 v8, s[8:11], s48 offen lds
    s_add_u32 s46, s40, 0x80
    s_add_u32 m0, s37, 0x6000
    s_nop 0
    buffer_load_dwordx4 v10, s[12:15], s46 offen lds
    s_add_u32 m0, s37, 0x6400
    s_nop 0
    buffer_load_dwordx4 v11, s[12:15], s46 offen lds
    s_add_u32 m0, s37, 0x6800
    s_nop 0
    buffer_load_dwordx4 v12, s[12:15], s46 offen lds
    v_mov_b32 v20, v19
    v_xor_b32 v21, 32, v20
    v_xor_b32 v22, 64, v20
    v_xor_b32 v23, 96, v20
    s_lshl_b32 s42, s26, 12
    v_add_u32 v252, s42, v20
    v_add_u32 v253, s42, v21
    v_add_u32 v254, s42, v22
    v_add_u32 v255, s42, v23
    s_mul_i32 s42, s24, 192
    v_add_u32 v24, s42, v3
    v_lshlrev_b32 v24, 12, v24
    v_lshl_add_u32 v24, v4, 4, v24
    s_lshl_b32 s42, s27, 1
    v_add_u32 v24, s42, v24
    s_waitcnt vmcnt(10)
    ds_read_b128 v[32:35], v13 offset:0
    ds_read_b128 v[36:39], v14 offset:0
    ds_read_b128 v[40:43], v15 offset:0
    ds_read_b128 v[44:47], v16 offset:0
    s_waitcnt vmcnt(7) lgkmcnt(0)
    s_barrier
    ds_read_b128 v[80:83], v20 offset:0
    ds_read_b128 v[84:87], v20 offset:4096
    ds_read_b128 v[88:91], v20 offset:8192
    ds_read_b128 v[92:95], v20 offset:12288
    ds_read_b128 v[96:99], v20 offset:16384
    ds_read_b128 v[100:103], v20 offset:20480
    ds_read_b128 v[244:247], v252 offset:0
    s_waitcnt lgkmcnt(0)
    s_mov_b32 s48, 256
    s_add_u32 m0, s49, 0x0
    s_nop 0
    buffer_load_dwordx4 v5, s[8:11], s48 offen lds
    s_add_u32 m0, s49, 0x400
    s_nop 0
    buffer_load_dwordx4 v6, s[8:11], s48 offen lds
    s_add_u32 m0, s49, 0x800
    s_nop 0
    buffer_load_dwordx4 v7, s[8:11], s48 offen lds
    s_add_u32 m0, s49, 0xc00
    s_nop 0
    buffer_load_dwordx4 v8, s[8:11], s48 offen lds
    s_add_u32 s46, s40, 0x100
    s_add_u32 m0, s37, 0xc000
    s_nop 0
    buffer_load_dwordx4 v10, s[12:15], s46 offen lds
    s_add_u32 m0, s37, 0xc400
    s_nop 0
    buffer_load_dwordx4 v11, s[12:15], s46 offen lds
    s_add_u32 m0, s37, 0xc800
    s_nop 0
    buffer_load_dwordx4 v12, s[12:15], s46 offen lds
    s_add_u32 s46, s40, 0x180
    s_add_u32 m0, s37, 0x12000
    s_nop 0
    buffer_load_dwordx4 v10, s[12:15], s46 offen lds
    s_add_u32 m0, s37, 0x12400
    s_nop 0
    buffer_load_dwordx4 v11, s[12:15], s46 offen lds
    s_add_u32 m0, s37, 0x12800
    s_nop 0
    buffer_load_dwordx4 v12, s[12:15], s46 offen lds
    s_waitcnt vmcnt(13)
    v_mfma_f32_32x32x16_bf16 v[128:143], v[32:35], v[80:83], 0
    ds_read_b128 v[48:51], v13 offset:4096
    ds_read_b128 v[52:55], v14 offset:4096
    v_dot2c_f32_bf16 v238, v32, v25
    v_dot2c_f32_bf16 v29, v32, v32
    v_dot2c_f32_bf16 v239, v33, v25
    v_dot2c_f32_bf16 v28, v33, v33
    v_dot2c_f32_bf16 v238, v34, v25
    v_dot2c_f32_bf16 v29, v34, v34
    v_mfma_f32_32x32x16_bf16 v[144:159], v[32:35], v[84:87], 0
    ds_read_b128 v[56:59], v15 offset:4096
    ds_read_b128 v[60:63], v16 offset:4096
    v_dot2c_f32_bf16 v239, v35, v25
    v_dot2c_f32_bf16 v28, v35, v35
    v_dot2c_f32_bf16 v30, v244, v25
    v_dot2c_f32_bf16 v31, v245, v25
    v_dot2c_f32_bf16 v30, v246, v25
    v_dot2c_f32_bf16 v31, v247, v25
    v_mfma_f32_32x32x16_bf16 v[160:175], v[32:35], v[88:91], 0
    ds_read_b128 v[104:107], v21 offset:0
    ds_read_b128 v[108:111], v21 offset:4096
    v_mfma_f32_32x32x16_bf16 v[176:191], v[32:35], v[92:95], 0
    ds_read_b128 v[112:115], v21 offset:8192
    ds_read_b128 v[116:119], v21 offset:12288
    v_mfma_f32_32x32x16_bf16 v[192:207], v[32:35], v[96:99], 0
    ds_read_b128 v[120:123], v21 offset:16384
    ds_read_b128 v[124:127], v21 offset:20480
    v_mfma_f32_32x32x16_bf16 v[208:223], v[32:35], v[100:103], 0
    ds_read_b128 v[248:251], v253 offset:0
    s_waitcnt lgkmcnt(0)
    v_mfma_f32_32x32x16_bf16 v[128:143], v[36:39], v[104:107], v[128:143]
    ds_read_b128 v[80:83], v22 offset:0
    ds_read_b128 v[84:87], v22 offset:4096
    s_mov_b32 s48, 384
    s_add_u32 m0, s49, 0x1000
    s_nop 0
    buffer_load_dwordx4 v5, s[8:11], s48 offen lds
    s_add_u32 m0, s49, 0x1400
    s_nop 0
    v_mfma_f32_32x32x16_bf16 v[144:159], v[36:39], v[108:111], v[144:159]
    ds_read_b128 v[88:91], v22 offset:8192
    ds_read_b128 v[92:95], v22 offset:12288
    buffer_load_dwordx4 v6, s[8:11], s48 offen lds
    s_add_u32 m0, s49, 0x1800
    s_nop 0
    buffer_load_dwordx4 v7, s[8:11], s48 offen lds
    s_add_u32 m0, s49, 0x1c00
    s_nop 0
    v_mfma_f32_32x32x16_bf16 v[160:175], v[36:39], v[112:115], v[160:175]
    ds_read_b128 v[96:99], v22 offset:16384
    ds_read_b128 v[100:103], v22 offset:20480
    buffer_load_dwordx4 v8, s[8:11], s48 offen lds
    v_dot2c_f32_bf16 v238, v36, v25
    v_dot2c_f32_bf16 v29, v36, v36
    v_dot2c_f32_bf16 v239, v37, v25
    v_dot2c_f32_bf16 v28, v37, v37
    v_dot2c_f32_bf16 v238, v38, v25
    v_mfma_f32_32x32x16_bf16 v[176:191], v[36:39], v[116:119], v[176:191]
    ds_read_b128 v[244:247], v254 offset:0
    v_dot2c_f32_bf16 v29, v38, v38
    v_dot2c_f32_bf16 v239, v39, v25
    v_dot2c_f32_bf16 v28, v39, v39
    v_dot2c_f32_bf16 v30, v248, v25
    v_dot2c_f32_bf16 v31, v249, v25
    v_dot2c_f32_bf16 v30, v250, v25
    v_mfma_f32_32x32x16_bf16 v[192:207], v[36:39], v[120:123], v[192:207]
    v_dot2c_f32_bf16 v31, v251, v25
    v_mfma_f32_32x32x16_bf16 v[208:223], v[36:39], v[124:127], v[208:223]
    s_waitcnt lgkmcnt(0)
    v_mfma_f32_32x32x16_bf16 v[128:143], v[40:43], v[80:83], v[128:143]
    ds_read_b128 v[104:107], v23 offset:0
    ds_read_b128 v[108:111], v23 offset:4096
    v_dot2c_f32_bf16 v238, v40, v25
    v_dot2c_f32_bf16 v29, v40, v40
    v_dot2c_f32_bf16 v239, v41, v25
    v_dot2c_f32_bf16 v28, v41, v41
    v_dot2c_f32_bf16 v238, v42, v25
    v_dot2c_f32_bf16 v29, v42, v42
    v_mfma_f32_32x32x16_bf16 v[144:159], v[40:43], v[84:87], v[144:159]
    ds_read_b128 v[112:115], v23 offset:8192
    ds_read_b128 v[116:119], v23 offset:12288
    v_dot2c_f32_bf16 v239, v43, v25
    v_dot2c_f32_bf16 v28, v43, v43
    v_dot2c_f32_bf16 v30, v244, v25
    v_dot2c_f32_bf16 v31, v245, v25
    v_dot2c_f32_bf16 v30, v246, v25
    v_dot2c_f32_bf16 v31, v247, v25
    v_mfma_f32_32x32x16_bf16 v[160:175], v[40:43], v[88:91], v[160:175]
    ds_read_b128 v[120:123], v23 offset:16384
    ds_read_b128 v[124:127], v23 offset:20480
    v_mfma_f32_32x32x16_bf16 v[176:191], v[40:43], v[92:95], v[176:191]
    ds_read_b128 v[248:251], v255 offset:0
    v_mfma_f32_32x32x16_bf16 v[192:207], v[40:43], v[96:99], v[192:207]
    v_mfma_f32_32x32x16_bf16 v[208:223], v[40:43], v[100:103], v[208:223]
    s_waitcnt vmcnt(14) lgkmcnt(0)
    s_barrier
    v_mfma_f32_32x32x16_bf16 v[128:143], v[44:47], v[104:107], v[128:143]
    ds_read_b128 v[80:83], v20 offset:24576
    ds_read_b128 v[84:87], v20 offset:28672
    s_add_u32 s46, s40, 0x200
    s_add_u32 m0, s37, 0x0
    s_nop 0
    buffer_load_dwordx4 v10, s[12:15], s46 offen lds
    s_add_u32 m0, s37, 0x400
    s_nop 0
    v_mfma_f32_32x32x16_bf16 v[144:159], v[44:47], v[108:111], v[144:159]
    ds_read_b128 v[88:91], v20 offset:32768
    ds_read_b128 v[92:95], v20 offset:36864
    buffer_load_dwordx4 v11, s[12:15], s46 offen lds
    s_add_u32 m0, s37, 0x800
    s_nop 0
    buffer_load_dwordx4 v12, s[12:15], s46 offen lds
    v_dot2c_f32_bf16 v238, v44, v25
    v_dot2c_f32_bf16 v29, v44, v44
    v_mfma_f32_32x32x16_bf16 v[160:175], v[44:47], v[112:115], v[160:175]
    ds_read_b128 v[96:99], v20 offset:40960
    ds_read_b128 v[100:103], v20 offset:45056
    v_dot2c_f32_bf16 v239, v45, v25
    v_dot2c_f32_bf16 v28, v45, v45
    v_dot2c_f32_bf16 v238, v46, v25
    v_dot2c_f32_bf16 v29, v46, v46
    v_dot2c_f32_bf16 v239, v47, v25
    v_dot2c_f32_bf16 v28, v47, v47
    v_mfma_f32_32x32x16_bf16 v[176:191], v[44:47], v[116:119], v[176:191]
    ds_read_b128 v[244:247], v252 offset:24576
    v_dot2c_f32_bf16 v30, v248, v25
    v_dot2c_f32_bf16 v31, v249, v25
    v_dot2c_f32_bf16 v30, v250, v25
    v_dot2c_f32_bf16 v31, v251, v25
    v_mfma_f32_32x32x16_bf16 v[192:207], v[44:47], v[120:123], v[192:207]
    v_mfma_f32_32x32x16_bf16 v[208:223], v[44:47], v[124:127], v[208:223]
    s_waitcnt lgkmcnt(0)
    s_waitcnt vmcnt(13)
    v_mfma_f32_32x32x16_bf16 v[128:143], v[48:51], v[80:83], v[128:143]
    ds_read_b128 v[64:67], v13 offset:0
    ds_read_b128 v[68:71], v14 offset:0
    v_dot2c_f32_bf16 v238, v48, v25
    v_dot2c_f32_bf16 v29, v48, v48
    v_dot2c_f32_bf16 v239, v49, v25
    v_dot2c_f32_bf16 v28, v49, v49
    v_dot2c_f32_bf16 v238, v50, v25
    v_dot2c_f32_bf16 v29, v50, v50
    v_mfma_f32_32x32x16_bf16 v[144:159], v[48:51], v[84:87], v[144:159]
    ds_read_b128 v[72:75], v15 offset:0
    ds_read_b128 v[76:79], v16 offset:0
    v_dot2c_f32_bf16 v239, v51, v25
    v_dot2c_f32_bf16 v28, v51, v51
    v_dot2c_f32_bf16 v30, v244, v25
    v_dot2c_f32_bf16 v31, v245, v25
    v_dot2c_f32_bf16 v30, v246, v25
    v_dot2c_f32_bf16 v31, v247, v25
    v_mfma_f32_32x32x16_bf16 v[160:175], v[48:51], v[88:91], v[160:175]
    ds_read_b128 v[104:107], v21 offset:24576
    ds_read_b128 v[108:111], v21 offset:28672
    v_mfma_f32_32x32x16_bf16 v[176:191], v[48:51], v[92:95], v[176:191]
    ds_read_b128 v[112:115], v21 offset:32768
    ds_read_b128 v[116:119], v21 offset:36864
    v_mfma_f32_32x32x16_bf16 v[192:207], v[48:51], v[96:99], v[192:207]
    ds_read_b128 v[120:123], v21 offset:40960
    ds_read_b128 v[124:127], v21 offset:45056
    v_mfma_f32_32x32x16_bf16 v[208:223], v[48:51], v[100:103], v[208:223]
    ds_read_b128 v[248:251], v253 offset:24576
    s_waitcnt lgkmcnt(0)
    v_mfma_f32_32x32x16_bf16 v[128:143], v[52:55], v[104:107], v[128:143]
    ds_read_b128 v[80:83], v22 offset:24576
    ds_read_b128 v[84:87], v22 offset:28672
    s_mov_b32 s48, 512
    s_add_u32 m0, s49, 0x0
    s_nop 0
    buffer_load_dwordx4 v5, s[8:11], s48 offen lds
    s_add_u32 m0, s49, 0x400
    s_nop 0
    v_mfma_f32_32x32x16_bf16 v[144:159], v[52:55], v[108:111], v[144:159]
    ds_read_b128 v[88:91], v22 offset:32768
    ds_read_b128 v[92:95], v22 offset:36864
    buffer_load_dwordx4 v6, s[8:11], s48 offen lds
    s_add_u32 m0, s49, 0x800
    s_nop 0
    buffer_load_dwordx4 v7, s[8:11], s48 offen lds
    s_add_u32 m0, s49, 0xc00
    s_nop 0
    v_mfma_f32_32x32x16_bf16 v[160:175], v[52:55], v[112:115], v[160:175]
    ds_read_b128 v[96:99], v22 offset:40960
    ds_read_b128 v[100:103], v22 offset:45056
    buffer_load_dwordx4 v8, s[8:11], s48 offen lds
    v_dot2c_f32_bf16 v238, v52, v25
    v_dot2c_f32_bf16 v29, v52, v52
    v_dot2c_f32_bf16 v239, v53, v25
    v_dot2c_f32_bf16 v28, v53, v53
    v_dot2c_f32_bf16 v238, v54, v25
    v_mfma_f32_32x32x16_bf16 v[176:191], v[52:55], v[116:119], v[176:191]
    ds_read_b128 v[244:247], v254 offset:24576
    v_dot2c_f32_bf16 v29, v54, v54
    v_dot2c_f32_bf16 v239, v55, v25
    v_dot2c_f32_bf16 v28, v55, v55
    v_dot2c_f32_bf16 v30, v248, v25
    v_dot2c_f32_bf16 v31, v249, v25
    v_dot2c_f32_bf16 v30, v250, v25
    v_mfma_f32_32x32x16_bf16 v[192:207], v[52:55], v[120:123], v[192:207]
    v_dot2c_f32_bf16 v31, v251, v25
    v_mfma_f32_32x32x16_bf16 v[208:223], v[52:55], v[124:127], v[208:223]
    s_waitcnt lgkmcnt(0)
    v_mfma_f32_32x32x16_bf16 v[128:143], v[56:59], v[80:83], v[128:143]
    ds_read_b128 v[104:107], v23 offset:24576
    ds_read_b128 v[108:111], v23 offset:28672
    v_dot2c_f32_bf16 v238, v56, v25
    v_dot2c_f32_bf16 v29, v56, v56
    v_dot2c_f32_bf16 v239, v57, v25
    v_dot2c_f32_bf16 v28, v57, v57
    v_dot2c_f32_bf16 v238, v58, v25
    v_dot2c_f32_bf16 v29, v58, v58
    v_mfma_f32_32x32x16_bf16 v[144:159], v[56:59], v[84:87], v[144:159]
    ds_read_b128 v[112:115], v23 offset:32768
    ds_read_b128 v[116:119], v23 offset:36864
    v_dot2c_f32_bf16 v239, v59, v25
    v_dot2c_f32_bf16 v28, v59, v59
    v_dot2c_f32_bf16 v30, v244, v25
    v_dot2c_f32_bf16 v31, v245, v25
    v_dot2c_f32_bf16 v30, v246, v25
    v_dot2c_f32_bf16 v31, v247, v25
    v_mfma_f32_32x32x16_bf16 v[160:175], v[56:59], v[88:91], v[160:175]
    ds_read_b128 v[120:123], v23 offset:40960
    ds_read_b128 v[124:127], v23 offset:45056
    v_mfma_f32_32x32x16_bf16 v[176:191], v[56:59], v[92:95], v[176:191]
    ds_read_b128 v[248:251], v255 offset:24576
    v_mfma_f32_32x32x16_bf16 v[192:207], v[56:59], v[96:99], v[192:207]
    v_mfma_f32_32x32x16_bf16 v[208:223], v[56:59], v[100:103], v[208:223]
    s_lshl_b32 s58, s2, 3
    s_add_u32 s58, s58, s26
    s_add_u32 s58, s58, 0
    s_mov_b32 s62, 0x800000
    s_mov_b32 s63, 0x00020000
    s_cmp_lt_u32 s58, 2048
    s_cselect_b32 s60, s52, s54
    s_cselect_b32 s61, s53, s55
    s_and_b32 s59, s58, 2047
    s_cmp_lt_u32 s58, 4096
    s_cselect_b32 s62, s62, 0
    s_lshl_b32 s59, s59, 12
    v_lshlrev_b32 v18, 6, v2
    buffer_load_dword v17, v18, s[60:63], s59 offen
    s_waitcnt vmcnt(15) lgkmcnt(0)
    s_barrier
    v_add_u32 v20, 0xc000, v20
    v_add_u32 v21, 0xc000, v21
    v_add_u32 v22, 0xc000, v22
    v_add_u32 v23, 0xc000, v23
    v_add_u32 v252, 0xc000, v252
    v_add_u32 v253, 0xc000, v253
    v_add_u32 v254, 0xc000, v254
    v_add_u32 v255, 0xc000, v255
    v_mfma_f32_32x32x16_bf16 v[128:143], v[60:63], v[104:107], v[128:143]
    ds_read_b128 v[80:83], v20 offset:0
    ds_read_b128 v[84:87], v20 offset:4096
    s_add_u32 s46, s40, 0x280
    s_add_u32 m0, s37, 0x6000
    s_nop 0
    buffer_load_dwordx4 v10, s[12:15], s46 offen lds
    s_add_u32 m0, s37, 0x6400
    s_nop 0
    v_mfma_f32_32x32x16_bf16 v[144:159], v[60:63], v[108:111], v[144:159]
    ds_read_b128 v[88:91], v20 offset:8192
    ds_read_b128 v[92:95], v20 offset:12288
    buffer_load_dwordx4 v11, s[12:15], s46 offen lds
    s_add_u32 m0, s37, 0x6800
    s_nop 0
    buffer_load_dwordx4 v12, s[12:15], s46 offen lds
    v_dot2c_f32_bf16 v238, v60, v25
    v_dot2c_f32_bf16 v29, v60, v60
    v_mfma_f32_32x32x16_bf16 v[160:175], v[60:63], v[112:115], v[160:175]
    ds_read_b128 v[96:99], v20 offset:16384
    ds_read_b128 v[100:103], v20 offset:20480
    v_dot2c_f32_bf16 v239, v61, v25
    v_dot2c_f32_bf16 v28, v61, v61
    v_dot2c_f32_bf16 v238, v62, v25
    v_dot2c_f32_bf16 v29, v62, v62
    v_dot2c_f32_bf16 v239, v63, v25
    v_dot2c_f32_bf16 v28, v63, v63
    v_mfma_f32_32x32x16_bf16 v[176:191], v[60:63], v[116:119], v[176:191]
    ds_read_b128 v[244:247], v252 offset:0
    v_dot2c_f32_bf16 v30, v248, v25
    v_dot2c_f32_bf16 v31, v249, v25
    v_dot2c_f32_bf16 v30, v250, v25
    v_dot2c_f32_bf16 v31, v251, v25
    v_mfma_f32_32x32x16_bf16 v[192:207], v[60:63], v[120:123], v[192:207]
    v_mfma_f32_32x32x16_bf16 v[208:223], v[60:63], v[124:127], v[208:223]
    s_waitcnt lgkmcnt(0)
    s_waitcnt vmcnt(11)
    v_mfma_f32_32x32x16_bf16 v[128:143], v[64:67], v[80:83], v[128:143]
    ds_read_b128 v[32:35], v13 offset:4096
    ds_read_b128 v[36:39], v14 offset:4096
    v_dot2c_f32_bf16 v238, v64, v25
    v_dot2c_f32_bf16 v29, v64, v64
    v_dot2c_f32_bf16 v239, v65, v25
    v_dot2c_f32_bf16 v28, v65, v65
    v_dot2c_f32_bf16 v238, v66, v25
    v_dot2c_f32_bf16 v29, v66, v66
    v_mfma_f32_32x32x16_bf16 v[144:159], v[64:67], v[84:87], v[144:159]
    ds_read_b128 v[40:43], v15 offset:4096
    ds_read_b128 v[44:47], v16 offset:4096
    v_dot2c_f32_bf16 v239, v67, v25
    v_dot2c_f32_bf16 v28, v67, v67
    v_dot2c_f32_bf16 v30, v244, v25
    v_dot2c_f32_bf16 v31, v245, v25
    v_dot2c_f32_bf16 v30, v246, v25
    v_dot2c_f32_bf16 v31, v247, v25
    v_mfma_f32_32x32x16_bf16 v[160:175], v[64:67], v[88:91], v[160:175]
    ds_read_b128 v[104:107], v21 offset:0
    ds_read_b128 v[108:111], v21 offset:4096
    v_mfma_f32_32x32x16_bf16 v[176:191], v[64:67], v[92:95], v[176:191]
    ds_read_b128 v[112:115], v21 offset:8192
    ds_read_b128 v[116:119], v21 offset:12288
    v_mfma_f32_32x32x16_bf16 v[192:207], v[64:67], v[96:99], v[192:207]
    ds_read_b128 v[120:123], v21 offset:16384
    ds_read_b128 v[124:127], v21 offset:20480
    v_mfma_f32_32x32x16_bf16 v[208:223], v[64:67], v[100:103], v[208:223]
    ds_read_b128 v[248:251], v253 offset:0
    s_waitcnt lgkmcnt(0)
    v_mfma_f32_32x32x16_bf16 v[128:143], v[68:71], v[104:107], v[128:143]
    ds_read_b128 v[80:83], v22 offset:0
    ds_read_b128 v[84:87], v22 offset:4096
    s_mov_b32 s48, 640
    s_add_u32 m0, s49, 0x1000
    s_nop 0
    buffer_load_dwordx4 v5, s[8:11], s48 offen lds
    s_add_u32 m0, s49, 0x1400
    s_nop 0
    v_mfma_f32_32x32x16_bf16 v[144:159], v[68:71], v[108:111], v[144:159]
    ds_read_b128 v[88:91], v22 offset:8192
    ds_read_b128 v[92:95], v22 offset:12288
    buffer_load_dwordx4 v6, s[8:11], s48 offen lds
    s_add_u32 m0, s49, 0x1800
    s_nop 0
    buffer_load_dwordx4 v7, s[8:11], s48 offen lds
    s_add_u32 m0, s49, 0x1c00
    s_nop 0
    v_mfma_f32_32x32x16_bf16 v[160:175], v[68:71], v[112:115], v[160:175]
    ds_read_b128 v[96:99], v22 offset:16384
    ds_read_b128 v[100:103], v22 offset:20480
    buffer_load_dwordx4 v8, s[8:11], s48 offen lds
    v_dot2c_f32_bf16 v238, v68, v25
    v_dot2c_f32_bf16 v29, v68, v68
    v_dot2c_f32_bf16 v239, v69, v25
    v_dot2c_f32_bf16 v28, v69, v69
    v_dot2c_f32_bf16 v238, v70, v25
    v_mfma_f32_32x32x16_bf16 v[176:191], v[68:71], v[116:119], v[176:191]
    ds_read_b128 v[244:247], v254 offset:0
    v_dot2c_f32_bf16 v29, v70, v70
    v_dot2c_f32_bf16 v239, v71, v25
    v_dot2c_f32_bf16 v28, v71, v71
    v_dot2c_f32_bf16 v30, v248, v25
    v_dot2c_f32_bf16 v31, v249, v25
    v_dot2c_f32_bf16 v30, v250, v25
    v_mfma_f32_32x32x16_bf16 v[192:207], v[68:71], v[120:123], v[192:207]
    v_dot2c_f32_bf16 v31, v251, v25
    v_mfma_f32_32x32x16_bf16 v[208:223], v[68:71], v[124:127], v[208:223]
    s_waitcnt lgkmcnt(0)
    v_mfma_f32_32x32x16_bf16 v[128:143], v[72:75], v[80:83], v[128:143]
    ds_read_b128 v[104:107], v23 offset:0
    ds_read_b128 v[108:111], v23 offset:4096
    v_dot2c_f32_bf16 v238, v72, v25
    v_dot2c_f32_bf16 v29, v72, v72
    v_dot2c_f32_bf16 v239, v73, v25
    v_dot2c_f32_bf16 v28, v73, v73
    v_dot2c_f32_bf16 v238, v74, v25
    v_dot2c_f32_bf16 v29, v74, v74
    v_mfma_f32_32x32x16_bf16 v[144:159], v[72:75], v[84:87], v[144:159]
    ds_read_b128 v[112:115], v23 offset:8192
    ds_read_b128 v[116:119], v23 offset:12288
    v_dot2c_f32_bf16 v239, v75, v25
    v_dot2c_f32_bf16 v28, v75, v75
    v_dot2c_f32_bf16 v30, v244, v25
    v_dot2c_f32_bf16 v31, v245, v25
    v_dot2c_f32_bf16 v30, v246, v25
    v_dot2c_f32_bf16 v31, v247, v25
    v_mfma_f32_32x32x16_bf16 v[160:175], v[72:75], v[88:91], v[160:175]
    ds_read_b128 v[120:123], v23 offset:16384
    ds_read_b128 v[124:127], v23 offset:20480
    v_mfma_f32_32x32x16_bf16 v[176:191], v[72:75], v[92:95], v[176:191]
    ds_read_b128 v[248:251], v255 offset:0
    v_mfma_f32_32x32x16_bf16 v[192:207], v[72:75], v[96:99], v[192:207]
    v_mfma_f32_32x32x16_bf16 v[208:223], v[72:75], v[100:103], v[208:223]
    s_waitcnt lgkmcnt(0)
    s_barrier
    v_mfma_f32_32x32x16_bf16 v[128:143], v[76:79], v[104:107], v[128:143]
    ds_read_b128 v[80:83], v20 offset:24576
    ds_read_b128 v[84:87], v20 offset:28672
    s_add_u32 s46, s40, 0x300
    s_add_u32 m0, s37, 0xc000
    s_nop 0
    buffer_load_dwordx4 v10, s[12:15], s46 offen lds
    s_add_u32 m0, s37, 0xc400
    s_nop 0
    v_mfma_f32_32x32x16_bf16 v[144:159], v[76:79], v[108:111], v[144:159]
    ds_read_b128 v[88:91], v20 offset:32768
    ds_read_b128 v[92:95], v20 offset:36864
    buffer_load_dwordx4 v11, s[12:15], s46 offen lds
    s_add_u32 m0, s37, 0xc800
    s_nop 0
    buffer_load_dwordx4 v12, s[12:15], s46 offen lds
    v_dot2c_f32_bf16 v238, v76, v25
    v_dot2c_f32_bf16 v29, v76, v76
    v_mfma_f32_32x32x16_bf16 v[160:175], v[76:79], v[112:115], v[160:175]
    ds_read_b128 v[96:99], v20 offset:40960
    ds_read_b128 v[100:103], v20 offset:45056
    v_dot2c_f32_bf16 v239, v77, v25
    v_dot2c_f32_bf16 v28, v77, v77
    v_dot2c_f32_bf16 v238, v78, v25
    v_dot2c_f32_bf16 v29, v78, v78
    v_dot2c_f32_bf16 v239, v79, v25
    v_dot2c_f32_bf16 v28, v79, v79
    v_mfma_f32_32x32x16_bf16 v[176:191], v[76:79], v[116:119], v[176:191]
    ds_read_b128 v[244:247], v252 offset:24576
    v_dot2c_f32_bf16 v30, v248, v25
    v_dot2c_f32_bf16 v31, v249, v25
    v_dot2c_f32_bf16 v30, v250, v25
    v_dot2c_f32_bf16 v31, v251, v25
    v_mfma_f32_32x32x16_bf16 v[192:207], v[76:79], v[120:123], v[192:207]
    v_mfma_f32_32x32x16_bf16 v[208:223], v[76:79], v[124:127], v[208:223]
    s_waitcnt lgkmcnt(0)
    s_waitcnt vmcnt(11)
    v_mfma_f32_32x32x16_bf16 v[128:143], v[32:35], v[80:83], v[128:143]
    ds_read_b128 v[48:51], v13 offset:0
    ds_read_b128 v[52:55], v14 offset:0
    v_dot2c_f32_bf16 v238, v32, v25
    v_dot2c_f32_bf16 v29, v32, v32
    v_dot2c_f32_bf16 v239, v33, v25
    v_dot2c_f32_bf16 v28, v33, v33
    v_dot2c_f32_bf16 v238, v34, v25
    v_dot2c_f32_bf16 v29, v34, v34
    v_mfma_f32_32x32x16_bf16 v[144:159], v[32:35], v[84:87], v[144:159]
    ds_read_b128 v[56:59], v15 offset:0
    ds_read_b128 v[60:63], v16 offset:0
    v_dot2c_f32_bf16 v239, v35, v25
    v_dot2c_f32_bf16 v28, v35, v35
    v_dot2c_f32_bf16 v30, v244, v25
    v_dot2c_f32_bf16 v31, v245, v25
    v_dot2c_f32_bf16 v30, v246, v25
    v_dot2c_f32_bf16 v31, v247, v25
    v_mfma_f32_32x32x16_bf16 v[160:175], v[32:35], v[88:91], v[160:175]
    ds_read_b128 v[104:107], v21 offset:24576
    ds_read_b128 v[108:111], v21 offset:28672
    v_mfma_f32_32x32x16_bf16 v[176:191], v[32:35], v[92:95], v[176:191]
    ds_read_b128 v[112:115], v21 offset:32768
    ds_read_b128 v[116:119], v21 offset:36864
    v_mfma_f32_32x32x16_bf16 v[192:207], v[32:35], v[96:99], v[192:207]
    ds_read_b128 v[120:123], v21 offset:40960
    ds_read_b128 v[124:127], v21 offset:45056
    v_mfma_f32_32x32x16_bf16 v[208:223], v[32:35], v[100:103], v[208:223]
    ds_read_b128 v[248:251], v253 offset:24576
    s_waitcnt lgkmcnt(0)
    v_mfma_f32_32x32x16_bf16 v[128:143], v[36:39], v[104:107], v[128:143]
    ds_read_b128 v[80:83], v22 offset:24576
    ds_read_b128 v[84:87], v22 offset:28672
    s_mov_b32 s48, 768
    s_add_u32 m0, s49, 0x0
    s_nop 0
    buffer_load_dwordx4 v5, s[8:11], s48 offen lds
    s_add_u32 m0, s49, 0x400
    s_nop 0
    v_mfma_f32_32x32x16_bf16 v[144:159], v[36:39], v[108:111], v[144:159]
    ds_read_b128 v[88:91], v22 offset:32768
    ds_read_b128 v[92:95], v22 offset:36864
    buffer_load_dwordx4 v6, s[8:11], s48 offen lds
    s_add_u32 m0, s49, 0x800
    s_nop 0
    buffer_load_dwordx4 v7, s[8:11], s48 offen lds
    s_add_u32 m0, s49, 0xc00
    s_nop 0
    v_mfma_f32_32x32x16_bf16 v[160:175], v[36:39], v[112:115], v[160:175]
    ds_read_b128 v[96:99], v22 offset:40960
    ds_read_b128 v[100:103], v22 offset:45056
    buffer_load_dwordx4 v8, s[8:11], s48 offen lds
    v_dot2c_f32_bf16 v238, v36, v25
    v_dot2c_f32_bf16 v29, v36, v36
    v_dot2c_f32_bf16 v239, v37, v25
    v_dot2c_f32_bf16 v28, v37, v37
    v_dot2c_f32_bf16 v238, v38, v25
    v_mfma_f32_32x32x16_bf16 v[176:191], v[36:39], v[116:119], v[176:191]
    ds_read_b128 v[244:247], v254 offset:24576
    v_dot2c_f32_bf16 v29, v38, v38
    v_dot2c_f32_bf16 v239, v39, v25
    v_dot2c_f32_bf16 v28, v39, v39
    v_dot2c_f32_bf16 v30, v248, v25
    v_dot2c_f32_bf16 v31, v249, v25
    v_dot2c_f32_bf16 v30, v250, v25
    v_mfma_f32_32x32x16_bf16 v[192:207], v[36:39], v[120:123], v[192:207]
    v_dot2c_f32_bf16 v31, v251, v25
    v_mfma_f32_32x32x16_bf16 v[208:223], v[36:39], v[124:127], v[208:223]
    s_lshl_b32 s58, s2, 3
    s_add_u32 s58, s58, s26
    s_add_u32 s58, s58, 1920
    s_mov_b32 s62, 0x800000
    s_mov_b32 s63, 0x00020000
    s_cmp_lt_u32 s58, 2048
    s_cselect_b32 s60, s52, s54
    s_cselect_b32 s61, s53, s55
    s_and_b32 s59, s58, 2047
    s_cmp_lt_u32 s58, 4096
    s_cselect_b32 s62, s62, 0
    s_lshl_b32 s59, s59, 12
    v_lshlrev_b32 v18, 6, v2
    buffer_load_dword v17, v18, s[60:63], s59 offen
    s_waitcnt lgkmcnt(0)
    v_mfma_f32_32x32x16_bf16 v[128:143], v[40:43], v[80:83], v[128:143]
    ds_read_b128 v[104:107], v23 offset:24576
    ds_read_b128 v[108:111], v23 offset:28672
    v_dot2c_f32_bf16 v238, v40, v25
    v_dot2c_f32_bf16 v29, v40, v40
    v_dot2c_f32_bf16 v239, v41, v25
    v_dot2c_f32_bf16 v28, v41, v41
    v_dot2c_f32_bf16 v238, v42, v25
    v_dot2c_f32_bf16 v29, v42, v42
    v_mfma_f32_32x32x16_bf16 v[144:159], v[40:43], v[84:87], v[144:159]
    ds_read_b128 v[112:115], v23 offset:32768
    ds_read_b128 v[116:119], v23 offset:36864
    v_dot2c_f32_bf16 v239, v43, v25
    v_dot2c_f32_bf16 v28, v43, v43
    v_dot2c_f32_bf16 v30, v244, v25
    v_dot2c_f32_bf16 v31, v245, v25
    v_dot2c_f32_bf16 v30, v246, v25
    v_dot2c_f32_bf16 v31, v247, v25
    v_mfma_f32_32x32x16_bf16 v[160:175], v[40:43], v[88:91], v[160:175]
    ds_read_b128 v[120:123], v23 offset:40960
    ds_read_b128 v[124:127], v23 offset:45056
    v_mfma_f32_32x32x16_bf16 v[176:191], v[40:43], v[92:95], v[176:191]
    ds_read_b128 v[248:251], v255 offset:24576
    v_mfma_f32_32x32x16_bf16 v[192:207], v[40:43], v[96:99], v[192:207]
    v_mfma_f32_32x32x16_bf16 v[208:223], v[40:43], v[100:103], v[208:223]
    s_waitcnt lgkmcnt(0)
    s_barrier
    v_subrev_u32 v20, 0xc000, v20
    v_subrev_u32 v21, 0xc000, v21
    v_subrev_u32 v22, 0xc000, v22
    v_subrev_u32 v23, 0xc000, v23
    v_subrev_u32 v252, 0xc000, v252
    v_subrev_u32 v253, 0xc000, v253
    v_subrev_u32 v254, 0xc000, v254
    v_subrev_u32 v255, 0xc000, v255
    v_mfma_f32_32x32x16_bf16 v[128:143], v[44:47], v[104:107], v[128:143]
    ds_read_b128 v[80:83], v20 offset:0
    ds_read_b128 v[84:87], v20 offset:4096
    s_add_u32 s46, s40, 0x380
    s_add_u32 m0, s37, 0x12000
    s_nop 0
    buffer_load_dwordx4 v10, s[12:15], s46 offen lds
    s_add_u32 m0, s37, 0x12400
    s_nop 0
    v_mfma_f32_32x32x16_bf16 v[144:159], v[44:47], v[108:111], v[144:159]
    ds_read_b128 v[88:91], v20 offset:8192
    ds_read_b128 v[92:95], v20 offset:12288
    buffer_load_dwordx4 v11, s[12:15], s46 offen lds
    s_add_u32 m0, s37, 0x12800
    s_nop 0
    buffer_load_dwordx4 v12, s[12:15], s46 offen lds
    v_dot2c_f32_bf16 v238, v44, v25
    v_dot2c_f32_bf16 v29, v44, v44
    v_mfma_f32_32x32x16_bf16 v[160:175], v[44:47], v[112:115], v[160:175]
    ds_read_b128 v[96:99], v20 offset:16384
    ds_read_b128 v[100:103], v20 offset:20480
    v_dot2c_f32_bf16 v239, v45, v25
    v_dot2c_f32_bf16 v28, v45, v45
    v_dot2c_f32_bf16 v238, v46, v25
    v_dot2c_f32_bf16 v29, v46, v46
    v_dot2c_f32_bf16 v239, v47, v25
    v_dot2c_f32_bf16 v28, v47, v47
    v_mfma_f32_32x32x16_bf16 v[176:191], v[44:47], v[116:119], v[176:191]
    ds_read_b128 v[244:247], v252 offset:0
    v_dot2c_f32_bf16 v30, v248, v25
    v_dot2c_f32_bf16 v31, v249, v25
    v_dot2c_f32_bf16 v30, v250, v25
    v_dot2c_f32_bf16 v31, v251, v25
    v_mfma_f32_32x32x16_bf16 v[192:207], v[44:47], v[120:123], v[192:207]
    v_mfma_f32_32x32x16_bf16 v[208:223], v[44:47], v[124:127], v[208:223]
    s_waitcnt lgkmcnt(0)
    s_waitcnt vmcnt(11)
    v_mfma_f32_32x32x16_bf16 v[128:143], v[48:51], v[80:83], v[128:143]
    ds_read_b128 v[64:67], v13 offset:4096
    ds_read_b128 v[68:71], v14 offset:4096
    v_dot2c_f32_bf16 v238, v48, v25
    v_dot2c_f32_bf16 v29, v48, v48
    v_dot2c_f32_bf16 v239, v49, v25
    v_dot2c_f32_bf16 v28, v49, v49
    v_dot2c_f32_bf16 v238, v50, v25
    v_dot2c_f32_bf16 v29, v50, v50
    v_mfma_f32_32x32x16_bf16 v[144:159], v[48:51], v[84:87], v[144:159]
    ds_read_b128 v[72:75], v15 offset:4096
    ds_read_b128 v[76:79], v16 offset:4096
    v_dot2c_f32_bf16 v239, v51, v25
    v_dot2c_f32_bf16 v28, v51, v51
    v_dot2c_f32_bf16 v30, v244, v25
    v_dot2c_f32_bf16 v31, v245, v25
    v_dot2c_f32_bf16 v30, v246, v25
    v_dot2c_f32_bf16 v31, v247, v25
    v_mfma_f32_32x32x16_bf16 v[160:175], v[48:51], v[88:91], v[160:175]
    ds_read_b128 v[104:107], v21 offset:0
    ds_read_b128 v[108:111], v21 offset:4096
    v_mfma_f32_32x32x16_bf16 v[176:191], v[48:51], v[92:95], v[176:191]
    ds_read_b128 v[112:115], v21 offset:8192
    ds_read_b128 v[116:119], v21 offset:12288
    v_mfma_f32_32x32x16_bf16 v[192:207], v[48:51], v[96:99], v[192:207]
    ds_read_b128 v[120:123], v21 offset:16384
    ds_read_b128 v[124:127], v21 offset:20480
    v_mfma_f32_32x32x16_bf16 v[208:223], v[48:51], v[100:103], v[208:223]
    ds_read_b128 v[248:251], v253 offset:0
    s_waitcnt lgkmcnt(0)
    v_mfma_f32_32x32x16_bf16 v[128:143], v[52:55], v[104:107], v[128:143]
    ds_read_b128 v[80:83], v22 offset:0
    ds_read_b128 v[84:87], v22 offset:4096
    s_mov_b32 s48, 896
    s_add_u32 m0, s49, 0x1000
    s_nop 0
    buffer_load_dwordx4 v5, s[8:11], s48 offen lds
    s_add_u32 m0, s49, 0x1400
    s_nop 0
    v_mfma_f32_32x32x16_bf16 v[144:159], v[52:55], v[108:111], v[144:159]
    ds_read_b128 v[88:91], v22 offset:8192
    ds_read_b128 v[92:95], v22 offset:12288
    buffer_load_dwordx4 v6, s[8:11], s48 offen lds
    s_add_u32 m0, s49, 0x1800
    s_nop 0
    buffer_load_dwordx4 v7, s[8:11], s48 offen lds
    s_add_u32 m0, s49, 0x1c00
    s_nop 0
    v_mfma_f32_32x32x16_bf16 v[160:175], v[52:55], v[112:115], v[160:175]
    ds_read_b128 v[96:99], v22 offset:16384
    ds_read_b128 v[100:103], v22 offset:20480
    buffer_load_dwordx4 v8, s[8:11], s48 offen lds
    v_dot2c_f32_bf16 v238, v52, v25
    v_dot2c_f32_bf16 v29, v52, v52
    v_dot2c_f32_bf16 v239, v53, v25
    v_dot2c_f32_bf16 v28, v53, v53
    v_dot2c_f32_bf16 v238, v54, v25
    v_mfma_f32_32x32x16_bf16 v[176:191], v[52:55], v[116:119], v[176:191]
    ds_read_b128 v[244:247], v254 offset:0
    v_dot2c_f32_bf16 v29, v54, v54
    v_dot2c_f32_bf16 v239, v55, v25
    v_dot2c_f32_bf16 v28, v55, v55
    v_dot2c_f32_bf16 v30, v248, v25
    v_dot2c_f32_bf16 v31, v249, v25
    v_dot2c_f32_bf16 v30, v250, v25
    v_mfma_f32_32x32x16_bf16 v[192:207], v[52:55], v[120:123], v[192:207]
    v_dot2c_f32_bf16 v31, v251, v25
    v_mfma_f32_32x32x16_bf16 v[208:223], v[52:55], v[124:127], v[208:223]
    s_waitcnt lgkmcnt(0)
    v_mfma_f32_32x32x16_bf16 v[128:143], v[56:59], v[80:83], v[128:143]
    ds_read_b128 v[104:107], v23 offset:0
    ds_read_b128 v[108:111], v23 offset:4096
    v_dot2c_f32_bf16 v238, v56, v25
    v_dot2c_f32_bf16 v29, v56, v56
    v_dot2c_f32_bf16 v239, v57, v25
    v_dot2c_f32_bf16 v28, v57, v57
    v_dot2c_f32_bf16 v238, v58, v25
    v_dot2c_f32_bf16 v29, v58, v58
    v_mfma_f32_32x32x16_bf16 v[144:159], v[56:59], v[84:87], v[144:159]
    ds_read_b128 v[112:115], v23 offset:8192
    ds_read_b128 v[116:119], v23 offset:12288
    v_dot2c_f32_bf16 v239, v59, v25
    v_dot2c_f32_bf16 v28, v59, v59
    v_dot2c_f32_bf16 v30, v244, v25
    v_dot2c_f32_bf16 v31, v245, v25
    v_dot2c_f32_bf16 v30, v246, v25
    v_dot2c_f32_bf16 v31, v247, v25
    v_mfma_f32_32x32x16_bf16 v[160:175], v[56:59], v[88:91], v[160:175]
    ds_read_b128 v[120:123], v23 offset:16384
    ds_read_b128 v[124:127], v23 offset:20480
    v_mfma_f32_32x32x16_bf16 v[176:191], v[56:59], v[92:95], v[176:191]
    ds_read_b128 v[248:251], v255 offset:0
    v_mfma_f32_32x32x16_bf16 v[192:207], v[56:59], v[96:99], v[192:207]
    v_mfma_f32_32x32x16_bf16 v[208:223], v[56:59], v[100:103], v[208:223]
    s_waitcnt lgkmcnt(0)
    s_barrier
    v_mfma_f32_32x32x16_bf16 v[128:143], v[60:63], v[104:107], v[128:143]
    ds_read_b128 v[80:83], v20 offset:24576
    ds_read_b128 v[84:87], v20 offset:28672
    s_add_u32 s46, s40, 0x400
    s_add_u32 m0, s37, 0x0
    s_nop 0
    buffer_load_dwordx4 v10, s[12:15], s46 offen lds
    s_add_u32 m0, s37, 0x400
    s_nop 0
    v_mfma_f32_32x32x16_bf16 v[144:159], v[60:63], v[108:111], v[144:159]
    ds_read_b128 v[88:91], v20 offset:32768
    ds_read_b128 v[92:95], v20 offset:36864
    buffer_load_dwordx4 v11, s[12:15], s46 offen lds
    s_add_u32 m0, s37, 0x800
    s_nop 0
    buffer_load_dwordx4 v12, s[12:15], s46 offen lds
    v_dot2c_f32_bf16 v238, v60, v25
    v_dot2c_f32_bf16 v29, v60, v60
    v_mfma_f32_32x32x16_bf16 v[160:175], v[60:63], v[112:115], v[160:175]
    ds_read_b128 v[96:99], v20 offset:40960
    ds_read_b128 v[100:103], v20 offset:45056
    v_dot2c_f32_bf16 v239, v61, v25
    v_dot2c_f32_bf16 v28, v61, v61
    v_dot2c_f32_bf16 v238, v62, v25
    v_dot2c_f32_bf16 v29, v62, v62
    v_dot2c_f32_bf16 v239, v63, v25
    v_dot2c_f32_bf16 v28, v63, v63
    v_mfma_f32_32x32x16_bf16 v[176:191], v[60:63], v[116:119], v[176:191]
    ds_read_b128 v[244:247], v252 offset:24576
    v_dot2c_f32_bf16 v30, v248, v25
    v_dot2c_f32_bf16 v31, v249, v25
    v_dot2c_f32_bf16 v30, v250, v25
    v_dot2c_f32_bf16 v31, v251, v25
    v_mfma_f32_32x32x16_bf16 v[192:207], v[60:63], v[120:123], v[192:207]
    v_mfma_f32_32x32x16_bf16 v[208:223], v[60:63], v[124:127], v[208:223]
    s_waitcnt lgkmcnt(0)
    s_waitcnt vmcnt(11)
    v_mfma_f32_32x32x16_bf16 v[128:143], v[64:67], v[80:83], v[128:143]
    ds_read_b128 v[32:35], v13 offset:0
    ds_read_b128 v[36:39], v14 offset:0
    v_dot2c_f32_bf16 v238, v64, v25
    v_dot2c_f32_bf16 v29, v64, v64
    v_dot2c_f32_bf16 v239, v65, v25
    v_dot2c_f32_bf16 v28, v65, v65
    v_dot2c_f32_bf16 v238, v66, v25
    v_dot2c_f32_bf16 v29, v66, v66
    v_mfma_f32_32x32x16_bf16 v[144:159], v[64:67], v[84:87], v[144:159]
    ds_read_b128 v[40:43], v15 offset:0
    ds_read_b128 v[44:47], v16 offset:0
    v_dot2c_f32_bf16 v239, v67, v25
    v_dot2c_f32_bf16 v28, v67, v67
    v_dot2c_f32_bf16 v30, v244, v25
    v_dot2c_f32_bf16 v31, v245, v25
    v_dot2c_f32_bf16 v30, v246, v25
    v_dot2c_f32_bf16 v31, v247, v25
    v_mfma_f32_32x32x16_bf16 v[160:175], v[64:67], v[88:91], v[160:175]
    ds_read_b128 v[104:107], v21 offset:24576
    ds_read_b128 v[108:111], v21 offset:28672
    v_mfma_f32_32x32x16_bf16 v[176:191], v[64:67], v[92:95], v[176:191]
    ds_read_b128 v[112:115], v21 offset:32768
    ds_read_b128 v[116:119], v21 offset:36864
    v_mfma_f32_32x32x16_bf16 v[192:207], v[64:67], v[96:99], v[192:207]
    ds_read_b128 v[120:123], v21 offset:40960
    ds_read_b128 v[124:127], v21 offset:45056
    v_mfma_f32_32x32x16_bf16 v[208:223], v[64:67], v[100:103], v[208:223]
    ds_read_b128 v[248:251], v253 offset:24576
    s_waitcnt lgkmcnt(0)
    v_mfma_f32_32x32x16_bf16 v[128:143], v[68:71], v[104:107], v[128:143]
    ds_read_b128 v[80:83], v22 offset:24576
    ds_read_b128 v[84:87], v22 offset:28672
    s_mov_b32 s48, 1024
    s_add_u32 m0, s49, 0x0
    s_nop 0
    buffer_load_dwordx4 v5, s[8:11], s48 offen lds
    s_add_u32 m0, s49, 0x400
    s_nop 0
    v_mfma_f32_32x32x16_bf16 v[144:159], v[68:71], v[108:111], v[144:159]
    ds_read_b128 v[88:91], v22 offset:32768
    ds_read_b128 v[92:95], v22 offset:36864
    buffer_load_dwordx4 v6, s[8:11], s48 offen lds
    s_add_u32 m0, s49, 0x800
    s_nop 0
    buffer_load_dwordx4 v7, s[8:11], s48 offen lds
    s_add_u32 m0, s49, 0xc00
    s_nop 0
    v_mfma_f32_32x32x16_bf16 v[160:175], v[68:71], v[112:115], v[160:175]
    ds_read_b128 v[96:99], v22 offset:40960
    ds_read_b128 v[100:103], v22 offset:45056
    buffer_load_dwordx4 v8, s[8:11], s48 offen lds
    v_dot2c_f32_bf16 v238, v68, v25
    v_dot2c_f32_bf16 v29, v68, v68
    v_dot2c_f32_bf16 v239, v69, v25
    v_dot2c_f32_bf16 v28, v69, v69
    v_dot2c_f32_bf16 v238, v70, v25
    v_mfma_f32_32x32x16_bf16 v[176:191], v[68:71], v[116:119], v[176:191]
    ds_read_b128 v[244:247], v254 offset:24576
    v_dot2c_f32_bf16 v29, v70, v70
    v_dot2c_f32_bf16 v239, v71, v25
    v_dot2c_f32_bf16 v28, v71, v71
    v_dot2c_f32_bf16 v30, v248, v25
    v_dot2c_f32_bf16 v31, v249, v25
    v_dot2c_f32_bf16 v30, v250, v25
    v_mfma_f32_32x32x16_bf16 v[192:207], v[68:71], v[120:123], v[192:207]
    v_dot2c_f32_bf16 v31, v251, v25
    v_mfma_f32_32x32x16_bf16 v[208:223], v[68:71], v[124:127], v[208:223]
    s_lshl_b32 s58, s2, 3
    s_add_u32 s58, s58, s26
    s_add_u32 s58, s58, 3840
    s_mov_b32 s62, 0x800000
    s_mov_b32 s63, 0x00020000
    s_cmp_lt_u32 s58, 2048
    s_cselect_b32 s60, s52, s54
    s_cselect_b32 s61, s53, s55
    s_and_b32 s59, s58, 2047
    s_cmp_lt_u32 s58, 4096
    s_cselect_b32 s62, s62, 0
    s_lshl_b32 s59, s59, 12
    v_lshlrev_b32 v18, 6, v2
    buffer_load_dword v17, v18, s[60:63], s59 offen
    s_waitcnt lgkmcnt(0)
    v_mfma_f32_32x32x16_bf16 v[128:143], v[72:75], v[80:83], v[128:143]
    ds_read_b128 v[104:107], v23 offset:24576
    ds_read_b128 v[108:111], v23 offset:28672
    v_dot2c_f32_bf16 v238, v72, v25
    v_dot2c_f32_bf16 v29, v72, v72
    v_dot2c_f32_bf16 v239, v73, v25
    v_dot2c_f32_bf16 v28, v73, v73
    v_dot2c_f32_bf16 v238, v74, v25
    v_dot2c_f32_bf16 v29, v74, v74
    v_mfma_f32_32x32x16_bf16 v[144:159], v[72:75], v[84:87], v[144:159]
    ds_read_b128 v[112:115], v23 offset:32768
    ds_read_b128 v[116:119], v23 offset:36864
    v_dot2c_f32_bf16 v239, v75, v25
    v_dot2c_f32_bf16 v28, v75, v75
    v_dot2c_f32_bf16 v30, v244, v25
    v_dot2c_f32_bf16 v31, v245, v25
    v_dot2c_f32_bf16 v30, v246, v25
    v_dot2c_f32_bf16 v31, v247, v25
    v_mfma_f32_32x32x16_bf16 v[160:175], v[72:75], v[88:91], v[160:175]
    ds_read_b128 v[120:123], v23 offset:40960
    ds_read_b128 v[124:127], v23 offset:45056
    v_mfma_f32_32x32x16_bf16 v[176:191], v[72:75], v[92:95], v[176:191]
    ds_read_b128 v[248:251], v255 offset:24576
    v_mfma_f32_32x32x16_bf16 v[192:207], v[72:75], v[96:99], v[192:207]
    v_mfma_f32_32x32x16_bf16 v[208:223], v[72:75], v[100:103], v[208:223]
    s_waitcnt vmcnt(5) lgkmcnt(0)
    s_barrier
    v_mfma_f32_32x32x16_bf16 v[128:143], v[76:79], v[104:107], v[128:143]
    v_dot2c_f32_bf16 v238, v76, v25
    v_dot2c_f32_bf16 v29, v76, v76
    v_dot2c_f32_bf16 v239, v77, v25
    v_dot2c_f32_bf16 v28, v77, v77
    v_dot2c_f32_bf16 v238, v78, v25
    v_dot2c_f32_bf16 v29, v78, v78
    v_mfma_f32_32x32x16_bf16 v[144:159], v[76:79], v[108:111], v[144:159]
    v_dot2c_f32_bf16 v239, v79, v25
    v_dot2c_f32_bf16 v28, v79, v79
    v_dot2c_f32_bf16 v30, v248, v25
    v_dot2c_f32_bf16 v31, v249, v25
    v_dot2c_f32_bf16 v30, v250, v25
    v_dot2c_f32_bf16 v31, v251, v25
    v_mfma_f32_32x32x16_bf16 v[160:175], v[76:79], v[112:115], v[160:175]
    v_mfma_f32_32x32x16_bf16 v[176:191], v[76:79], v[116:119], v[176:191]
    v_mfma_f32_32x32x16_bf16 v[192:207], v[76:79], v[120:123], v[192:207]
    v_mfma_f32_32x32x16_bf16 v[208:223], v[76:79], v[124:127], v[208:223]
    v_add_u32 v20, 0xc000, v20
    v_add_u32 v21, 0xc000, v21
    v_add_u32 v22, 0xc000, v22
    v_add_u32 v23, 0xc000, v23
    v_add_u32 v252, 0xc000, v252
    v_add_u32 v253, 0xc000, v253
    v_add_u32 v254, 0xc000, v254
    v_add_u32 v255, 0xc000, v255
    ds_read_b128 v[80:83], v20 offset:0
    ds_read_b128 v[84:87], v21 offset:0
    ds_read_b128 v[88:91], v22 offset:0
    ds_read_b128 v[92:95], v23 offset:0
    ds_read_b128 v[120:123], v252 offset:0
    ds_read_b128 v[124:127], v253 offset:0
    s_waitcnt lgkmcnt(0)
    v_dot2c_f32_bf16 v30, v120, v25
    v_dot2c_f32_bf16 v31, v121, v25
    v_dot2c_f32_bf16 v30, v122, v25
    v_dot2c_f32_bf16 v31, v123, v25
    v_dot2c_f32_bf16 v30, v124, v25
    v_dot2c_f32_bf16 v31, v125, v25
    v_dot2c_f32_bf16 v30, v126, v25
    v_dot2c_f32_bf16 v31, v127, v25
    v_mfma_f32_32x32x16_bf16 v[128:143], v[32:35], v[80:83], v[128:143]
    ds_read_b128 v[48:51], v13 offset:4096
    ds_read_b128 v[52:55], v14 offset:4096
    ds_read_b128 v[56:59], v15 offset:4096
    v_dot2c_f32_bf16 v238, v32, v25
    v_dot2c_f32_bf16 v29, v32, v32
    v_dot2c_f32_bf16 v239, v33, v25
    v_dot2c_f32_bf16 v28, v33, v33
    v_dot2c_f32_bf16 v238, v34, v25
    v_dot2c_f32_bf16 v29, v34, v34
    v_dot2c_f32_bf16 v239, v35, v25
    v_dot2c_f32_bf16 v28, v35, v35
    v_dot2c_f32_bf16 v238, v36, v25
    v_dot2c_f32_bf16 v29, v36, v36
    v_dot2c_f32_bf16 v239, v37, v25
    v_dot2c_f32_bf16 v28, v37, v37
    v_dot2c_f32_bf16 v238, v38, v25
    v_dot2c_f32_bf16 v29, v38, v38
    v_mfma_f32_32x32x16_bf16 v[128:143], v[36:39], v[84:87], v[128:143]
    ds_read_b128 v[60:63], v16 offset:4096
    ds_read_b128 v[96:99], v20 offset:4096
    ds_read_b128 v[100:103], v21 offset:4096
    v_dot2c_f32_bf16 v239, v39, v25
    v_dot2c_f32_bf16 v28, v39, v39
    v_dot2c_f32_bf16 v238, v40, v25
    v_dot2c_f32_bf16 v29, v40, v40
    v_dot2c_f32_bf16 v239, v41, v25
    v_dot2c_f32_bf16 v28, v41, v41
    v_dot2c_f32_bf16 v238, v42, v25
    v_dot2c_f32_bf16 v29, v42, v42
    v_dot2c_f32_bf16 v239, v43, v25
    v_dot2c_f32_bf16 v28, v43, v43
    v_dot2c_f32_bf16 v238, v44, v25
    v_dot2c_f32_bf16 v29, v44, v44
    v_dot2c_f32_bf16 v239, v45, v25
    v_dot2c_f32_bf16 v28, v45, v45
    v_mfma_f32_32x32x16_bf16 v[128:143], v[40:43], v[88:91], v[128:143]
    ds_read_b128 v[104:107], v22 offset:4096
    ds_read_b128 v[108:111], v23 offset:4096
    ds_read_b128 v[120:123], v254 offset:0
    v_dot2c_f32_bf16 v238, v46, v25
    v_dot2c_f32_bf16 v29, v46, v46
    v_dot2c_f32_bf16 v239, v47, v25
    v_dot2c_f32_bf16 v28, v47, v47
    v_mfma_f32_32x32x16_bf16 v[128:143], v[44:47], v[92:95], v[128:143]
    ds_read_b128 v[124:127], v255 offset:0
    s_waitcnt lgkmcnt(0)
    v_dot2c_f32_bf16 v30, v120, v25
    v_dot2c_f32_bf16 v31, v121, v25
    v_dot2c_f32_bf16 v30, v122, v25
    v_dot2c_f32_bf16 v31, v123, v25
    v_dot2c_f32_bf16 v30, v124, v25
    v_dot2c_f32_bf16 v31, v125, v25
    v_dot2c_f32_bf16 v30, v126, v25
    v_dot2c_f32_bf16 v31, v127, v25
    v_mfma_f32_32x32x16_bf16 v[144:159], v[32:35], v[96:99], v[144:159]
    ds_read_b128 v[80:83], v20 offset:24576
    ds_read_b128 v[84:87], v21 offset:24576
    v_mfma_f32_32x32x16_bf16 v[144:159], v[36:39], v[100:103], v[144:159]
    ds_read_b128 v[88:91], v22 offset:24576
    ds_read_b128 v[92:95], v23 offset:24576
    v_mfma_f32_32x32x16_bf16 v[144:159], v[40:43], v[104:107], v[144:159]
    ds_read_b128 v[120:123], v252 offset:24576
    ds_read_b128 v[124:127], v253 offset:24576
    v_mfma_f32_32x32x16_bf16 v[144:159], v[44:47], v[108:111], v[144:159]
    s_waitcnt lgkmcnt(0)
    v_dot2c_f32_bf16 v30, v120, v25
    v_dot2c_f32_bf16 v31, v121, v25
    v_dot2c_f32_bf16 v30, v122, v25
    v_dot2c_f32_bf16 v31, v123, v25
    v_dot2c_f32_bf16 v30, v124, v25
    v_dot2c_f32_bf16 v31, v125, v25
    v_dot2c_f32_bf16 v30, v126, v25
    v_dot2c_f32_bf16 v31, v127, v25
    s_waitcnt vmcnt(1)
    v_mfma_f32_32x32x16_bf16 v[128:143], v[48:51], v[80:83], v[128:143]
    ds_read_b128 v[64:67], v13 offset:0
    ds_read_b128 v[68:71], v14 offset:0
    ds_read_b128 v[72:75], v15 offset:0
    v_dot2c_f32_bf16 v238, v48, v25
    v_dot2c_f32_bf16 v29, v48, v48
    v_dot2c_f32_bf16 v239, v49, v25
    v_dot2c_f32_bf16 v28, v49, v49
    v_dot2c_f32_bf16 v238, v50, v25
    v_dot2c_f32_bf16 v29, v50, v50
    v_dot2c_f32_bf16 v239, v51, v25
    v_dot2c_f32_bf16 v28, v51, v51
    v_dot2c_f32_bf16 v238, v52, v25
    v_dot2c_f32_bf16 v29, v52, v52
    v_dot2c_f32_bf16 v239, v53, v25
    v_dot2c_f32_bf16 v28, v53, v53
    v_dot2c_f32_bf16 v238, v54, v25
    v_dot2c_f32_bf16 v29, v54, v54
    v_mfma_f32_32x32x16_bf16 v[128:143], v[52:55], v[84:87], v[128:143]
    ds_read_b128 v[76:79], v16 offset:0
    ds_read_b128 v[96:99], v20 offset:28672
    ds_read_b128 v[100:103], v21 offset:28672
    v_dot2c_f32_bf16 v239, v55, v25
    v_dot2c_f32_bf16 v28, v55, v55
    v_dot2c_f32_bf16 v238, v56, v25
    v_dot2c_f32_bf16 v29, v56, v56
    v_dot2c_f32_bf16 v239, v57, v25
    v_dot2c_f32_bf16 v28, v57, v57
    v_dot2c_f32_bf16 v238, v58, v25
    v_dot2c_f32_bf16 v29, v58, v58
    v_dot2c_f32_bf16 v239, v59, v25
    v_dot2c_f32_bf16 v28, v59, v59
    v_dot2c_f32_bf16 v238, v60, v25
    v_dot2c_f32_bf16 v29, v60, v60
    v_dot2c_f32_bf16 v239, v61, v25
    v_dot2c_f32_bf16 v28, v61, v61
    v_mfma_f32_32x32x16_bf16 v[128:143], v[56:59], v[88:91], v[128:143]
    ds_read_b128 v[104:107], v22 offset:28672
    ds_read_b128 v[108:111], v23 offset:28672
    ds_read_b128 v[120:123], v254 offset:24576
    v_dot2c_f32_bf16 v238, v62, v25
    v_dot2c_f32_bf16 v29, v62, v62
    v_dot2c_f32_bf16 v239, v63, v25
    v_dot2c_f32_bf16 v28, v63, v63
    v_mfma_f32_32x32x16_bf16 v[128:143], v[60:63], v[92:95], v[128:143]
    ds_read_b128 v[124:127], v255 offset:24576
    s_waitcnt lgkmcnt(0)
    v_dot2c_f32_bf16 v30, v120, v25
    v_dot2c_f32_bf16 v31, v121, v25
    v_dot2c_f32_bf16 v30, v122, v25
    v_dot2c_f32_bf16 v31, v123, v25
    v_dot2c_f32_bf16 v30, v124, v25
    v_dot2c_f32_bf16 v31, v125, v25
    v_dot2c_f32_bf16 v30, v126, v25
    v_dot2c_f32_bf16 v31, v127, v25
    v_subrev_u32 v20, 0xc000, v20
    v_subrev_u32 v21, 0xc000, v21
    v_subrev_u32 v22, 0xc000, v22
    v_subrev_u32 v23, 0xc000, v23
    v_subrev_u32 v252, 0xc000, v252
    v_subrev_u32 v253, 0xc000, v253
    v_subrev_u32 v254, 0xc000, v254
    v_subrev_u32 v255, 0xc000, v255
    v_mfma_f32_32x32x16_bf16 v[144:159], v[48:51], v[96:99], v[144:159]
    ds_read_b128 v[80:83], v20 offset:0
    ds_read_b128 v[84:87], v21 offset:0
    v_mfma_f32_32x32x16_bf16 v[144:159], v[52:55], v[100:103], v[144:159]
    ds_read_b128 v[88:91], v22 offset:0
    ds_read_b128 v[92:95], v23 offset:0
    v_mfma_f32_32x32x16_bf16 v[144:159], v[56:59], v[104:107], v[144:159]
    ds_read_b128 v[120:123], v252 offset:0
    ds_read_b128 v[124:127], v253 offset:0
    v_mfma_f32_32x32x16_bf16 v[144:159], v[60:63], v[108:111], v[144:159]
    s_waitcnt lgkmcnt(0)
    v_dot2c_f32_bf16 v30, v120, v25
    v_dot2c_f32_bf16 v31, v121, v25
    v_dot2c_f32_bf16 v30, v122, v25
    v_dot2c_f32_bf16 v31, v123, v25
    v_dot2c_f32_bf16 v30, v124, v25
    v_dot2c_f32_bf16 v31, v125, v25
    v_dot2c_f32_bf16 v30, v126, v25
    v_dot2c_f32_bf16 v31, v127, v25
    v_mfma_f32_32x32x16_bf16 v[128:143], v[64:67], v[80:83], v[128:143]
    ds_read_b128 v[96:99], v20 offset:4096
    ds_read_b128 v[100:103], v21 offset:4096
    v_dot2c_f32_bf16 v238, v64, v25
    v_dot2c_f32_bf16 v29, v64, v64
    v_dot2c_f32_bf16 v239, v65, v25
    v_dot2c_f32_bf16 v28, v65, v65
    v_dot2c_f32_bf16 v238, v66, v25
    v_dot2c_f32_bf16 v29, v66, v66
    v_dot2c_f32_bf16 v239, v67, v25
    v_dot2c_f32_bf16 v28, v67, v67
    v_dot2c_f32_bf16 v238, v68, v25
    v_dot2c_f32_bf16 v29, v68, v68
    v_dot2c_f32_bf16 v239, v69, v25
    v_dot2c_f32_bf16 v28, v69, v69
    v_dot2c_f32_bf16 v238, v70, v25
    v_dot2c_f32_bf16 v29, v70, v70
    v_mfma_f32_32x32x16_bf16 v[128:143], v[68:71], v[84:87], v[128:143]
    ds_read_b128 v[104:107], v22 offset:4096
    ds_read_b128 v[108:111], v23 offset:4096
    v_dot2c_f32_bf16 v239, v71, v25
    v_dot2c_f32_bf16 v28, v71, v71
    v_dot2c_f32_bf16 v238, v72, v25
    v_dot2c_f32_bf16 v29, v72, v72
    v_dot2c_f32_bf16 v239, v73, v25
    v_dot2c_f32_bf16 v28, v73, v73
    v_dot2c_f32_bf16 v238, v74, v25
    v_dot2c_f32_bf16 v29, v74, v74
    v_dot2c_f32_bf16 v239, v75, v25
    v_dot2c_f32_bf16 v28, v75, v75
    v_dot2c_f32_bf16 v238, v76, v25
    v_dot2c_f32_bf16 v29, v76, v76
    v_dot2c_f32_bf16 v239, v77, v25
    v_dot2c_f32_bf16 v28, v77, v77
    v_mfma_f32_32x32x16_bf16 v[128:143], v[72:75], v[88:91], v[128:143]
    ds_read_b128 v[120:123], v254 offset:0
    ds_read_b128 v[124:127], v255 offset:0
    v_dot2c_f32_bf16 v238, v78, v25
    v_dot2c_f32_bf16 v29, v78, v78
    v_dot2c_f32_bf16 v239, v79, v25
    v_dot2c_f32_bf16 v28, v79, v79
    v_mfma_f32_32x32x16_bf16 v[128:143], v[76:79], v[92:95], v[128:143]
    s_waitcnt lgkmcnt(0)
    v_dot2c_f32_bf16 v30, v120, v25
    v_dot2c_f32_bf16 v31, v121, v25
    v_dot2c_f32_bf16 v30, v122, v25
    v_dot2c_f32_bf16 v31, v123, v25
    v_dot2c_f32_bf16 v30, v124, v25
    v_dot2c_f32_bf16 v31, v125, v25
    v_dot2c_f32_bf16 v30, v126, v25
    v_dot2c_f32_bf16 v31, v127, v25
    v_add_u32 v20, 0xc000, v20
    v_add_u32 v21, 0xc000, v21
    v_add_u32 v22, 0xc000, v22
    v_add_u32 v23, 0xc000, v23
    v_add_u32 v252, 0xc000, v252
    v_add_u32 v253, 0xc000, v253
    v_add_u32 v254, 0xc000, v254
    v_add_u32 v255, 0xc000, v255
    v_mfma_f32_32x32x16_bf16 v[144:159], v[64:67], v[96:99], v[144:159]
    ds_read_b128 v[80:83], v20 offset:8192
    v_mfma_f32_32x32x16_bf16 v[144:159], v[68:71], v[100:103], v[144:159]
    ds_read_b128 v[84:87], v21 offset:8192
    v_mfma_f32_32x32x16_bf16 v[144:159], v[72:75], v[104:107], v[144:159]
    ds_read_b128 v[88:91], v22 offset:8192
    v_mfma_f32_32x32x16_bf16 v[144:159], v[76:79], v[108:111], v[144:159]
    ds_read_b128 v[92:95], v23 offset:8192
    s_waitcnt lgkmcnt(0)
    v_mfma_f32_32x32x16_bf16 v[160:175], v[32:35], v[80:83], v[160:175]
    ds_read_b128 v[96:99], v20 offset:32768
    s_nop 3
    v_add_f32 v29, v29, v28
    v_add_f32 v30, v30, v31
    v_add_f32 v28, v238, v239
    v_mov_b32 v224, v28
    v_mov_b32 v225, v28
    s_nop 1
    v_permlane32_swap_b32 v224, v225
    s_nop 1
    v_add_f32 v28, v224, v225
    v_mov_b32 v226, v29
    v_mov_b32 v227, v29
    s_nop 1
    v_permlane32_swap_b32 v226, v227
    v_mfma_f32_32x32x16_bf16 v[160:175], v[36:39], v[84:87], v[160:175]
    ds_read_b128 v[100:103], v21 offset:32768
    s_nop 1
    v_add_f32 v29, v226, v227
    v_mov_b32 v228, v30
    v_mov_b32 v229, v30
    s_nop 1
    v_permlane32_swap_b32 v228, v229
    s_nop 1
    v_add_f32 v30, v228, v229
    v_mul_f32 v28, 0x3ae38e39, v28
    v_mul_f32 v29, 0x3ae38e39, v29
    v_fma_f32 v29, -v28, v28, v29
    v_max_f32 v29, 0, v29
    v_mov_b32 v224, v28
    v_cvt_pk_bf16_f32 v224, v224, v224
    v_mfma_f32_32x32x16_bf16 v[160:175], v[40:43], v[88:91], v[160:175]
    ds_read_b128 v[104:107], v22 offset:32768
    v_lshlrev_b32 v224, 16, v224
    v_mov_b32 v225, v29
    v_cvt_pk_bf16_f32 v225, v225, v225
    v_lshlrev_b32 v225, 16, v225
    v_add_f32 v225, 0x3727c5ac, v225
    v_cvt_pk_bf16_f32 v225, v225, v225
    v_lshlrev_b32 v225, 16, v225
    v_sqrt_f32 v225, v225
    s_nop 0
    v_cvt_pk_bf16_f32 v225, v225, v225
    v_lshlrev_b32 v225, 16, v225
    v_rcp_f32 v240, v225
    v_mfma_f32_32x32x16_bf16 v[160:175], v[44:47], v[92:95], v[160:175]
    ds_read_b128 v[108:111], v23 offset:32768
    s_nop 0
    v_mul_f32 v241, v224, v240
    v_sub_f32 v241, 0, v241
    s_lshl_b32 s42, s26, 7
    s_add_u32 s42, s42, 24576
    v_lshlrev_b32 v228, 2, v3
    v_add_u32 v228, s42, v228
    ds_write_b32 v228, v30
    s_lshl_b32 s42, s26, 8
    s_add_u32 s42, s42, 26624
    v_lshlrev_b32 v229, 3, v3
    v_add_u32 v229, s42, v229
    ds_write_b64 v229, v[240:241]
    v_lshlrev_b32 v229, 5, v4
    s_waitcnt lgkmcnt(0)
    v_subrev_u32 v20, 0xc000, v20
    v_subrev_u32 v21, 0xc000, v21
    v_subrev_u32 v22, 0xc000, v22
    v_subrev_u32 v23, 0xc000, v23
    v_mfma_f32_32x32x16_bf16 v[160:175], v[48:51], v[96:99], v[160:175]
    ds_read_b128 v[80:83], v20 offset:8192
    v_add_u32 v229, s42, v229
    v_lshlrev_b32 v26, 2, v3
    v_add_u32 v26, 24576, v26
    s_waitcnt lgkmcnt(0)
    s_barrier
    v_mov_b32 v27, v229
    ds_read_b128 v[224:227], v27 offset:0
    ds_read_b128 v[228:231], v27 offset:16
    ds_read_b128 v[232:235], v27 offset:64
    ds_read_b128 v[236:239], v27 offset:80
    ds_read_b128 v[240:243], v27 offset:128
    ds_read_b128 v[244:247], v27 offset:144
    ds_read_b128 v[248:251], v27 offset:192
    ds_read_b128 v[252:255], v27 offset:208
    v_mfma_f32_32x32x16_bf16 v[160:175], v[52:55], v[100:103], v[160:175]
    ds_read_b128 v[84:87], v21 offset:8192
    s_waitcnt lgkmcnt(0)
    v_mfma_f32_32x32x16_bf16 v[160:175], v[56:59], v[104:107], v[160:175]
    ds_read_b128 v[88:91], v22 offset:8192
    v_mfma_f32_32x32x16_bf16 v[160:175], v[60:63], v[108:111], v[160:175]
    ds_read_b128 v[92:95], v23 offset:8192
    s_waitcnt lgkmcnt(0)
    v_add_u32 v20, 0xc000, v20
    v_add_u32 v21, 0xc000, v21
    v_add_u32 v22, 0xc000, v22
    v_add_u32 v23, 0xc000, v23
    v_mfma_f32_32x32x16_bf16 v[160:175], v[64:67], v[80:83], v[160:175]
    ds_read_b128 v[96:99], v20 offset:12288
    ds_read_b32 v112, v26 offset:0
    s_waitcnt lgkmcnt(0)
    v_mul_f32 v113, v225, v112
    v_fma_f32 v128, v128, v224, v113
    v_mul_f32 v113, v227, v112
    v_fma_f32 v129, v129, v226, v113
    v_mul_f32 v113, v229, v112
    v_fma_f32 v130, v130, v228, v113
    v_mul_f32 v113, v231, v112
    v_fma_f32 v131, v131, v230, v113
    v_mul_f32 v113, v233, v112
    v_fma_f32 v132, v132, v232, v113
    v_mul_f32 v113, v235, v112
    v_fma_f32 v133, v133, v234, v113
    v_mfma_f32_32x32x16_bf16 v[160:175], v[68:71], v[84:87], v[160:175]
    ds_read_b128 v[100:103], v21 offset:12288
    v_mul_f32 v113, v237, v112
    v_fma_f32 v134, v134, v236, v113
    v_mul_f32 v113, v239, v112
    v_fma_f32 v135, v135, v238, v113
    v_cvt_pk_bf16_f32 v128, v128, v129
    v_cvt_pk_bf16_f32 v129, v130, v131
    v_cvt_pk_bf16_f32 v130, v132, v133
    v_cvt_pk_bf16_f32 v131, v134, v135
    s_nop 1
    v_permlane32_swap_b32 v128, v130
    v_permlane32_swap_b32 v129, v131
    s_mov_b32 s47, 0x0
    buffer_store_dwordx4 v[128:131], v24, s[16:19], s47 offen offset:0
    v_mul_f32 v113, v241, v112
    v_mfma_f32_32x32x16_bf16 v[160:175], v[72:75], v[88:91], v[160:175]
    ds_read_b128 v[104:107], v22 offset:12288
    v_fma_f32 v136, v136, v240, v113
    v_mul_f32 v113, v243, v112
    v_fma_f32 v137, v137, v242, v113
    v_mul_f32 v113, v245, v112
    v_fma_f32 v138, v138, v244, v113
    v_mul_f32 v113, v247, v112
    v_fma_f32 v139, v139, v246, v113
    v_mul_f32 v113, v249, v112
    v_fma_f32 v140, v140, v248, v113
    v_mul_f32 v113, v251, v112
    v_fma_f32 v141, v141, v250, v113
    v_mul_f32 v113, v253, v112
    v_fma_f32 v142, v142, v252, v113
    v_mul_f32 v113, v255, v112
    v_mfma_f32_32x32x16_bf16 v[160:175], v[76:79], v[92:95], v[160:175]
    ds_read_b128 v[108:111], v23 offset:12288
    v_fma_f32 v143, v143, v254, v113
    v_cvt_pk_bf16_f32 v136, v136, v137
    v_cvt_pk_bf16_f32 v137, v138, v139
    v_cvt_pk_bf16_f32 v138, v140, v141
    v_cvt_pk_bf16_f32 v139, v142, v143
    s_nop 1
    v_permlane32_swap_b32 v136, v138
    v_permlane32_swap_b32 v137, v139
    s_mov_b32 s47, 0x0
    buffer_store_dwordx4 v[136:139], v24, s[16:19], s47 offen offset:32
    ds_read_b32 v112, v26 offset:128
    s_waitcnt lgkmcnt(0)
    v_mul_f32 v113, v225, v112
    v_fma_f32 v144, v144, v224, v113
    s_waitcnt lgkmcnt(0)
    v_mfma_f32_32x32x16_bf16 v[176:191], v[32:35], v[96:99], v[176:191]
    ds_read_b128 v[80:83], v20 offset:36864
    v_mul_f32 v113, v227, v112
    v_fma_f32 v145, v145, v226, v113
    v_mul_f32 v113, v229, v112
    v_fma_f32 v146, v146, v228, v113
    v_mul_f32 v113, v231, v112
    v_fma_f32 v147, v147, v230, v113
    v_mul_f32 v113, v233, v112
    v_fma_f32 v148, v148, v232, v113
    v_mul_f32 v113, v235, v112
    v_fma_f32 v149, v149, v234, v113
    v_mul_f32 v113, v237, v112
    v_fma_f32 v150, v150, v236, v113
    v_mul_f32 v113, v239, v112
    v_fma_f32 v151, v151, v238, v113
    v_mfma_f32_32x32x16_bf16 v[176:191], v[36:39], v[100:103], v[176:191]
    ds_read_b128 v[84:87], v21 offset:36864
    v_cvt_pk_bf16_f32 v144, v144, v145
    v_cvt_pk_bf16_f32 v145, v146, v147
    v_cvt_pk_bf16_f32 v146, v148, v149
    v_cvt_pk_bf16_f32 v147, v150, v151
    s_nop 1
    v_permlane32_swap_b32 v144, v146
    v_permlane32_swap_b32 v145, v147
    s_mov_b32 s47, 0x20000
    buffer_store_dwordx4 v[144:147], v24, s[16:19], s47 offen offset:0
    v_mul_f32 v113, v241, v112
    v_fma_f32 v152, v152, v240, v113
    v_mul_f32 v113, v243, v112
    v_fma_f32 v153, v153, v242, v113
    v_mul_f32 v113, v245, v112
    v_mfma_f32_32x32x16_bf16 v[176:191], v[40:43], v[104:107], v[176:191]
    ds_read_b128 v[88:91], v22 offset:36864
    v_fma_f32 v154, v154, v244, v113
    v_mul_f32 v113, v247, v112
    v_fma_f32 v155, v155, v246, v113
    v_mul_f32 v113, v249, v112
    v_fma_f32 v156, v156, v248, v113
    v_mul_f32 v113, v251, v112
    v_fma_f32 v157, v157, v250, v113
    v_mul_f32 v113, v253, v112
    v_fma_f32 v158, v158, v252, v113
    v_mul_f32 v113, v255, v112
    v_fma_f32 v159, v159, v254, v113
    v_cvt_pk_bf16_f32 v152, v152, v153
    v_cvt_pk_bf16_f32 v153, v154, v155
    v_cvt_pk_bf16_f32 v154, v156, v157
    v_mfma_f32_32x32x16_bf16 v[176:191], v[44:47], v[108:111], v[176:191]
    ds_read_b128 v[92:95], v23 offset:36864
    v_cvt_pk_bf16_f32 v155, v158, v159
    s_nop 1
    v_permlane32_swap_b32 v152, v154
    v_permlane32_swap_b32 v153, v155
    s_mov_b32 s47, 0x20000
    buffer_store_dwordx4 v[152:155], v24, s[16:19], s47 offen offset:32
    s_waitcnt lgkmcnt(0)
    v_subrev_u32 v20, 0xc000, v20
    v_subrev_u32 v21, 0xc000, v21
    v_subrev_u32 v22, 0xc000, v22
    v_subrev_u32 v23, 0xc000, v23
    v_mfma_f32_32x32x16_bf16 v[176:191], v[48:51], v[80:83], v[176:191]
    ds_read_b128 v[96:99], v20 offset:12288
    v_mfma_f32_32x32x16_bf16 v[176:191], v[52:55], v[84:87], v[176:191]
    ds_read_b128 v[100:103], v21 offset:12288
    v_mfma_f32_32x32x16_bf16 v[176:191], v[56:59], v[88:91], v[176:191]
    ds_read_b128 v[104:107], v22 offset:12288
    v_mfma_f32_32x32x16_bf16 v[176:191], v[60:63], v[92:95], v[176:191]
    ds_read_b128 v[108:111], v23 offset:12288
    s_waitcnt lgkmcnt(0)
    v_add_u32 v20, 0xc000, v20
    v_add_u32 v21, 0xc000, v21
    v_add_u32 v22, 0xc000, v22
    v_add_u32 v23, 0xc000, v23
    v_mfma_f32_32x32x16_bf16 v[176:191], v[64:67], v[96:99], v[176:191]
    ds_read_b128 v[80:83], v20 offset:16384
    ds_read_b32 v112, v26 offset:256
    s_waitcnt lgkmcnt(0)
    v_mul_f32 v113, v225, v112
    v_fma_f32 v160, v160, v224, v113
    v_mul_f32 v113, v227, v112
    v_fma_f32 v161, v161, v226, v113
    v_mul_f32 v113, v229, v112
    v_fma_f32 v162, v162, v228, v113
    v_mul_f32 v113, v231, v112
    v_fma_f32 v163, v163, v230, v113
    v_mul_f32 v113, v233, v112
    v_fma_f32 v164, v164, v232, v113
    v_mul_f32 v113, v235, v112
    v_fma_f32 v165, v165, v234, v113
    v_mfma_f32_32x32x16_bf16 v[176:191], v[68:71], v[100:103], v[176:191]
    ds_read_b128 v[84:87], v21 offset:16384
    v_mul_f32 v113, v237, v112
    v_fma_f32 v166, v166, v236, v113
    v_mul_f32 v113, v239, v112
    v_fma_f32 v167, v167, v238, v113
    v_cvt_pk_bf16_f32 v160, v160, v161
    v_cvt_pk_bf16_f32 v161, v162, v163
    v_cvt_pk_bf16_f32 v162, v164, v165
    v_cvt_pk_bf16_f32 v163, v166, v167
    s_nop 1
    v_permlane32_swap_b32 v160, v162
    v_permlane32_swap_b32 v161, v163
    s_mov_b32 s47, 0x40000
    buffer_store_dwordx4 v[160:163], v24, s[16:19], s47 offen offset:0
    v_mul_f32 v113, v241, v112
    v_mfma_f32_32x32x16_bf16 v[176:191], v[72:75], v[104:107], v[176:191]
    ds_read_b128 v[88:91], v22 offset:16384
    v_fma_f32 v168, v168, v240, v113
    v_mul_f32 v113, v243, v112
    v_fma_f32 v169, v169, v242, v113
    v_mul_f32 v113, v245, v112
    v_fma_f32 v170, v170, v244, v113
    v_mul_f32 v113, v247, v112
    v_fma_f32 v171, v171, v246, v113
    v_mul_f32 v113, v249, v112
    v_fma_f32 v172, v172, v248, v113
    v_mul_f32 v113, v251, v112
    v_fma_f32 v173, v173, v250, v113
    v_mul_f32 v113, v253, v112
    v_fma_f32 v174, v174, v252, v113
    v_mul_f32 v113, v255, v112
    v_mfma_f32_32x32x16_bf16 v[176:191], v[76:79], v[108:111], v[176:191]
    ds_read_b128 v[92:95], v23 offset:16384
    v_fma_f32 v175, v175, v254, v113
    v_cvt_pk_bf16_f32 v168, v168, v169
    v_cvt_pk_bf16_f32 v169, v170, v171
    v_cvt_pk_bf16_f32 v170, v172, v173
    v_cvt_pk_bf16_f32 v171, v174, v175
    s_nop 1
    v_permlane32_swap_b32 v168, v170
    v_permlane32_swap_b32 v169, v171
    s_mov_b32 s47, 0x40000
    buffer_store_dwordx4 v[168:171], v24, s[16:19], s47 offen offset:32
    s_waitcnt lgkmcnt(0)
    v_mfma_f32_32x32x16_bf16 v[192:207], v[32:35], v[80:83], v[192:207]
    ds_read_b128 v[96:99], v20 offset:40960
    v_mfma_f32_32x32x16_bf16 v[192:207], v[36:39], v[84:87], v[192:207]
    ds_read_b128 v[100:103], v21 offset:40960
    v_mfma_f32_32x32x16_bf16 v[192:207], v[40:43], v[88:91], v[192:207]
    ds_read_b128 v[104:107], v22 offset:40960
    v_mfma_f32_32x32x16_bf16 v[192:207], v[44:47], v[92:95], v[192:207]
    ds_read_b128 v[108:111], v23 offset:40960
    s_waitcnt lgkmcnt(0)
    v_subrev_u32 v20, 0xc000, v20
    v_subrev_u32 v21, 0xc000, v21
    v_subrev_u32 v22, 0xc000, v22
    v_subrev_u32 v23, 0xc000, v23
    v_mfma_f32_32x32x16_bf16 v[192:207], v[48:51], v[96:99], v[192:207]
    ds_read_b128 v[80:83], v20 offset:16384
    v_mfma_f32_32x32x16_bf16 v[192:207], v[52:55], v[100:103], v[192:207]
    ds_read_b128 v[84:87], v21 offset:16384
    v_mfma_f32_32x32x16_bf16 v[192:207], v[56:59], v[104:107], v[192:207]
    ds_read_b128 v[88:91], v22 offset:16384
    v_mfma_f32_32x32x16_bf16 v[192:207], v[60:63], v[108:111], v[192:207]
    ds_read_b128 v[92:95], v23 offset:16384
    s_waitcnt lgkmcnt(0)
    v_add_u32 v20, 0xc000, v20
    v_add_u32 v21, 0xc000, v21
    v_add_u32 v22, 0xc000, v22
    v_add_u32 v23, 0xc000, v23
    v_mfma_f32_32x32x16_bf16 v[192:207], v[64:67], v[80:83], v[192:207]
    ds_read_b128 v[96:99], v20 offset:20480
    ds_read_b32 v112, v26 offset:384
    s_waitcnt lgkmcnt(0)
    v_mul_f32 v113, v225, v112
    v_fma_f32 v176, v176, v224, v113
    v_mul_f32 v113, v227, v112
    v_fma_f32 v177, v177, v226, v113
    v_mul_f32 v113, v229, v112
    v_fma_f32 v178, v178, v228, v113
    v_mul_f32 v113, v231, v112
    v_fma_f32 v179, v179, v230, v113
    v_mul_f32 v113, v233, v112
    v_fma_f32 v180, v180, v232, v113
    v_mul_f32 v113, v235, v112
    v_fma_f32 v181, v181, v234, v113
    v_mfma_f32_32x32x16_bf16 v[192:207], v[68:71], v[84:87], v[192:207]
    ds_read_b128 v[100:103], v21 offset:20480
    v_mul_f32 v113, v237, v112
    v_fma_f32 v182, v182, v236, v113
    v_mul_f32 v113, v239, v112
    v_fma_f32 v183, v183, v238, v113
    v_cvt_pk_bf16_f32 v176, v176, v177
    v_cvt_pk_bf16_f32 v177, v178, v179
    v_cvt_pk_bf16_f32 v178, v180, v181
    v_cvt_pk_bf16_f32 v179, v182, v183
    s_nop 1
    v_permlane32_swap_b32 v176, v178
    v_permlane32_swap_b32 v177, v179
    s_mov_b32 s47, 0x60000
    buffer_store_dwordx4 v[176:179], v24, s[16:19], s47 offen offset:0
    v_mul_f32 v113, v241, v112
    v_mfma_f32_32x32x16_bf16 v[192:207], v[72:75], v[88:91], v[192:207]
    ds_read_b128 v[104:107], v22 offset:20480
    v_fma_f32 v184, v184, v240, v113
    v_mul_f32 v113, v243, v112
    v_fma_f32 v185, v185, v242, v113
    v_mul_f32 v113, v245, v112
    v_fma_f32 v186, v186, v244, v113
    v_mul_f32 v113, v247, v112
    v_fma_f32 v187, v187, v246, v113
    v_mul_f32 v113, v249, v112
    v_fma_f32 v188, v188, v248, v113
    v_mul_f32 v113, v251, v112
    v_fma_f32 v189, v189, v250, v113
    v_mul_f32 v113, v253, v112
    v_fma_f32 v190, v190, v252, v113
    v_mul_f32 v113, v255, v112
    v_mfma_f32_32x32x16_bf16 v[192:207], v[76:79], v[92:95], v[192:207]
    ds_read_b128 v[108:111], v23 offset:20480
    v_fma_f32 v191, v191, v254, v113
    v_cvt_pk_bf16_f32 v184, v184, v185
    v_cvt_pk_bf16_f32 v185, v186, v187
    v_cvt_pk_bf16_f32 v186, v188, v189
    v_cvt_pk_bf16_f32 v187, v190, v191
    s_nop 1
    v_permlane32_swap_b32 v184, v186
    v_permlane32_swap_b32 v185, v187
    s_mov_b32 s47, 0x60000
    buffer_store_dwordx4 v[184:187], v24, s[16:19], s47 offen offset:32
    s_waitcnt lgkmcnt(0)
    v_mfma_f32_32x32x16_bf16 v[208:223], v[32:35], v[96:99], v[208:223]
    ds_read_b128 v[80:83], v20 offset:45056
    v_mfma_f32_32x32x16_bf16 v[208:223], v[36:39], v[100:103], v[208:223]
    ds_read_b128 v[84:87], v21 offset:45056
    v_mfma_f32_32x32x16_bf16 v[208:223], v[40:43], v[104:107], v[208:223]
    ds_read_b128 v[88:91], v22 offset:45056
    v_mfma_f32_32x32x16_bf16 v[208:223], v[44:47], v[108:111], v[208:223]
    ds_read_b128 v[92:95], v23 offset:45056
    s_waitcnt lgkmcnt(0)
    v_subrev_u32 v20, 0xc000, v20
    v_subrev_u32 v21, 0xc000, v21
    v_subrev_u32 v22, 0xc000, v22
    v_subrev_u32 v23, 0xc000, v23
    v_mfma_f32_32x32x16_bf16 v[208:223], v[48:51], v[80:83], v[208:223]
    ds_read_b128 v[96:99], v20 offset:20480
    v_mfma_f32_32x32x16_bf16 v[208:223], v[52:55], v[84:87], v[208:223]
    ds_read_b128 v[100:103], v21 offset:20480
    v_mfma_f32_32x32x16_bf16 v[208:223], v[56:59], v[88:91], v[208:223]
    ds_read_b128 v[104:107], v22 offset:20480
    v_mfma_f32_32x32x16_bf16 v[208:223], v[60:63], v[92:95], v[208:223]
    ds_read_b128 v[108:111], v23 offset:20480
    s_waitcnt lgkmcnt(0)
    v_mfma_f32_32x32x16_bf16 v[208:223], v[64:67], v[96:99], v[208:223]
    ds_read_b32 v112, v26 offset:512
    s_waitcnt lgkmcnt(0)
    v_mul_f32 v113, v225, v112
    v_fma_f32 v192, v192, v224, v113
    v_mul_f32 v113, v227, v112
    v_fma_f32 v193, v193, v226, v113
    v_mul_f32 v113, v229, v112
    v_fma_f32 v194, v194, v228, v113
    v_mul_f32 v113, v231, v112
    v_fma_f32 v195, v195, v230, v113
    v_mul_f32 v113, v233, v112
    v_fma_f32 v196, v196, v232, v113
    v_mul_f32 v113, v235, v112
    v_fma_f32 v197, v197, v234, v113
    v_mfma_f32_32x32x16_bf16 v[208:223], v[68:71], v[100:103], v[208:223]
    v_mul_f32 v113, v237, v112
    v_fma_f32 v198, v198, v236, v113
    v_mul_f32 v113, v239, v112
    v_fma_f32 v199, v199, v238, v113
    v_cvt_pk_bf16_f32 v192, v192, v193
    v_cvt_pk_bf16_f32 v193, v194, v195
    v_cvt_pk_bf16_f32 v194, v196, v197
    v_cvt_pk_bf16_f32 v195, v198, v199
    s_nop 1
    v_permlane32_swap_b32 v192, v194
    v_permlane32_swap_b32 v193, v195
    s_mov_b32 s47, 0x80000
    buffer_store_dwordx4 v[192:195], v24, s[16:19], s47 offen offset:0
    v_mul_f32 v113, v241, v112
    v_mfma_f32_32x32x16_bf16 v[208:223], v[72:75], v[104:107], v[208:223]
    v_fma_f32 v200, v200, v240, v113
    v_mul_f32 v113, v243, v112
    v_fma_f32 v201, v201, v242, v113
    v_mul_f32 v113, v245, v112
    v_fma_f32 v202, v202, v244, v113
    v_mul_f32 v113, v247, v112
    v_fma_f32 v203, v203, v246, v113
    v_mul_f32 v113, v249, v112
    v_fma_f32 v204, v204, v248, v113
    v_mul_f32 v113, v251, v112
    v_fma_f32 v205, v205, v250, v113
    v_mul_f32 v113, v253, v112
    v_fma_f32 v206, v206, v252, v113
    v_mul_f32 v113, v255, v112
    v_mfma_f32_32x32x16_bf16 v[208:223], v[76:79], v[108:111], v[208:223]
    v_fma_f32 v207, v207, v254, v113
    v_cvt_pk_bf16_f32 v200, v200, v201
    v_cvt_pk_bf16_f32 v201, v202, v203
    v_cvt_pk_bf16_f32 v202, v204, v205
    v_cvt_pk_bf16_f32 v203, v206, v207
    s_nop 1
    v_permlane32_swap_b32 v200, v202
    v_permlane32_swap_b32 v201, v203
    s_mov_b32 s47, 0x80000
    buffer_store_dwordx4 v[200:203], v24, s[16:19], s47 offen offset:32
    s_nop 7
    s_nop 7
    ds_read_b32 v112, v26 offset:640
    s_waitcnt lgkmcnt(0)
    v_mul_f32 v113, v225, v112
    v_fma_f32 v208, v208, v224, v113
    v_mul_f32 v113, v227, v112
    v_fma_f32 v209, v209, v226, v113
    v_mul_f32 v113, v229, v112
    v_fma_f32 v210, v210, v228, v113
    v_mul_f32 v113, v231, v112
    v_fma_f32 v211, v211, v230, v113
    v_mul_f32 v113, v233, v112
    v_fma_f32 v212, v212, v232, v113
    v_mul_f32 v113, v235, v112
    v_fma_f32 v213, v213, v234, v113
    v_mul_f32 v113, v237, v112
    v_fma_f32 v214, v214, v236, v113
    v_mul_f32 v113, v239, v112
    v_fma_f32 v215, v215, v238, v113
    v_cvt_pk_bf16_f32 v208, v208, v209
    v_cvt_pk_bf16_f32 v209, v210, v211
    v_cvt_pk_bf16_f32 v210, v212, v213
    v_cvt_pk_bf16_f32 v211, v214, v215
    s_nop 1
    v_permlane32_swap_b32 v208, v210
    v_permlane32_swap_b32 v209, v211
    s_mov_b32 s47, 0xa0000
    buffer_store_dwordx4 v[208:211], v24, s[16:19], s47 offen offset:0
    v_mul_f32 v113, v241, v112
    v_fma_f32 v216, v216, v240, v113
    v_mul_f32 v113, v243, v112
    v_fma_f32 v217, v217, v242, v113
    v_mul_f32 v113, v245, v112
    v_fma_f32 v218, v218, v244, v113
    v_mul_f32 v113, v247, v112
    v_fma_f32 v219, v219, v246, v113
    v_mul_f32 v113, v249, v112
    v_fma_f32 v220, v220, v248, v113
    v_mul_f32 v113, v251, v112
    v_fma_f32 v221, v221, v250, v113
    v_mul_f32 v113, v253, v112
    v_fma_f32 v222, v222, v252, v113
    v_mul_f32 v113, v255, v112
    v_fma_f32 v223, v223, v254, v113
    v_cvt_pk_bf16_f32 v216, v216, v217
    v_cvt_pk_bf16_f32 v217, v218, v219
    v_cvt_pk_bf16_f32 v218, v220, v221
    v_cvt_pk_bf16_f32 v219, v222, v223
    s_nop 1
    v_permlane32_swap_b32 v216, v218
    v_permlane32_swap_b32 v217, v219
    s_mov_b32 s47, 0xa0000
    buffer_store_dwordx4 v[216:219], v24, s[16:19], s47 offen offset:32
    s_endpgm
KA_G3:
    s_mov_b32 s12, s32
    s_mov_b32 s13, s33
    s_mov_b32 s14, 0x510000
    s_mov_b32 s15, 0x00020000
    s_add_u32 s16, s6, 0x1000000
    s_addc_u32 s17, s7, 0
    s_mov_b32 s18, 0x1200000
    s_mov_b32 s19, 0x00020000
    s_mov_b32 s20, s34
    s_mov_b32 s21, s35
    s_mov_b32 s22, 0x2400
    s_mov_b32 s23, 0x00020000
    s_sub_u32 s41, s24, 6
    s_mul_i32 s40, s41, 384
    s_mul_i32 s42, s26, 192
    v_add_u32 v9, s42, v2
    v_mul_u32_u24 v17, 2731, v9
    v_lshrrev_b32 v17, 16, v17
    v_mul_u32_u24 v18, 24, v17
    v_sub_u32 v18, v9, v18
    v_bfe_u32 v9, v17, 1, 1
    v_lshlrev_b32 v9, 2, v9
    v_xor_b32 v18, v18, v9
    v_mul_u32_u24 v17, 9216, v17
    v_lshl_add_u32 v10, v18, 4, v17
    v_add_u32 v9, s42, v2
    v_add_u32 v9, 64, v9
    v_mul_u32_u24 v17, 2731, v9
    v_lshrrev_b32 v17, 16, v17
    v_mul_u32_u24 v18, 24, v17
    v_sub_u32 v18, v9, v18
    v_bfe_u32 v9, v17, 1, 1
    v_lshlrev_b32 v9, 2, v9
    v_xor_b32 v18, v18, v9
    v_mul_u32_u24 v17, 9216, v17
    v_lshl_add_u32 v11, v18, 4, v17
    v_add_u32 v9, s42, v2
    v_add_u32 v9, 128, v9
    v_mul_u32_u24 v17, 2731, v9
    v_lshrrev_b32 v17, 16, v17
    v_mul_u32_u24 v18, 24, v17
    v_sub_u32 v18, v9, v18
    v_bfe_u32 v9, v17, 1, 1
    v_lshlrev_b32 v9, 2, v9
    v_xor_b32 v18, v18, v9
    v_mul_u32_u24 v17, 9216, v17
    v_lshl_add_u32 v12, v18, 4, v17
    s_mov_b32 s48, 0
    s_add_u32 m0, s49, 0x0
    s_nop 0
    buffer_load_dwordx4 v5, s[8:11], s48 offen lds
    s_add_u32 m0, s49, 0x400
    s_nop 0
    buffer_load_dwordx4 v6, s[8:11], s48 offen lds
    s_add_u32 m0, s49, 0x800
    s_nop 0
    buffer_load_dwordx4 v7, s[8:11], s48 offen lds
    s_add_u32 m0, s49, 0xc00
    s_nop 0
    buffer_load_dwordx4 v8, s[8:11], s48 offen lds
    s_add_u32 s46, s40, 0x0
    s_add_u32 m0, s37, 0x0
    s_nop 0
    buffer_load_dwordx4 v10, s[12:15], s46 offen lds
    s_add_u32 m0, s37, 0x400
    s_nop 0
    buffer_load_dwordx4 v11, s[12:15], s46 offen lds
    s_add_u32 m0, s37, 0x800
    s_nop 0
    buffer_load_dwordx4 v12, s[12:15], s46 offen lds
    s_mov_b32 s48, 128
    s_add_u32 m0, s49, 0x1000
    s_nop 0
    buffer_load_dwordx4 v5, s[8:11], s48 offen lds
    s_add_u32 m0, s49, 0x1400
    s_nop 0
    buffer_load_dwordx4 v6, s[8:11], s48 offen lds
    s_add_u32 m0, s49, 0x1800
    s_nop 0
    buffer_load_dwordx4 v7, s[8:11], s48 offen lds
    s_add_u32 m0, s49, 0x1c00
    s_nop 0
    buffer_load_dwordx4 v8, s[8:11], s48 offen lds
    s_add_u32 s46, s40, 0x90000
    s_add_u32 m0, s37, 0x6000
    s_nop 0
    buffer_load_dwordx4 v10, s[12:15], s46 offen lds
    s_add_u32 m0, s37, 0x6400
    s_nop 0
    buffer_load_dwordx4 v11, s[12:15], s46 offen lds
    s_add_u32 m0, s37, 0x6800
    s_nop 0
    buffer_load_dwordx4 v12, s[12:15], s46 offen lds
    v_lshrrev_b32 v9, 5, v2
    v_lshlrev_b32 v9, 3, v9
    v_bfe_u32 v17, v2, 2, 2
    v_add_u32 v9, v9, v17
    v_mul_u32_u24 v9, 384, v9
    v_bfe_u32 v18, v2, 4, 1
    v_lshlrev_b32 v18, 5, v18
    v_and_b32 v22, 3, v2
    v_lshl_add_u32 v18, v22, 3, v18
    v_lshrrev_b32 v17, 1, v17
    v_lshlrev_b32 v17, 6, v17
    v_xor_b32 v18, v18, v17
    v_add_u32 v20, v9, v18
    v_xor_b32 v18, 64, v18
    v_add_u32 v21, v9, v18
    s_and_b32 s42, s26, 1
    s_lshl_b32 s42, s42, 6
    v_xor_b32 v18, 64, v18
    v_xor_b32 v18, s42, v18
    v_add_u32 v252, v9, v18
    s_lshr_b32 s42, s26, 1
    s_lshl_b32 s42, s42, 7
    v_add_u32 v252, s42, v252
    v_add_u32 v24, s27, v3
    v_mul_u32_u24 v24, 9216, v24
    v_lshl_add_u32 v24, v4, 4, v24
    v_add_u32 v24, s40, v24
    s_lshl_b32 s42, s26, 6
    s_add_u32 s42, s42, s40
    v_lshlrev_b32 v26, 1, v3
    v_add_u32 v26, s42, v26
    s_mov_b32 s44, 0xbdd2d3e8
    v_mov_b32 v27, 0xc0135761
    s_waitcnt vmcnt(10)
    ds_read_b128 v[32:35], v13 offset:0
    ds_read_b128 v[36:39], v14 offset:0
    ds_read_b128 v[40:43], v15 offset:0
    ds_read_b128 v[44:47], v16 offset:0
    s_waitcnt vmcnt(7) lgkmcnt(0)
    s_barrier
    ds_read_b64_tr_b16 v[80:81], v20 offset:0
    ds_read_b64_tr_b16 v[82:83], v20 offset:1536
    ds_read_b64_tr_b16 v[84:85], v21 offset:0
    ds_read_b64_tr_b16 v[86:87], v21 offset:1536
    ds_read_b64_tr_b16 v[88:89], v20 offset:128
    ds_read_b64_tr_b16 v[90:91], v20 offset:1664
    ds_read_b64_tr_b16 v[92:93], v21 offset:128
    ds_read_b64_tr_b16 v[94:95], v21 offset:1664
    ds_read_b64_tr_b16 v[96:97], v20 offset:256
    ds_read_b64_tr_b16 v[98:99], v20 offset:1792
    ds_read_b64_tr_b16 v[100:101], v21 offset:256
    ds_read_b64_tr_b16 v[102:103], v21 offset:1792
    ds_read_b64_tr_b16 v[244:245], v252 offset:0
    ds_read_b64_tr_b16 v[246:247], v252 offset:1536
    s_waitcnt lgkmcnt(0)
    s_mov_b32 s48, 256
    s_add_u32 m0, s49, 0x0
    s_nop 0
    buffer_load_dwordx4 v5, s[8:11], s48 offen lds
    s_add_u32 m0, s49, 0x400
    s_nop 0
    buffer_load_dwordx4 v6, s[8:11], s48 offen lds
    s_add_u32 m0, s49, 0x800
    s_nop 0
    buffer_load_dwordx4 v7, s[8:11], s48 offen lds
    s_add_u32 m0, s49, 0xc00
    s_nop 0
    buffer_load_dwordx4 v8, s[8:11], s48 offen lds
    s_add_u32 s46, s40, 0x120000
    s_add_u32 m0, s37, 0xc000
    s_nop 0
    buffer_load_dwordx4 v10, s[12:15], s46 offen lds
    s_add_u32 m0, s37, 0xc400
    s_nop 0
    buffer_load_dwordx4 v11, s[12:15], s46 offen lds
    s_add_u32 m0, s37, 0xc800
    s_nop 0
    buffer_load_dwordx4 v12, s[12:15], s46 offen lds
    s_add_u32 s46, s40, 0x1b0000
    s_add_u32 m0, s37, 0x12000
    s_nop 0
    buffer_load_dwordx4 v10, s[12:15], s46 offen lds
    s_add_u32 m0, s37, 0x12400
    s_nop 0
    buffer_load_dwordx4 v11, s[12:15], s46 offen lds
    s_add_u32 m0, s37, 0x12800
    s_nop 0
    buffer_load_dwordx4 v12, s[12:15], s46 offen lds
    s_waitcnt vmcnt(13)
    v_mfma_f32_32x32x16_bf16 v[128:143], v[80:83], v[32:35], 0
    ds_read_b128 v[48:51], v13 offset:4096
    ds_read_b128 v[52:55], v14 offset:4096
    ds_read_b128 v[56:59], v15 offset:4096
    v_dot2c_f32_bf16 v238, v32, v25
    v_dot2c_f32_bf16 v29, v32, v32
    v_dot2c_f32_bf16 v239, v33, v25
    v_dot2c_f32_bf16 v28, v33, v33
    v_dot2c_f32_bf16 v238, v34, v25
    v_dot2c_f32_bf16 v29, v34, v34
    v_mfma_f32_32x32x16_bf16 v[144:159], v[84:87], v[32:35], 0
    ds_read_b128 v[60:63], v16 offset:4096
    ds_read_b64_tr_b16 v[104:105], v20 offset:6144
    ds_read_b64_tr_b16 v[106:107], v20 offset:7680
    v_dot2c_f32_bf16 v239, v35, v25
    v_dot2c_f32_bf16 v28, v35, v35
    v_dot2c_f32_bf16 v30, v244, v25
    v_dot2c_f32_bf16 v31, v245, v25
    v_dot2c_f32_bf16 v30, v246, v25
    v_dot2c_f32_bf16 v31, v247, v25
    v_mfma_f32_32x32x16_bf16 v[160:175], v[88:91], v[32:35], 0
    ds_read_b64_tr_b16 v[108:109], v21 offset:6144
    ds_read_b64_tr_b16 v[110:111], v21 offset:7680
    ds_read_b64_tr_b16 v[112:113], v20 offset:6272
    v_mfma_f32_32x32x16_bf16 v[176:191], v[92:95], v[32:35], 0
    ds_read_b64_tr_b16 v[114:115], v20 offset:7808
    ds_read_b64_tr_b16 v[116:117], v21 offset:6272
    ds_read_b64_tr_b16 v[118:119], v21 offset:7808
    v_mfma_f32_32x32x16_bf16 v[192:207], v[96:99], v[32:35], 0
    ds_read_b64_tr_b16 v[120:121], v20 offset:6400
    ds_read_b64_tr_b16 v[122:123], v20 offset:7936
    ds_read_b64_tr_b16 v[124:125], v21 offset:6400
    v_mfma_f32_32x32x16_bf16 v[208:223], v[100:103], v[32:35], 0
    ds_read_b64_tr_b16 v[126:127], v21 offset:7936
    ds_read_b64_tr_b16 v[248:249], v252 offset:6144
    ds_read_b64_tr_b16 v[250:251], v252 offset:7680
    s_waitcnt lgkmcnt(0)
    v_mfma_f32_32x32x16_bf16 v[128:143], v[104:107], v[36:39], v[128:143]
    ds_read_b64_tr_b16 v[80:81], v20 offset:12288
    ds_read_b64_tr_b16 v[82:83], v20 offset:13824
    ds_read_b64_tr_b16 v[84:85], v21 offset:12288
    s_mov_b32 s48, 384
    s_add_u32 m0, s49, 0x1000
    s_nop 0
    buffer_load_dwordx4 v5, s[8:11], s48 offen lds
    s_add_u32 m0, s49, 0x1400
    s_nop 0
    v_mfma_f32_32x32x16_bf16 v[144:159], v[108:111], v[36:39], v[144:159]
    ds_read_b64_tr_b16 v[86:87], v21 offset:13824
    ds_read_b64_tr_b16 v[88:89], v20 offset:12416
    ds_read_b64_tr_b16 v[90:91], v20 offset:13952
    buffer_load_dwordx4 v6, s[8:11], s48 offen lds
    s_add_u32 m0, s49, 0x1800
    s_nop 0
    buffer_load_dwordx4 v7, s[8:11], s48 offen lds
    s_add_u32 m0, s49, 0x1c00
    s_nop 0
    v_mfma_f32_32x32x16_bf16 v[160:175], v[112:115], v[36:39], v[160:175]
    ds_read_b64_tr_b16 v[92:93], v21 offset:12416
    ds_read_b64_tr_b16 v[94:95], v21 offset:13952
    ds_read_b64_tr_b16 v[96:97], v20 offset:12544
    buffer_load_dwordx4 v8, s[8:11], s48 offen lds
    v_dot2c_f32_bf16 v238, v36, v25
    v_dot2c_f32_bf16 v29, v36, v36
    v_dot2c_f32_bf16 v239, v37, v25
    v_dot2c_f32_bf16 v28, v37, v37
    v_dot2c_f32_bf16 v238, v38, v25
    v_mfma_f32_32x32x16_bf16 v[176:191], v[116:119], v[36:39], v[176:191]
    ds_read_b64_tr_b16 v[98:99], v20 offset:14080
    ds_read_b64_tr_b16 v[100:101], v21 offset:12544
    ds_read_b64_tr_b16 v[102:103], v21 offset:14080
    v_dot2c_f32_bf16 v29, v38, v38
    v_dot2c_f32_bf16 v239, v39, v25
    v_dot2c_f32_bf16 v28, v39, v39
    v_dot2c_f32_bf16 v30, v248, v25
    v_dot2c_f32_bf16 v31, v249, v25
    v_dot2c_f32_bf16 v30, v250, v25
    v_mfma_f32_32x32x16_bf16 v[192:207], v[120:123], v[36:39], v[192:207]
    ds_read_b64_tr_b16 v[244:245], v252 offset:12288
    ds_read_b64_tr_b16 v[246:247], v252 offset:13824
    v_dot2c_f32_bf16 v31, v251, v25
    v_mfma_f32_32x32x16_bf16 v[208:223], v[124:127], v[36:39], v[208:223]
    s_waitcnt lgkmcnt(0)
    v_mfma_f32_32x32x16_bf16 v[128:143], v[80:83], v[40:43], v[128:143]
    ds_read_b64_tr_b16 v[104:105], v20 offset:18432
    ds_read_b64_tr_b16 v[106:107], v20 offset:19968
    ds_read_b64_tr_b16 v[108:109], v21 offset:18432
    v_dot2c_f32_bf16 v238, v40, v25
    v_dot2c_f32_bf16 v29, v40, v40
    v_dot2c_f32_bf16 v239, v41, v25
    v_dot2c_f32_bf16 v28, v41, v41
    v_dot2c_f32_bf16 v238, v42, v25
    v_dot2c_f32_bf16 v29, v42, v42
    v_mfma_f32_32x32x16_bf16 v[144:159], v[84:87], v[40:43], v[144:159]
    ds_read_b64_tr_b16 v[110:111], v21 offset:19968
    ds_read_b64_tr_b16 v[112:113], v20 offset:18560
    ds_read_b64_tr_b16 v[114:115], v20 offset:20096
    v_dot2c_f32_bf16 v239, v43, v25
    v_dot2c_f32_bf16 v28, v43, v43
    v_dot2c_f32_bf16 v30, v244, v25
    v_dot2c_f32_bf16 v31, v245, v25
    v_dot2c_f32_bf16 v30, v246, v25
    v_dot2c_f32_bf16 v31, v247, v25
    v_mfma_f32_32x32x16_bf16 v[160:175], v[88:91], v[40:43], v[160:175]
    ds_read_b64_tr_b16 v[116:117], v21 offset:18560
    ds_read_b64_tr_b16 v[118:119], v21 offset:20096
    ds_read_b64_tr_b16 v[120:121], v20 offset:18688
    v_mfma_f32_32x32x16_bf16 v[176:191], v[92:95], v[40:43], v[176:191]
    ds_read_b64_tr_b16 v[122:123], v20 offset:20224
    ds_read_b64_tr_b16 v[124:125], v21 offset:18688
    ds_read_b64_tr_b16 v[126:127], v21 offset:20224
    v_mfma_f32_32x32x16_bf16 v[192:207], v[96:99], v[40:43], v[192:207]
    ds_read_b64_tr_b16 v[248:249], v252 offset:18432
    ds_read_b64_tr_b16 v[250:251], v252 offset:19968
    v_mfma_f32_32x32x16_bf16 v[208:223], v[100:103], v[40:43], v[208:223]
    s_waitcnt vmcnt(14) lgkmcnt(0)
    s_barrier
    v_mfma_f32_32x32x16_bf16 v[128:143], v[104:107], v[44:47], v[128:143]
    ds_read_b64_tr_b16 v[80:81], v20 offset:24576
    ds_read_b64_tr_b16 v[82:83], v20 offset:26112
    ds_read_b64_tr_b16 v[84:85], v21 offset:24576
    s_add_u32 s46, s40, 0x240000
    s_add_u32 m0, s37, 0x0
    s_nop 0
    buffer_load_dwordx4 v10, s[12:15], s46 offen lds
    s_add_u32 m0, s37, 0x400
    s_nop 0
    v_mfma_f32_32x32x16_bf16 v[144:159], v[108:111], v[44:47], v[144:159]
    ds_read_b64_tr_b16 v[86:87], v21 offset:26112
    ds_read_b64_tr_b16 v[88:89], v20 offset:24704
    ds_read_b64_tr_b16 v[90:91], v20 offset:26240
    buffer_load_dwordx4 v11, s[12:15], s46 offen lds
    s_add_u32 m0, s37, 0x800
    s_nop 0
    buffer_load_dwordx4 v12, s[12:15], s46 offen lds
    v_dot2c_f32_bf16 v238, v44, v25
    v_dot2c_f32_bf16 v29, v44, v44
    v_mfma_f32_32x32x16_bf16 v[160:175], v[112:115], v[44:47], v[160:175]
    ds_read_b64_tr_b16 v[92:93], v21 offset:24704
    ds_read_b64_tr_b16 v[94:95], v21 offset:26240
    ds_read_b64_tr_b16 v[96:97], v20 offset:24832
    v_dot2c_f32_bf16 v239, v45, v25
    v_dot2c_f32_bf16 v28, v45, v45
    v_dot2c_f32_bf16 v238, v46, v25
    v_dot2c_f32_bf16 v29, v46, v46
    v_dot2c_f32_bf16 v239, v47, v25
    v_dot2c_f32_bf16 v28, v47, v47
    v_mfma_f32_32x32x16_bf16 v[176:191], v[116:119], v[44:47], v[176:191]
    ds_read_b64_tr_b16 v[98:99], v20 offset:26368
    ds_read_b64_tr_b16 v[100:101], v21 offset:24832
    ds_read_b64_tr_b16 v[102:103], v21 offset:26368
    v_dot2c_f32_bf16 v30, v248, v25
    v_dot2c_f32_bf16 v31, v249, v25
    v_dot2c_f32_bf16 v30, v250, v25
    v_dot2c_f32_bf16 v31, v251, v25
    v_mfma_f32_32x32x16_bf16 v[192:207], v[120:123], v[44:47], v[192:207]
    ds_read_b64_tr_b16 v[244:245], v252 offset:24576
    ds_read_b64_tr_b16 v[246:247], v252 offset:26112
    v_mfma_f32_32x32x16_bf16 v[208:223], v[124:127], v[44:47], v[208:223]
    s_waitcnt lgkmcnt(0)
    s_waitcnt vmcnt(13)
    v_mfma_f32_32x32x16_bf16 v[128:143], v[80:83], v[48:51], v[128:143]
    ds_read_b128 v[64:67], v13 offset:0
    ds_read_b128 v[68:71], v14 offset:0
    ds_read_b128 v[72:75], v15 offset:0
    v_dot2c_f32_bf16 v238, v48, v25
    v_dot2c_f32_bf16 v29, v48, v48
    v_dot2c_f32_bf16 v239, v49, v25
    v_dot2c_f32_bf16 v28, v49, v49
    v_dot2c_f32_bf16 v238, v50, v25
    v_dot2c_f32_bf16 v29, v50, v50
    v_mfma_f32_32x32x16_bf16 v[144:159], v[84:87], v[48:51], v[144:159]
    ds_read_b128 v[76:79], v16 offset:0
    ds_read_b64_tr_b16 v[104:105], v20 offset:30720
    ds_read_b64_tr_b16 v[106:107], v20 offset:32256
    v_dot2c_f32_bf16 v239, v51, v25
    v_dot2c_f32_bf16 v28, v51, v51
    v_dot2c_f32_bf16 v30, v244, v25
    v_dot2c_f32_bf16 v31, v245, v25
    v_dot2c_f32_bf16 v30, v246, v25
    v_dot2c_f32_bf16 v31, v247, v25
    v_mfma_f32_32x32x16_bf16 v[160:175], v[88:91], v[48:51], v[160:175]
    ds_read_b64_tr_b16 v[108:109], v21 offset:30720
    ds_read_b64_tr_b16 v[110:111], v21 offset:32256
    ds_read_b64_tr_b16 v[112:113], v20 offset:30848
    v_mfma_f32_32x32x16_bf16 v[176:191], v[92:95], v[48:51], v[176:191]
    ds_read_b64_tr_b16 v[114:115], v20 offset:32384
    ds_read_b64_tr_b16 v[116:117], v21 offset:30848
    ds_read_b64_tr_b16 v[118:119], v21 offset:32384
    v_mfma_f32_32x32x16_bf16 v[192:207], v[96:99], v[48:51], v[192:207]
    ds_read_b64_tr_b16 v[120:121], v20 offset:30976
    ds_read_b64_tr_b16 v[122:123], v20 offset:32512
    ds_read_b64_tr_b16 v[124:125], v21 offset:30976
    v_mfma_f32_32x32x16_bf16 v[208:223], v[100:103], v[48:51], v[208:223]
    ds_read_b64_tr_b16 v[126:127], v21 offset:32512
    ds_read_b64_tr_b16 v[248:249], v252 offset:30720
    ds_read_b64_tr_b16 v[250:251], v252 offset:32256
    s_waitcnt lgkmcnt(0)
    v_mfma_f32_32x32x16_bf16 v[128:143], v[104:107], v[52:55], v[128:143]
    ds_read_b64_tr_b16 v[80:81], v20 offset:36864
    ds_read_b64_tr_b16 v[82:83], v20 offset:38400
    ds_read_b64_tr_b16 v[84:85], v21 offset:36864
    s_mov_b32 s48, 512
    s_add_u32 m0, s49, 0x0
    s_nop 0
    buffer_load_dwordx4 v5, s[8:11], s48 offen lds
    s_add_u32 m0, s49, 0x400
    s_nop 0
    v_mfma_f32_32x32x16_bf16 v[144:159], v[108:111], v[52:55], v[144:159]
    ds_read_b64_tr_b16 v[86:87], v21 offset:38400
    ds_read_b64_tr_b16 v[88:89], v20 offset:36992
    ds_read_b64_tr_b16 v[90:91], v20 offset:38528
    buffer_load_dwordx4 v6, s[8:11], s48 offen lds
    s_add_u32 m0, s49, 0x800
    s_nop 0
    buffer_load_dwordx4 v7, s[8:11], s48 offen lds
    s_add_u32 m0, s49, 0xc00
    s_nop 0
    v_mfma_f32_32x32x16_bf16 v[160:175], v[112:115], v[52:55], v[160:175]
    ds_read_b64_tr_b16 v[92:93], v21 offset:36992
    ds_read_b64_tr_b16 v[94:95], v21 offset:38528
    ds_read_b64_tr_b16 v[96:97], v20 offset:37120
    buffer_load_dwordx4 v8, s[8:11], s48 offen lds
    v_dot2c_f32_bf16 v238, v52, v25
    v_dot2c_f32_bf16 v29, v52, v52
    v_dot2c_f32_bf16 v239, v53, v25
    v_dot2c_f32_bf16 v28, v53, v53
    v_dot2c_f32_bf16 v238, v54, v25
    v_mfma_f32_32x32x16_bf16 v[176:191], v[116:119], v[52:55], v[176:191]
    ds_read_b64_tr_b16 v[98:99], v20 offset:38656
    ds_read_b64_tr_b16 v[100:101], v21 offset:37120
    ds_read_b64_tr_b16 v[102:103], v21 offset:38656
    v_dot2c_f32_bf16 v29, v54, v54
    v_dot2c_f32_bf16 v239, v55, v25
    v_dot2c_f32_bf16 v28, v55, v55
    v_dot2c_f32_bf16 v30, v248, v25
    v_dot2c_f32_bf16 v31, v249, v25
    v_dot2c_f32_bf16 v30, v250, v25
    v_mfma_f32_32x32x16_bf16 v[192:207], v[120:123], v[52:55], v[192:207]
    ds_read_b64_tr_b16 v[244:245], v252 offset:36864
    ds_read_b64_tr_b16 v[246:247], v252 offset:38400
    v_dot2c_f32_bf16 v31, v251, v25
    v_mfma_f32_32x32x16_bf16 v[208:223], v[124:127], v[52:55], v[208:223]
    s_waitcnt lgkmcnt(0)
    v_mfma_f32_32x32x16_bf16 v[128:143], v[80:83], v[56:59], v[128:143]
    ds_read_b64_tr_b16 v[104:105], v20 offset:43008
    ds_read_b64_tr_b16 v[106:107], v20 offset:44544
    ds_read_b64_tr_b16 v[108:109], v21 offset:43008
    v_dot2c_f32_bf16 v238, v56, v25
    v_dot2c_f32_bf16 v29, v56, v56
    v_dot2c_f32_bf16 v239, v57, v25
    v_dot2c_f32_bf16 v28, v57, v57
    v_dot2c_f32_bf16 v238, v58, v25
    v_dot2c_f32_bf16 v29, v58, v58
    v_mfma_f32_32x32x16_bf16 v[144:159], v[84:87], v[56:59], v[144:159]
    ds_read_b64_tr_b16 v[110:111], v21 offset:44544
    ds_read_b64_tr_b16 v[112:113], v20 offset:43136
    ds_read_b64_tr_b16 v[114:115], v20 offset:44672
    v_dot2c_f32_bf16 v239, v59, v25
    v_dot2c_f32_bf16 v28, v59, v59
    v_dot2c_f32_bf16 v30, v244, v25
    v_dot2c_f32_bf16 v31, v245, v25
    v_dot2c_f32_bf16 v30, v246, v25
    v_dot2c_f32_bf16 v31, v247, v25
    v_mfma_f32_32x32x16_bf16 v[160:175], v[88:91], v[56:59], v[160:175]
    ds_read_b64_tr_b16 v[116:117], v21 offset:43136
    ds_read_b64_tr_b16 v[118:119], v21 offset:44672
    ds_read_b64_tr_b16 v[120:121], v20 offset:43264
    v_mfma_f32_32x32x16_bf16 v[176:191], v[92:95], v[56:59], v[176:191]
    ds_read_b64_tr_b16 v[122:123], v20 offset:44800
    ds_read_b64_tr_b16 v[124:125], v21 offset:43264
    ds_read_b64_tr_b16 v[126:127], v21 offset:44800
    v_mfma_f32_32x32x16_bf16 v[192:207], v[96:99], v[56:59], v[192:207]
    ds_read_b64_tr_b16 v[248:249], v252 offset:43008
    ds_read_b64_tr_b16 v[250:251], v252 offset:44544
    v_mfma_f32_32x32x16_bf16 v[208:223], v[100:103], v[56:59], v[208:223]
    s_lshl_b32 s58, s2, 3
    s_add_u32 s58, s58, s26
    s_add_u32 s58, s58, 0
    s_mov_b32 s62, 0x800000
    s_mov_b32 s63, 0x00020000
    s_cmp_lt_u32 s58, 2048
    s_cselect_b32 s60, s52, s54
    s_cselect_b32 s61, s53, s55
    s_and_b32 s59, s58, 2047
    s_cmp_lt_u32 s58, 4096
    s_cselect_b32 s62, s62, 0
    s_lshl_b32 s59, s59, 12
    v_lshlrev_b32 v18, 6, v2
    buffer_load_dword v17, v18, s[60:63], s59 offen
    s_waitcnt vmcnt(15) lgkmcnt(0)
    s_barrier
    v_add_u32 v20, 0xc000, v20
    v_add_u32 v21, 0xc000, v21
    v_add_u32 v252, 0xc000, v252
    v_mfma_f32_32x32x16_bf16 v[128:143], v[104:107], v[60:63], v[128:143]
    ds_read_b64_tr_b16 v[80:81], v20 offset:0
    ds_read_b64_tr_b16 v[82:83], v20 offset:1536
    ds_read_b64_tr_b16 v[84:85], v21 offset:0
    s_add_u32 s46, s40, 0x2d0000
    s_add_u32 m0, s37, 0x6000
    s_nop 0
    buffer_load_dwordx4 v10, s[12:15], s46 offen lds
    s_add_u32 m0, s37, 0x6400
    s_nop 0
    v_mfma_f32_32x32x16_bf16 v[144:159], v[108:111], v[60:63], v[144:159]
    ds_read_b64_tr_b16 v[86:87], v21 offset:1536
    ds_read_b64_tr_b16 v[88:89], v20 offset:128
    ds_read_b64_tr_b16 v[90:91], v20 offset:1664
    buffer_load_dwordx4 v11, s[12:15], s46 offen lds
    s_add_u32 m0, s37, 0x6800
    s_nop 0
    buffer_load_dwordx4 v12, s[12:15], s46 offen lds
    v_dot2c_f32_bf16 v238, v60, v25
    v_dot2c_f32_bf16 v29, v60, v60
    v_mfma_f32_32x32x16_bf16 v[160:175], v[112:115], v[60:63], v[160:175]
    ds_read_b64_tr_b16 v[92:93], v21 offset:128
    ds_read_b64_tr_b16 v[94:95], v21 offset:1664
    ds_read_b64_tr_b16 v[96:97], v20 offset:256
    v_dot2c_f32_bf16 v239, v61, v25
    v_dot2c_f32_bf16 v28, v61, v61
    v_dot2c_f32_bf16 v238, v62, v25
    v_dot2c_f32_bf16 v29, v62, v62
    v_dot2c_f32_bf16 v239, v63, v25
    v_dot2c_f32_bf16 v28, v63, v63
    v_mfma_f32_32x32x16_bf16 v[176:191], v[116:119], v[60:63], v[176:191]
    ds_read_b64_tr_b16 v[98:99], v20 offset:1792
    ds_read_b64_tr_b16 v[100:101], v21 offset:256
    ds_read_b64_tr_b16 v[102:103], v21 offset:1792
    v_dot2c_f32_bf16 v30, v248, v25
    v_dot2c_f32_bf16 v31, v249, v25
    v_dot2c_f32_bf16 v30, v250, v25
    v_dot2c_f32_bf16 v31, v251, v25
    v_mfma_f32_32x32x16_bf16 v[192:207], v[120:123], v[60:63], v[192:207]
    ds_read_b64_tr_b16 v[244:245], v252 offset:0
    ds_read_b64_tr_b16 v[246:247], v252 offset:1536
    v_mfma_f32_32x32x16_bf16 v[208:223], v[124:127], v[60:63], v[208:223]
    s_waitcnt lgkmcnt(0)
    s_waitcnt vmcnt(11)
    v_mfma_f32_32x32x16_bf16 v[128:143], v[80:83], v[64:67], v[128:143]
    ds_read_b128 v[32:35], v13 offset:4096
    ds_read_b128 v[36:39], v14 offset:4096
    ds_read_b128 v[40:43], v15 offset:4096
    v_dot2c_f32_bf16 v238, v64, v25
    v_dot2c_f32_bf16 v29, v64, v64
    v_dot2c_f32_bf16 v239, v65, v25
    v_dot2c_f32_bf16 v28, v65, v65
    v_dot2c_f32_bf16 v238, v66, v25
    v_dot2c_f32_bf16 v29, v66, v66
    v_mfma_f32_32x32x16_bf16 v[144:159], v[84:87], v[64:67], v[144:159]
    ds_read_b128 v[44:47], v16 offset:4096
    ds_read_b64_tr_b16 v[104:105], v20 offset:6144
    ds_read_b64_tr_b16 v[106:107], v20 offset:7680
    v_dot2c_f32_bf16 v239, v67, v25
    v_dot2c_f32_bf16 v28, v67, v67
    v_dot2c_f32_bf16 v30, v244, v25
    v_dot2c_f32_bf16 v31, v245, v25
    v_dot2c_f32_bf16 v30, v246, v25
    v_dot2c_f32_bf16 v31, v247, v25
    v_mfma_f32_32x32x16_bf16 v[160:175], v[88:91], v[64:67], v[160:175]
    ds_read_b64_tr_b16 v[108:109], v21 offset:6144
    ds_read_b64_tr_b16 v[110:111], v21 offset:7680
    ds_read_b64_tr_b16 v[112:113], v20 offset:6272
    v_mfma_f32_32x32x16_bf16 v[176:191], v[92:95], v[64:67], v[176:191]
    ds_read_b64_tr_b16 v[114:115], v20 offset:7808
    ds_read_b64_tr_b16 v[116:117], v21 offset:6272
    ds_read_b64_tr_b16 v[118:119], v21 offset:7808
    v_mfma_f32_32x32x16_bf16 v[192:207], v[96:99], v[64:67], v[192:207]
    ds_read_b64_tr_b16 v[120:121], v20 offset:6400
    ds_read_b64_tr_b16 v[122:123], v20 offset:7936
    ds_read_b64_tr_b16 v[124:125], v21 offset:6400
    v_mfma_f32_32x32x16_bf16 v[208:223], v[100:103], v[64:67], v[208:223]
    ds_read_b64_tr_b16 v[126:127], v21 offset:7936
    ds_read_b64_tr_b16 v[248:249], v252 offset:6144
    ds_read_b64_tr_b16 v[250:251], v252 offset:7680
    s_waitcnt lgkmcnt(0)
    v_mfma_f32_32x32x16_bf16 v[128:143], v[104:107], v[68:71], v[128:143]
    ds_read_b64_tr_b16 v[80:81], v20 offset:12288
    ds_read_b64_tr_b16 v[82:83], v20 offset:13824
    ds_read_b64_tr_b16 v[84:85], v21 offset:12288
    s_mov_b32 s48, 640
    s_add_u32 m0, s49, 0x1000
    s_nop 0
    buffer_load_dwordx4 v5, s[8:11], s48 offen lds
    s_add_u32 m0, s49, 0x1400
    s_nop 0
    v_mfma_f32_32x32x16_bf16 v[144:159], v[108:111], v[68:71], v[144:159]
    ds_read_b64_tr_b16 v[86:87], v21 offset:13824
    ds_read_b64_tr_b16 v[88:89], v20 offset:12416
    ds_read_b64_tr_b16 v[90:91], v20 offset:13952
    buffer_load_dwordx4 v6, s[8:11], s48 offen lds
    s_add_u32 m0, s49, 0x1800
    s_nop 0
    buffer_load_dwordx4 v7, s[8:11], s48 offen lds
    s_add_u32 m0, s49, 0x1c00
    s_nop 0
    v_mfma_f32_32x32x16_bf16 v[160:175], v[112:115], v[68:71], v[160:175]
    ds_read_b64_tr_b16 v[92:93], v21 offset:12416
    ds_read_b64_tr_b16 v[94:95], v21 offset:13952
    ds_read_b64_tr_b16 v[96:97], v20 offset:12544
    buffer_load_dwordx4 v8, s[8:11], s48 offen lds
    v_dot2c_f32_bf16 v238, v68, v25
    v_dot2c_f32_bf16 v29, v68, v68
    v_dot2c_f32_bf16 v239, v69, v25
    v_dot2c_f32_bf16 v28, v69, v69
    v_dot2c_f32_bf16 v238, v70, v25
    v_mfma_f32_32x32x16_bf16 v[176:191], v[116:119], v[68:71], v[176:191]
    ds_read_b64_tr_b16 v[98:99], v20 offset:14080
    ds_read_b64_tr_b16 v[100:101], v21 offset:12544
    ds_read_b64_tr_b16 v[102:103], v21 offset:14080
    v_dot2c_f32_bf16 v29, v70, v70
    v_dot2c_f32_bf16 v239, v71, v25
    v_dot2c_f32_bf16 v28, v71, v71
    v_dot2c_f32_bf16 v30, v248, v25
    v_dot2c_f32_bf16 v31, v249, v25
    v_dot2c_f32_bf16 v30, v250, v25
    v_mfma_f32_32x32x16_bf16 v[192:207], v[120:123], v[68:71], v[192:207]
    ds_read_b64_tr_b16 v[244:245], v252 offset:12288
    ds_read_b64_tr_b16 v[246:247], v252 offset:13824
    v_dot2c_f32_bf16 v31, v251, v25
    v_mfma_f32_32x32x16_bf16 v[208:223], v[124:127], v[68:71], v[208:223]
    s_waitcnt lgkmcnt(0)
    v_mfma_f32_32x32x16_bf16 v[128:143], v[80:83], v[72:75], v[128:143]
    ds_read_b64_tr_b16 v[104:105], v20 offset:18432
    ds_read_b64_tr_b16 v[106:107], v20 offset:19968
    ds_read_b64_tr_b16 v[108:109], v21 offset:18432
    v_dot2c_f32_bf16 v238, v72, v25
    v_dot2c_f32_bf16 v29, v72, v72
    v_dot2c_f32_bf16 v239, v73, v25
    v_dot2c_f32_bf16 v28, v73, v73
    v_dot2c_f32_bf16 v238, v74, v25
    v_dot2c_f32_bf16 v29, v74, v74
    v_mfma_f32_32x32x16_bf16 v[144:159], v[84:87], v[72:75], v[144:159]
    ds_read_b64_tr_b16 v[110:111], v21 offset:19968
    ds_read_b64_tr_b16 v[112:113], v20 offset:18560
    ds_read_b64_tr_b16 v[114:115], v20 offset:20096
    v_dot2c_f32_bf16 v239, v75, v25
    v_dot2c_f32_bf16 v28, v75, v75
    v_dot2c_f32_bf16 v30, v244, v25
    v_dot2c_f32_bf16 v31, v245, v25
    v_dot2c_f32_bf16 v30, v246, v25
    v_dot2c_f32_bf16 v31, v247, v25
    v_mfma_f32_32x32x16_bf16 v[160:175], v[88:91], v[72:75], v[160:175]
    ds_read_b64_tr_b16 v[116:117], v21 offset:18560
    ds_read_b64_tr_b16 v[118:119], v21 offset:20096
    ds_read_b64_tr_b16 v[120:121], v20 offset:18688
    v_mfma_f32_32x32x16_bf16 v[176:191], v[92:95], v[72:75], v[176:191]
    ds_read_b64_tr_b16 v[122:123], v20 offset:20224
    ds_read_b64_tr_b16 v[124:125], v21 offset:18688
    ds_read_b64_tr_b16 v[126:127], v21 offset:20224
    v_mfma_f32_32x32x16_bf16 v[192:207], v[96:99], v[72:75], v[192:207]
    ds_read_b64_tr_b16 v[248:249], v252 offset:18432
    ds_read_b64_tr_b16 v[250:251], v252 offset:19968
    v_mfma_f32_32x32x16_bf16 v[208:223], v[100:103], v[72:75], v[208:223]
    s_waitcnt lgkmcnt(0)
    s_barrier
    v_mfma_f32_32x32x16_bf16 v[128:143], v[104:107], v[76:79], v[128:143]
    ds_read_b64_tr_b16 v[80:81], v20 offset:24576
    ds_read_b64_tr_b16 v[82:83], v20 offset:26112
    ds_read_b64_tr_b16 v[84:85], v21 offset:24576
    s_add_u32 s46, s40, 0x360000
    s_add_u32 m0, s37, 0xc000
    s_nop 0
    buffer_load_dwordx4 v10, s[12:15], s46 offen lds
    s_add_u32 m0, s37, 0xc400
    s_nop 0
    v_mfma_f32_32x32x16_bf16 v[144:159], v[108:111], v[76:79], v[144:159]
    ds_read_b64_tr_b16 v[86:87], v21 offset:26112
    ds_read_b64_tr_b16 v[88:89], v20 offset:24704
    ds_read_b64_tr_b16 v[90:91], v20 offset:26240
    buffer_load_dwordx4 v11, s[12:15], s46 offen lds
    s_add_u32 m0, s37, 0xc800
    s_nop 0
    buffer_load_dwordx4 v12, s[12:15], s46 offen lds
    v_dot2c_f32_bf16 v238, v76, v25
    v_dot2c_f32_bf16 v29, v76, v76
    v_mfma_f32_32x32x16_bf16 v[160:175], v[112:115], v[76:79], v[160:175]
    ds_read_b64_tr_b16 v[92:93], v21 offset:24704
    ds_read_b64_tr_b16 v[94:95], v21 offset:26240
    ds_read_b64_tr_b16 v[96:97], v20 offset:24832
    v_dot2c_f32_bf16 v239, v77, v25
    v_dot2c_f32_bf16 v28, v77, v77
    v_dot2c_f32_bf16 v238, v78, v25
    v_dot2c_f32_bf16 v29, v78, v78
    v_dot2c_f32_bf16 v239, v79, v25
    v_dot2c_f32_bf16 v28, v79, v79
    v_mfma_f32_32x32x16_bf16 v[176:191], v[116:119], v[76:79], v[176:191]
    ds_read_b64_tr_b16 v[98:99], v20 offset:26368
    ds_read_b64_tr_b16 v[100:101], v21 offset:24832
    ds_read_b64_tr_b16 v[102:103], v21 offset:26368
    v_dot2c_f32_bf16 v30, v248, v25
    v_dot2c_f32_bf16 v31, v249, v25
    v_dot2c_f32_bf16 v30, v250, v25
    v_dot2c_f32_bf16 v31, v251, v25
    v_mfma_f32_32x32x16_bf16 v[192:207], v[120:123], v[76:79], v[192:207]
    ds_read_b64_tr_b16 v[244:245], v252 offset:24576
    ds_read_b64_tr_b16 v[246:247], v252 offset:26112
    v_mfma_f32_32x32x16_bf16 v[208:223], v[124:127], v[76:79], v[208:223]
    s_waitcnt lgkmcnt(0)
    s_waitcnt vmcnt(11)
    v_mfma_f32_32x32x16_bf16 v[128:143], v[80:83], v[32:35], v[128:143]
    ds_read_b128 v[48:51], v13 offset:0
    ds_read_b128 v[52:55], v14 offset:0
    ds_read_b128 v[56:59], v15 offset:0
    v_dot2c_f32_bf16 v238, v32, v25
    v_dot2c_f32_bf16 v29, v32, v32
    v_dot2c_f32_bf16 v239, v33, v25
    v_dot2c_f32_bf16 v28, v33, v33
    v_dot2c_f32_bf16 v238, v34, v25
    v_dot2c_f32_bf16 v29, v34, v34
    v_mfma_f32_32x32x16_bf16 v[144:159], v[84:87], v[32:35], v[144:159]
    ds_read_b128 v[60:63], v16 offset:0
    ds_read_b64_tr_b16 v[104:105], v20 offset:30720
    ds_read_b64_tr_b16 v[106:107], v20 offset:32256
    v_dot2c_f32_bf16 v239, v35, v25
    v_dot2c_f32_bf16 v28, v35, v35
    v_dot2c_f32_bf16 v30, v244, v25
    v_dot2c_f32_bf16 v31, v245, v25
    v_dot2c_f32_bf16 v30, v246, v25
    v_dot2c_f32_bf16 v31, v247, v25
    v_mfma_f32_32x32x16_bf16 v[160:175], v[88:91], v[32:35], v[160:175]
    ds_read_b64_tr_b16 v[108:109], v21 offset:30720
    ds_read_b64_tr_b16 v[110:111], v21 offset:32256
    ds_read_b64_tr_b16 v[112:113], v20 offset:30848
    v_mfma_f32_32x32x16_bf16 v[176:191], v[92:95], v[32:35], v[176:191]
    ds_read_b64_tr_b16 v[114:115], v20 offset:32384
    ds_read_b64_tr_b16 v[116:117], v21 offset:30848
    ds_read_b64_tr_b16 v[118:119], v21 offset:32384
    v_mfma_f32_32x32x16_bf16 v[192:207], v[96:99], v[32:35], v[192:207]
    ds_read_b64_tr_b16 v[120:121], v20 offset:30976
    ds_read_b64_tr_b16 v[122:123], v20 offset:32512
    ds_read_b64_tr_b16 v[124:125], v21 offset:30976
    v_mfma_f32_32x32x16_bf16 v[208:223], v[100:103], v[32:35], v[208:223]
    ds_read_b64_tr_b16 v[126:127], v21 offset:32512
    ds_read_b64_tr_b16 v[248:249], v252 offset:30720
    ds_read_b64_tr_b16 v[250:251], v252 offset:32256
    s_waitcnt lgkmcnt(0)
    v_mfma_f32_32x32x16_bf16 v[128:143], v[104:107], v[36:39], v[128:143]
    ds_read_b64_tr_b16 v[80:81], v20 offset:36864
    ds_read_b64_tr_b16 v[82:83], v20 offset:38400
    ds_read_b64_tr_b16 v[84:85], v21 offset:36864
    s_mov_b32 s48, 768
    s_add_u32 m0, s49, 0x0
    s_nop 0
    buffer_load_dwordx4 v5, s[8:11], s48 offen lds
    s_add_u32 m0, s49, 0x400
    s_nop 0
    v_mfma_f32_32x32x16_bf16 v[144:159], v[108:111], v[36:39], v[144:159]
    ds_read_b64_tr_b16 v[86:87], v21 offset:38400
    ds_read_b64_tr_b16 v[88:89], v20 offset:36992
    ds_read_b64_tr_b16 v[90:91], v20 offset:38528
    buffer_load_dwordx4 v6, s[8:11], s48 offen lds
    s_add_u32 m0, s49, 0x800
    s_nop 0
    buffer_load_dwordx4 v7, s[8:11], s48 offen lds
    s_add_u32 m0, s49, 0xc00
    s_nop 0
    v_mfma_f32_32x32x16_bf16 v[160:175], v[112:115], v[36:39], v[160:175]
    ds_read_b64_tr_b16 v[92:93], v21 offset:36992
    ds_read_b64_tr_b16 v[94:95], v21 offset:38528
    ds_read_b64_tr_b16 v[96:97], v20 offset:37120
    buffer_load_dwordx4 v8, s[8:11], s48 offen lds
    v_dot2c_f32_bf16 v238, v36, v25
    v_dot2c_f32_bf16 v29, v36, v36
    v_dot2c_f32_bf16 v239, v37, v25
    v_dot2c_f32_bf16 v28, v37, v37
    v_dot2c_f32_bf16 v238, v38, v25
    v_mfma_f32_32x32x16_bf16 v[176:191], v[116:119], v[36:39], v[176:191]
    ds_read_b64_tr_b16 v[98:99], v20 offset:38656
    ds_read_b64_tr_b16 v[100:101], v21 offset:37120
    ds_read_b64_tr_b16 v[102:103], v21 offset:38656
    v_dot2c_f32_bf16 v29, v38, v38
    v_dot2c_f32_bf16 v239, v39, v25
    v_dot2c_f32_bf16 v28, v39, v39
    v_dot2c_f32_bf16 v30, v248, v25
    v_dot2c_f32_bf16 v31, v249, v25
    v_dot2c_f32_bf16 v30, v250, v25
    v_mfma_f32_32x32x16_bf16 v[192:207], v[120:123], v[36:39], v[192:207]
    ds_read_b64_tr_b16 v[244:245], v252 offset:36864
    ds_read_b64_tr_b16 v[246:247], v252 offset:38400
    v_dot2c_f32_bf16 v31, v251, v25
    v_mfma_f32_32x32x16_bf16 v[208:223], v[124:127], v[36:39], v[208:223]
    s_lshl_b32 s58, s2, 3
    s_add_u32 s58, s58, s26
    s_add_u32 s58, s58, 1920
    s_mov_b32 s62, 0x800000
    s_mov_b32 s63, 0x00020000
    s_cmp_lt_u32 s58, 2048
    s_cselect_b32 s60, s52, s54
    s_cselect_b32 s61, s53, s55
    s_and_b32 s59, s58, 2047
    s_cmp_lt_u32 s58, 4096
    s_cselect_b32 s62, s62, 0
    s_lshl_b32 s59, s59, 12
    v_lshlrev_b32 v18, 6, v2
    buffer_load_dword v17, v18, s[60:63], s59 offen
    s_waitcnt lgkmcnt(0)
    v_mfma_f32_32x32x16_bf16 v[128:143], v[80:83], v[40:43], v[128:143]
    ds_read_b64_tr_b16 v[104:105], v20 offset:43008
    ds_read_b64_tr_b16 v[106:107], v20 offset:44544
    ds_read_b64_tr_b16 v[108:109], v21 offset:43008
    v_dot2c_f32_bf16 v238, v40, v25
    v_dot2c_f32_bf16 v29, v40, v40
    v_dot2c_f32_bf16 v239, v41, v25
    v_dot2c_f32_bf16 v28, v41, v41
    v_dot2c_f32_bf16 v238, v42, v25
    v_dot2c_f32_bf16 v29, v42, v42
    v_mfma_f32_32x32x16_bf16 v[144:159], v[84:87], v[40:43], v[144:159]
    ds_read_b64_tr_b16 v[110:111], v21 offset:44544
    ds_read_b64_tr_b16 v[112:113], v20 offset:43136
    ds_read_b64_tr_b16 v[114:115], v20 offset:44672
    v_dot2c_f32_bf16 v239, v43, v25
    v_dot2c_f32_bf16 v28, v43, v43
    v_dot2c_f32_bf16 v30, v244, v25
    v_dot2c_f32_bf16 v31, v245, v25
    v_dot2c_f32_bf16 v30, v246, v25
    v_dot2c_f32_bf16 v31, v247, v25
    v_mfma_f32_32x32x16_bf16 v[160:175], v[88:91], v[40:43], v[160:175]
    ds_read_b64_tr_b16 v[116:117], v21 offset:43136
    ds_read_b64_tr_b16 v[118:119], v21 offset:44672
    ds_read_b64_tr_b16 v[120:121], v20 offset:43264
    v_mfma_f32_32x32x16_bf16 v[176:191], v[92:95], v[40:43], v[176:191]
    ds_read_b64_tr_b16 v[122:123], v20 offset:44800
    ds_read_b64_tr_b16 v[124:125], v21 offset:43264
    ds_read_b64_tr_b16 v[126:127], v21 offset:44800
    v_mfma_f32_32x32x16_bf16 v[192:207], v[96:99], v[40:43], v[192:207]
    ds_read_b64_tr_b16 v[248:249], v252 offset:43008
    ds_read_b64_tr_b16 v[250:251], v252 offset:44544
    v_mfma_f32_32x32x16_bf16 v[208:223], v[100:103], v[40:43], v[208:223]
    s_waitcnt lgkmcnt(0)
    s_barrier
    v_subrev_u32 v20, 0xc000, v20
    v_subrev_u32 v21, 0xc000, v21
    v_subrev_u32 v252, 0xc000, v252
    v_mfma_f32_32x32x16_bf16 v[128:143], v[104:107], v[44:47], v[128:143]
    ds_read_b64_tr_b16 v[80:81], v20 offset:0
    ds_read_b64_tr_b16 v[82:83], v20 offset:1536
    ds_read_b64_tr_b16 v[84:85], v21 offset:0
    s_add_u32 s46, s40, 0x3f0000
    s_add_u32 m0, s37, 0x12000
    s_nop 0
    buffer_load_dwordx4 v10, s[12:15], s46 offen lds
    s_add_u32 m0, s37, 0x12400
    s_nop 0
    v_mfma_f32_32x32x16_bf16 v[144:159], v[108:111], v[44:47], v[144:159]
    ds_read_b64_tr_b16 v[86:87], v21 offset:1536
    ds_read_b64_tr_b16 v[88:89], v20 offset:128
    ds_read_b64_tr_b16 v[90:91], v20 offset:1664
    buffer_load_dwordx4 v11, s[12:15], s46 offen lds
    s_add_u32 m0, s37, 0x12800
    s_nop 0
    buffer_load_dwordx4 v12, s[12:15], s46 offen lds
    v_dot2c_f32_bf16 v238, v44, v25
    v_dot2c_f32_bf16 v29, v44, v44
    v_mfma_f32_32x32x16_bf16 v[160:175], v[112:115], v[44:47], v[160:175]
    ds_read_b64_tr_b16 v[92:93], v21 offset:128
    ds_read_b64_tr_b16 v[94:95], v21 offset:1664
    ds_read_b64_tr_b16 v[96:97], v20 offset:256
    v_dot2c_f32_bf16 v239, v45, v25
    v_dot2c_f32_bf16 v28, v45, v45
    v_dot2c_f32_bf16 v238, v46, v25
    v_dot2c_f32_bf16 v29, v46, v46
    v_dot2c_f32_bf16 v239, v47, v25
    v_dot2c_f32_bf16 v28, v47, v47
    v_mfma_f32_32x32x16_bf16 v[176:191], v[116:119], v[44:47], v[176:191]
    ds_read_b64_tr_b16 v[98:99], v20 offset:1792
    ds_read_b64_tr_b16 v[100:101], v21 offset:256
    ds_read_b64_tr_b16 v[102:103], v21 offset:1792
    v_dot2c_f32_bf16 v30, v248, v25
    v_dot2c_f32_bf16 v31, v249, v25
    v_dot2c_f32_bf16 v30, v250, v25
    v_dot2c_f32_bf16 v31, v251, v25
    v_mfma_f32_32x32x16_bf16 v[192:207], v[120:123], v[44:47], v[192:207]
    ds_read_b64_tr_b16 v[244:245], v252 offset:0
    ds_read_b64_tr_b16 v[246:247], v252 offset:1536
    v_mfma_f32_32x32x16_bf16 v[208:223], v[124:127], v[44:47], v[208:223]
    s_waitcnt lgkmcnt(0)
    s_waitcnt vmcnt(11)
    v_mfma_f32_32x32x16_bf16 v[128:143], v[80:83], v[48:51], v[128:143]
    ds_read_b128 v[64:67], v13 offset:4096
    ds_read_b128 v[68:71], v14 offset:4096
    ds_read_b128 v[72:75], v15 offset:4096
    v_dot2c_f32_bf16 v238, v48, v25
    v_dot2c_f32_bf16 v29, v48, v48
    v_dot2c_f32_bf16 v239, v49, v25
    v_dot2c_f32_bf16 v28, v49, v49
    v_dot2c_f32_bf16 v238, v50, v25
    v_dot2c_f32_bf16 v29, v50, v50
    v_mfma_f32_32x32x16_bf16 v[144:159], v[84:87], v[48:51], v[144:159]
    ds_read_b128 v[76:79], v16 offset:4096
    ds_read_b64_tr_b16 v[104:105], v20 offset:6144
    ds_read_b64_tr_b16 v[106:107], v20 offset:7680
    v_dot2c_f32_bf16 v239, v51, v25
    v_dot2c_f32_bf16 v28, v51, v51
    v_dot2c_f32_bf16 v30, v244, v25
    v_dot2c_f32_bf16 v31, v245, v25
    v_dot2c_f32_bf16 v30, v246, v25
    v_dot2c_f32_bf16 v31, v247, v25
    v_mfma_f32_32x32x16_bf16 v[160:175], v[88:91], v[48:51], v[160:175]
    ds_read_b64_tr_b16 v[108:109], v21 offset:6144
    ds_read_b64_tr_b16 v[110:111], v21 offset:7680
    ds_read_b64_tr_b16 v[112:113], v20 offset:6272
    v_mfma_f32_32x32x16_bf16 v[176:191], v[92:95], v[48:51], v[176:191]
    ds_read_b64_tr_b16 v[114:115], v20 offset:7808
    ds_read_b64_tr_b16 v[116:117], v21 offset:6272
    ds_read_b64_tr_b16 v[118:119], v21 offset:7808
    v_mfma_f32_32x32x16_bf16 v[192:207], v[96:99], v[48:51], v[192:207]
    ds_read_b64_tr_b16 v[120:121], v20 offset:6400
    ds_read_b64_tr_b16 v[122:123], v20 offset:7936
    ds_read_b64_tr_b16 v[124:125], v21 offset:6400
    v_mfma_f32_32x32x16_bf16 v[208:223], v[100:103], v[48:51], v[208:223]
    ds_read_b64_tr_b16 v[126:127], v21 offset:7936
    ds_read_b64_tr_b16 v[248:249], v252 offset:6144
    ds_read_b64_tr_b16 v[250:251], v252 offset:7680
    buffer_load_ushort v26, v26, s[20:23], 0 offen
    s_waitcnt lgkmcnt(0)
    v_mfma_f32_32x32x16_bf16 v[128:143], v[104:107], v[52:55], v[128:143]
    ds_read_b64_tr_b16 v[80:81], v20 offset:12288
    ds_read_b64_tr_b16 v[82:83], v20 offset:13824
    ds_read_b64_tr_b16 v[84:85], v21 offset:12288
    s_mov_b32 s48, 896
    s_add_u32 m0, s49, 0x1000
    s_nop 0
    buffer_load_dwordx4 v5, s[8:11], s48 offen lds
    s_add_u32 m0, s49, 0x1400
    s_nop 0
    v_mfma_f32_32x32x16_bf16 v[144:159], v[108:111], v[52:55], v[144:159]
    ds_read_b64_tr_b16 v[86:87], v21 offset:13824
    ds_read_b64_tr_b16 v[88:89], v20 offset:12416
    ds_read_b64_tr_b16 v[90:91], v20 offset:13952
    buffer_load_dwordx4 v6, s[8:11], s48 offen lds
    s_add_u32 m0, s49, 0x1800
    s_nop 0
    buffer_load_dwordx4 v7, s[8:11], s48 offen lds
    s_add_u32 m0, s49, 0x1c00
    s_nop 0
    v_mfma_f32_32x32x16_bf16 v[160:175], v[112:115], v[52:55], v[160:175]
    ds_read_b64_tr_b16 v[92:93], v21 offset:12416
    ds_read_b64_tr_b16 v[94:95], v21 offset:13952
    ds_read_b64_tr_b16 v[96:97], v20 offset:12544
    buffer_load_dwordx4 v8, s[8:11], s48 offen lds
    v_dot2c_f32_bf16 v238, v52, v25
    v_dot2c_f32_bf16 v29, v52, v52
    v_dot2c_f32_bf16 v239, v53, v25
    v_dot2c_f32_bf16 v28, v53, v53
    v_dot2c_f32_bf16 v238, v54, v25
    v_mfma_f32_32x32x16_bf16 v[176:191], v[116:119], v[52:55], v[176:191]
    ds_read_b64_tr_b16 v[98:99], v20 offset:14080
    ds_read_b64_tr_b16 v[100:101], v21 offset:12544
    ds_read_b64_tr_b16 v[102:103], v21 offset:14080
    v_dot2c_f32_bf16 v29, v54, v54
    v_dot2c_f32_bf16 v239, v55, v25
    v_dot2c_f32_bf16 v28, v55, v55
    v_dot2c_f32_bf16 v30, v248, v25
    v_dot2c_f32_bf16 v31, v249, v25
    v_dot2c_f32_bf16 v30, v250, v25
    v_mfma_f32_32x32x16_bf16 v[192:207], v[120:123], v[52:55], v[192:207]
    ds_read_b64_tr_b16 v[244:245], v252 offset:12288
    ds_read_b64_tr_b16 v[246:247], v252 offset:13824
    v_dot2c_f32_bf16 v31, v251, v25
    v_mfma_f32_32x32x16_bf16 v[208:223], v[124:127], v[52:55], v[208:223]
    s_waitcnt lgkmcnt(0)
    v_mfma_f32_32x32x16_bf16 v[128:143], v[80:83], v[56:59], v[128:143]
    ds_read_b64_tr_b16 v[104:105], v20 offset:18432
    ds_read_b64_tr_b16 v[106:107], v20 offset:19968
    ds_read_b64_tr_b16 v[108:109], v21 offset:18432
    v_dot2c_f32_bf16 v238, v56, v25
    v_dot2c_f32_bf16 v29, v56, v56
    v_dot2c_f32_bf16 v239, v57, v25
    v_dot2c_f32_bf16 v28, v57, v57
    v_dot2c_f32_bf16 v238, v58, v25
    v_dot2c_f32_bf16 v29, v58, v58
    v_mfma_f32_32x32x16_bf16 v[144:159], v[84:87], v[56:59], v[144:159]
    ds_read_b64_tr_b16 v[110:111], v21 offset:19968
    ds_read_b64_tr_b16 v[112:113], v20 offset:18560
    ds_read_b64_tr_b16 v[114:115], v20 offset:20096
    v_dot2c_f32_bf16 v239, v59, v25
    v_dot2c_f32_bf16 v28, v59, v59
    v_dot2c_f32_bf16 v30, v244, v25
    v_dot2c_f32_bf16 v31, v245, v25
    v_dot2c_f32_bf16 v30, v246, v25
    v_dot2c_f32_bf16 v31, v247, v25
    v_mfma_f32_32x32x16_bf16 v[160:175], v[88:91], v[56:59], v[160:175]
    ds_read_b64_tr_b16 v[116:117], v21 offset:18560
    ds_read_b64_tr_b16 v[118:119], v21 offset:20096
    ds_read_b64_tr_b16 v[120:121], v20 offset:18688
    v_mfma_f32_32x32x16_bf16 v[176:191], v[92:95], v[56:59], v[176:191]
    ds_read_b64_tr_b16 v[122:123], v20 offset:20224
    ds_read_b64_tr_b16 v[124:125], v21 offset:18688
    ds_read_b64_tr_b16 v[126:127], v21 offset:20224
    v_mfma_f32_32x32x16_bf16 v[192:207], v[96:99], v[56:59], v[192:207]
    ds_read_b64_tr_b16 v[248:249], v252 offset:18432
    ds_read_b64_tr_b16 v[250:251], v252 offset:19968
    v_mfma_f32_32x32x16_bf16 v[208:223], v[100:103], v[56:59], v[208:223]
    s_waitcnt lgkmcnt(0)
    s_barrier
    v_mfma_f32_32x32x16_bf16 v[128:143], v[104:107], v[60:63], v[128:143]
    ds_read_b64_tr_b16 v[80:81], v20 offset:24576
    ds_read_b64_tr_b16 v[82:83], v20 offset:26112
    ds_read_b64_tr_b16 v[84:85], v21 offset:24576
    s_add_u32 s46, s40, 0x480000
    s_add_u32 m0, s37, 0x0
    s_nop 0
    buffer_load_dwordx4 v10, s[12:15], s46 offen lds
    s_add_u32 m0, s37, 0x400
    s_nop 0
    v_mfma_f32_32x32x16_bf16 v[144:159], v[108:111], v[60:63], v[144:159]
    ds_read_b64_tr_b16 v[86:87], v21 offset:26112
    ds_read_b64_tr_b16 v[88:89], v20 offset:24704
    ds_read_b64_tr_b16 v[90:91], v20 offset:26240
    buffer_load_dwordx4 v11, s[12:15], s46 offen lds
    s_add_u32 m0, s37, 0x800
    s_nop 0
    buffer_load_dwordx4 v12, s[12:15], s46 offen lds
    v_dot2c_f32_bf16 v238, v60, v25
    v_dot2c_f32_bf16 v29, v60, v60
    v_mfma_f32_32x32x16_bf16 v[160:175], v[112:115], v[60:63], v[160:175]
    ds_read_b64_tr_b16 v[92:93], v21 offset:24704
    ds_read_b64_tr_b16 v[94:95], v21 offset:26240
    ds_read_b64_tr_b16 v[96:97], v20 offset:24832
    v_dot2c_f32_bf16 v239, v61, v25
    v_dot2c_f32_bf16 v28, v61, v61
    v_dot2c_f32_bf16 v238, v62, v25
    v_dot2c_f32_bf16 v29, v62, v62
    v_dot2c_f32_bf16 v239, v63, v25
    v_dot2c_f32_bf16 v28, v63, v63
    v_mfma_f32_32x32x16_bf16 v[176:191], v[116:119], v[60:63], v[176:191]
    ds_read_b64_tr_b16 v[98:99], v20 offset:26368
    ds_read_b64_tr_b16 v[100:101], v21 offset:24832
    ds_read_b64_tr_b16 v[102:103], v21 offset:26368
    v_dot2c_f32_bf16 v30, v248, v25
    v_dot2c_f32_bf16 v31, v249, v25
    v_dot2c_f32_bf16 v30, v250, v25
    v_dot2c_f32_bf16 v31, v251, v25
    v_mfma_f32_32x32x16_bf16 v[192:207], v[120:123], v[60:63], v[192:207]
    ds_read_b64_tr_b16 v[244:245], v252 offset:24576
    ds_read_b64_tr_b16 v[246:247], v252 offset:26112
    v_mfma_f32_32x32x16_bf16 v[208:223], v[124:127], v[60:63], v[208:223]
    s_waitcnt lgkmcnt(0)
    s_waitcnt vmcnt(12)
    v_mfma_f32_32x32x16_bf16 v[128:143], v[80:83], v[64:67], v[128:143]
    ds_read_b128 v[32:35], v13 offset:0
    ds_read_b128 v[36:39], v14 offset:0
    ds_read_b128 v[40:43], v15 offset:0
    v_dot2c_f32_bf16 v238, v64, v25
    v_dot2c_f32_bf16 v29, v64, v64
    v_dot2c_f32_bf16 v239, v65, v25
    v_dot2c_f32_bf16 v28, v65, v65
    v_dot2c_f32_bf16 v238, v66, v25
    v_dot2c_f32_bf16 v29, v66, v66
    v_mfma_f32_32x32x16_bf16 v[144:159], v[84:87], v[64:67], v[144:159]
    ds_read_b128 v[44:47], v16 offset:0
    ds_read_b64_tr_b16 v[104:105], v20 offset:30720
    ds_read_b64_tr_b16 v[106:107], v20 offset:32256
    v_dot2c_f32_bf16 v239, v67, v25
    v_dot2c_f32_bf16 v28, v67, v67
    v_dot2c_f32_bf16 v30, v244, v25
    v_dot2c_f32_bf16 v31, v245, v25
    v_dot2c_f32_bf16 v30, v246, v25
    v_dot2c_f32_bf16 v31, v247, v25
    v_mfma_f32_32x32x16_bf16 v[160:175], v[88:91], v[64:67], v[160:175]
    ds_read_b64_tr_b16 v[108:109], v21 offset:30720
    ds_read_b64_tr_b16 v[110:111], v21 offset:32256
    ds_read_b64_tr_b16 v[112:113], v20 offset:30848
    v_mfma_f32_32x32x16_bf16 v[176:191], v[92:95], v[64:67], v[176:191]
    ds_read_b64_tr_b16 v[114:115], v20 offset:32384
    ds_read_b64_tr_b16 v[116:117], v21 offset:30848
    ds_read_b64_tr_b16 v[118:119], v21 offset:32384
    v_mfma_f32_32x32x16_bf16 v[192:207], v[96:99], v[64:67], v[192:207]
    ds_read_b64_tr_b16 v[120:121], v20 offset:30976
    ds_read_b64_tr_b16 v[122:123], v20 offset:32512
    ds_read_b64_tr_b16 v[124:125], v21 offset:30976
    v_mfma_f32_32x32x16_bf16 v[208:223], v[100:103], v[64:67], v[208:223]
    ds_read_b64_tr_b16 v[126:127], v21 offset:32512
    ds_read_b64_tr_b16 v[248:249], v252 offset:30720
    ds_read_b64_tr_b16 v[250:251], v252 offset:32256
    s_waitcnt lgkmcnt(0)
    v_mfma_f32_32x32x16_bf16 v[128:143], v[104:107], v[68:71], v[128:143]
    ds_read_b64_tr_b16 v[80:81], v20 offset:36864
    ds_read_b64_tr_b16 v[82:83], v20 offset:38400
    ds_read_b64_tr_b16 v[84:85], v21 offset:36864
    s_mov_b32 s48, 1024
    s_add_u32 m0, s49, 0x0
    s_nop 0
    buffer_load_dwordx4 v5, s[8:11], s48 offen lds
    s_add_u32 m0, s49, 0x400
    s_nop 0
    v_mfma_f32_32x32x16_bf16 v[144:159], v[108:111], v[68:71], v[144:159]
    ds_read_b64_tr_b16 v[86:87], v21 offset:38400
    ds_read_b64_tr_b16 v[88:89], v20 offset:36992
    ds_read_b64_tr_b16 v[90:91], v20 offset:38528
    buffer_load_dwordx4 v6, s[8:11], s48 offen lds
    s_add_u32 m0, s49, 0x800
    s_nop 0
    buffer_load_dwordx4 v7, s[8:11], s48 offen lds
    s_add_u32 m0, s49, 0xc00
    s_nop 0
    v_mfma_f32_32x32x16_bf16 v[160:175], v[112:115], v[68:71], v[160:175]
    ds_read_b64_tr_b16 v[92:93], v21 offset:36992
    ds_read_b64_tr_b16 v[94:95], v21 offset:38528
    ds_read_b64_tr_b16 v[96:97], v20 offset:37120
    buffer_load_dwordx4 v8, s[8:11], s48 offen lds
    v_dot2c_f32_bf16 v238, v68, v25
    v_dot2c_f32_bf16 v29, v68, v68
    v_dot2c_f32_bf16 v239, v69, v25
    v_dot2c_f32_bf16 v28, v69, v69
    v_dot2c_f32_bf16 v238, v70, v25
    v_mfma_f32_32x32x16_bf16 v[176:191], v[116:119], v[68:71], v[176:191]
    ds_read_b64_tr_b16 v[98:99], v20 offset:38656
    ds_read_b64_tr_b16 v[100:101], v21 offset:37120
    ds_read_b64_tr_b16 v[102:103], v21 offset:38656
    v_dot2c_f32_bf16 v29, v70, v70
    v_dot2c_f32_bf16 v239, v71, v25
    v_dot2c_f32_bf16 v28, v71, v71
    v_dot2c_f32_bf16 v30, v248, v25
    v_dot2c_f32_bf16 v31, v249, v25
    v_dot2c_f32_bf16 v30, v250, v25
    v_mfma_f32_32x32x16_bf16 v[192:207], v[120:123], v[68:71], v[192:207]
    ds_read_b64_tr_b16 v[244:245], v252 offset:36864
    ds_read_b64_tr_b16 v[246:247], v252 offset:38400
    v_dot2c_f32_bf16 v31, v251, v25
    v_mfma_f32_32x32x16_bf16 v[208:223], v[124:127], v[68:71], v[208:223]
    s_lshl_b32 s58, s2, 3
    s_add_u32 s58, s58, s26
    s_add_u32 s58, s58, 3840
    s_mov_b32 s62, 0x800000
    s_mov_b32 s63, 0x00020000
    s_cmp_lt_u32 s58, 2048
    s_cselect_b32 s60, s52, s54
    s_cselect_b32 s61, s53, s55
    s_and_b32 s59, s58, 2047
    s_cmp_lt_u32 s58, 4096
    s_cselect_b32 s62, s62, 0
    s_lshl_b32 s59, s59, 12
    v_lshlrev_b32 v18, 6, v2
    buffer_load_dword v17, v18, s[60:63], s59 offen
    s_waitcnt lgkmcnt(0)
    v_mfma_f32_32x32x16_bf16 v[128:143], v[80:83], v[72:75], v[128:143]
    ds_read_b64_tr_b16 v[104:105], v20 offset:43008
    ds_read_b64_tr_b16 v[106:107], v20 offset:44544
    ds_read_b64_tr_b16 v[108:109], v21 offset:43008
    v_dot2c_f32_bf16 v238, v72, v25
    v_dot2c_f32_bf16 v29, v72, v72
    v_dot2c_f32_bf16 v239, v73, v25
    v_dot2c_f32_bf16 v28, v73, v73
    v_dot2c_f32_bf16 v238, v74, v25
    v_dot2c_f32_bf16 v29, v74, v74
    v_mfma_f32_32x32x16_bf16 v[144:159], v[84:87], v[72:75], v[144:159]
    ds_read_b64_tr_b16 v[110:111], v21 offset:44544
    ds_read_b64_tr_b16 v[112:113], v20 offset:43136
    ds_read_b64_tr_b16 v[114:115], v20 offset:44672
    v_dot2c_f32_bf16 v239, v75, v25
    v_dot2c_f32_bf16 v28, v75, v75
    v_dot2c_f32_bf16 v30, v244, v25
    v_dot2c_f32_bf16 v31, v245, v25
    v_dot2c_f32_bf16 v30, v246, v25
    v_dot2c_f32_bf16 v31, v247, v25
    v_mfma_f32_32x32x16_bf16 v[160:175], v[88:91], v[72:75], v[160:175]
    ds_read_b64_tr_b16 v[116:117], v21 offset:43136
    ds_read_b64_tr_b16 v[118:119], v21 offset:44672
    ds_read_b64_tr_b16 v[120:121], v20 offset:43264
    v_mfma_f32_32x32x16_bf16 v[176:191], v[92:95], v[72:75], v[176:191]
    ds_read_b64_tr_b16 v[122:123], v20 offset:44800
    ds_read_b64_tr_b16 v[124:125], v21 offset:43264
    ds_read_b64_tr_b16 v[126:127], v21 offset:44800
    v_mfma_f32_32x32x16_bf16 v[192:207], v[96:99], v[72:75], v[192:207]
    ds_read_b64_tr_b16 v[248:249], v252 offset:43008
    ds_read_b64_tr_b16 v[250:251], v252 offset:44544
    v_mfma_f32_32x32x16_bf16 v[208:223], v[100:103], v[72:75], v[208:223]
    s_waitcnt vmcnt(5) lgkmcnt(0)
    s_barrier
    v_mfma_f32_32x32x16_bf16 v[128:143], v[104:107], v[76:79], v[128:143]
    v_dot2c_f32_bf16 v238, v76, v25
    v_dot2c_f32_bf16 v29, v76, v76
    v_dot2c_f32_bf16 v239, v77, v25
    v_dot2c_f32_bf16 v28, v77, v77
    v_dot2c_f32_bf16 v238, v78, v25
    v_dot2c_f32_bf16 v29, v78, v78
    v_mfma_f32_32x32x16_bf16 v[144:159], v[108:111], v[76:79], v[144:159]
    v_dot2c_f32_bf16 v239, v79, v25
    v_dot2c_f32_bf16 v28, v79, v79
    v_dot2c_f32_bf16 v30, v248, v25
    v_dot2c_f32_bf16 v31, v249, v25
    v_dot2c_f32_bf16 v30, v250, v25
    v_dot2c_f32_bf16 v31, v251, v25
    v_mfma_f32_32x32x16_bf16 v[160:175], v[112:115], v[76:79], v[160:175]
    v_mfma_f32_32x32x16_bf16 v[176:191], v[116:119], v[76:79], v[176:191]
    v_mfma_f32_32x32x16_bf16 v[192:207], v[120:123], v[76:79], v[192:207]
    v_mfma_f32_32x32x16_bf16 v[208:223], v[124:127], v[76:79], v[208:223]
    v_add_u32 v20, 0xc000, v20
    v_add_u32 v21, 0xc000, v21
    v_add_u32 v252, 0xc000, v252
    ds_read_b64_tr_b16 v[80:81], v20 offset:0
    ds_read_b64_tr_b16 v[82:83], v20 offset:1536
    ds_read_b64_tr_b16 v[84:85], v20 offset:6144
    ds_read_b64_tr_b16 v[86:87], v20 offset:7680
    ds_read_b64_tr_b16 v[88:89], v20 offset:12288
    ds_read_b64_tr_b16 v[90:91], v20 offset:13824
    ds_read_b64_tr_b16 v[92:93], v20 offset:18432
    ds_read_b64_tr_b16 v[94:95], v20 offset:19968
    ds_read_b64_tr_b16 v[120:121], v252 offset:0
    ds_read_b64_tr_b16 v[122:123], v252 offset:1536
    ds_read_b64_tr_b16 v[124:125], v252 offset:6144
    ds_read_b64_tr_b16 v[126:127], v252 offset:7680
    s_waitcnt lgkmcnt(0)
    v_dot2c_f32_bf16 v30, v120, v25
    v_dot2c_f32_bf16 v31, v121, v25
    v_dot2c_f32_bf16 v30, v122, v25
    v_dot2c_f32_bf16 v31, v123, v25
    v_dot2c_f32_bf16 v30, v124, v25
    v_dot2c_f32_bf16 v31, v125, v25
    v_dot2c_f32_bf16 v30, v126, v25
    v_dot2c_f32_bf16 v31, v127, v25
    v_mfma_f32_32x32x16_bf16 v[128:143], v[80:83], v[32:35], v[128:143]
    ds_read_b128 v[48:51], v13 offset:4096
    ds_read_b128 v[52:55], v14 offset:4096
    ds_read_b128 v[56:59], v15 offset:4096
    ds_read_b128 v[60:63], v16 offset:4096
    v_dot2c_f32_bf16 v238, v32, v25
    v_dot2c_f32_bf16 v29, v32, v32
    v_dot2c_f32_bf16 v239, v33, v25
    v_dot2c_f32_bf16 v28, v33, v33
    v_dot2c_f32_bf16 v238, v34, v25
    v_dot2c_f32_bf16 v29, v34, v34
    v_dot2c_f32_bf16 v239, v35, v25
    v_dot2c_f32_bf16 v28, v35, v35
    v_dot2c_f32_bf16 v238, v36, v25
    v_dot2c_f32_bf16 v29, v36, v36
    v_dot2c_f32_bf16 v239, v37, v25
    v_dot2c_f32_bf16 v28, v37, v37
    v_dot2c_f32_bf16 v238, v38, v25
    v_dot2c_f32_bf16 v29, v38, v38
    v_mfma_f32_32x32x16_bf16 v[128:143], v[84:87], v[36:39], v[128:143]
    ds_read_b64_tr_b16 v[96:97], v21 offset:0
    ds_read_b64_tr_b16 v[98:99], v21 offset:1536
    ds_read_b64_tr_b16 v[100:101], v21 offset:6144
    ds_read_b64_tr_b16 v[102:103], v21 offset:7680
    v_dot2c_f32_bf16 v239, v39, v25
    v_dot2c_f32_bf16 v28, v39, v39
    v_dot2c_f32_bf16 v238, v40, v25
    v_dot2c_f32_bf16 v29, v40, v40
    v_dot2c_f32_bf16 v239, v41, v25
    v_dot2c_f32_bf16 v28, v41, v41
    v_dot2c_f32_bf16 v238, v42, v25
    v_dot2c_f32_bf16 v29, v42, v42
    v_dot2c_f32_bf16 v239, v43, v25
    v_dot2c_f32_bf16 v28, v43, v43
    v_dot2c_f32_bf16 v238, v44, v25
    v_dot2c_f32_bf16 v29, v44, v44
    v_dot2c_f32_bf16 v239, v45, v25
    v_dot2c_f32_bf16 v28, v45, v45
    v_mfma_f32_32x32x16_bf16 v[128:143], v[88:91], v[40:43], v[128:143]
    ds_read_b64_tr_b16 v[104:105], v21 offset:12288
    ds_read_b64_tr_b16 v[106:107], v21 offset:13824
    ds_read_b64_tr_b16 v[108:109], v21 offset:18432
    ds_read_b64_tr_b16 v[110:111], v21 offset:19968
    v_dot2c_f32_bf16 v238, v46, v25
    v_dot2c_f32_bf16 v29, v46, v46
    v_dot2c_f32_bf16 v239, v47, v25
    v_dot2c_f32_bf16 v28, v47, v47
    v_mfma_f32_32x32x16_bf16 v[128:143], v[92:95], v[44:47], v[128:143]
    ds_read_b64_tr_b16 v[120:121], v252 offset:12288
    ds_read_b64_tr_b16 v[122:123], v252 offset:13824
    ds_read_b64_tr_b16 v[124:125], v252 offset:18432
    ds_read_b64_tr_b16 v[126:127], v252 offset:19968
    s_waitcnt lgkmcnt(0)
    v_dot2c_f32_bf16 v30, v120, v25
    v_dot2c_f32_bf16 v31, v121, v25
    v_dot2c_f32_bf16 v30, v122, v25
    v_dot2c_f32_bf16 v31, v123, v25
    v_dot2c_f32_bf16 v30, v124, v25
    v_dot2c_f32_bf16 v31, v125, v25
    v_dot2c_f32_bf16 v30, v126, v25
    v_dot2c_f32_bf16 v31, v127, v25
    v_mfma_f32_32x32x16_bf16 v[144:159], v[96:99], v[32:35], v[144:159]
    ds_read_b64_tr_b16 v[80:81], v20 offset:24576
    ds_read_b64_tr_b16 v[82:83], v20 offset:26112
    ds_read_b64_tr_b16 v[84:85], v20 offset:30720
    v_mfma_f32_32x32x16_bf16 v[144:159], v[100:103], v[36:39], v[144:159]
    ds_read_b64_tr_b16 v[86:87], v20 offset:32256
    ds_read_b64_tr_b16 v[88:89], v20 offset:36864
    ds_read_b64_tr_b16 v[90:91], v20 offset:38400
    v_mfma_f32_32x32x16_bf16 v[144:159], v[104:107], v[40:43], v[144:159]
    ds_read_b64_tr_b16 v[92:93], v20 offset:43008
    ds_read_b64_tr_b16 v[94:95], v20 offset:44544
    ds_read_b64_tr_b16 v[120:121], v252 offset:24576
    v_mfma_f32_32x32x16_bf16 v[144:159], v[108:111], v[44:47], v[144:159]
    ds_read_b64_tr_b16 v[122:123], v252 offset:26112
    ds_read_b64_tr_b16 v[124:125], v252 offset:30720
    ds_read_b64_tr_b16 v[126:127], v252 offset:32256
    s_waitcnt lgkmcnt(0)
    v_dot2c_f32_bf16 v30, v120, v25
    v_dot2c_f32_bf16 v31, v121, v25
    v_dot2c_f32_bf16 v30, v122, v25
    v_dot2c_f32_bf16 v31, v123, v25
    v_dot2c_f32_bf16 v30, v124, v25
    v_dot2c_f32_bf16 v31, v125, v25
    v_dot2c_f32_bf16 v30, v126, v25
    v_dot2c_f32_bf16 v31, v127, v25
    s_waitcnt vmcnt(1)
    v_mfma_f32_32x32x16_bf16 v[128:143], v[80:83], v[48:51], v[128:143]
    ds_read_b128 v[64:67], v13 offset:0
    ds_read_b128 v[68:71], v14 offset:0
    ds_read_b128 v[72:75], v15 offset:0
    ds_read_b128 v[76:79], v16 offset:0
    v_dot2c_f32_bf16 v238, v48, v25
    v_dot2c_f32_bf16 v29, v48, v48
    v_dot2c_f32_bf16 v239, v49, v25
    v_dot2c_f32_bf16 v28, v49, v49
    v_dot2c_f32_bf16 v238, v50, v25
    v_dot2c_f32_bf16 v29, v50, v50
    v_dot2c_f32_bf16 v239, v51, v25
    v_dot2c_f32_bf16 v28, v51, v51
    v_dot2c_f32_bf16 v238, v52, v25
    v_dot2c_f32_bf16 v29, v52, v52
    v_dot2c_f32_bf16 v239, v53, v25
    v_dot2c_f32_bf16 v28, v53, v53
    v_dot2c_f32_bf16 v238, v54, v25
    v_dot2c_f32_bf16 v29, v54, v54
    v_mfma_f32_32x32x16_bf16 v[128:143], v[84:87], v[52:55], v[128:143]
    ds_read_b64_tr_b16 v[96:97], v21 offset:24576
    ds_read_b64_tr_b16 v[98:99], v21 offset:26112
    ds_read_b64_tr_b16 v[100:101], v21 offset:30720
    ds_read_b64_tr_b16 v[102:103], v21 offset:32256
    v_dot2c_f32_bf16 v239, v55, v25
    v_dot2c_f32_bf16 v28, v55, v55
    v_dot2c_f32_bf16 v238, v56, v25
    v_dot2c_f32_bf16 v29, v56, v56
    v_dot2c_f32_bf16 v239, v57, v25
    v_dot2c_f32_bf16 v28, v57, v57
    v_dot2c_f32_bf16 v238, v58, v25
    v_dot2c_f32_bf16 v29, v58, v58
    v_dot2c_f32_bf16 v239, v59, v25
    v_dot2c_f32_bf16 v28, v59, v59
    v_dot2c_f32_bf16 v238, v60, v25
    v_dot2c_f32_bf16 v29, v60, v60
    v_dot2c_f32_bf16 v239, v61, v25
    v_dot2c_f32_bf16 v28, v61, v61
    v_mfma_f32_32x32x16_bf16 v[128:143], v[88:91], v[56:59], v[128:143]
    ds_read_b64_tr_b16 v[104:105], v21 offset:36864
    ds_read_b64_tr_b16 v[106:107], v21 offset:38400
    ds_read_b64_tr_b16 v[108:109], v21 offset:43008
    ds_read_b64_tr_b16 v[110:111], v21 offset:44544
    v_dot2c_f32_bf16 v238, v62, v25
    v_dot2c_f32_bf16 v29, v62, v62
    v_dot2c_f32_bf16 v239, v63, v25
    v_dot2c_f32_bf16 v28, v63, v63
    v_mfma_f32_32x32x16_bf16 v[128:143], v[92:95], v[60:63], v[128:143]
    ds_read_b64_tr_b16 v[120:121], v252 offset:36864
    ds_read_b64_tr_b16 v[122:123], v252 offset:38400
    ds_read_b64_tr_b16 v[124:125], v252 offset:43008
    ds_read_b64_tr_b16 v[126:127], v252 offset:44544
    s_waitcnt lgkmcnt(0)
    v_dot2c_f32_bf16 v30, v120, v25
    v_dot2c_f32_bf16 v31, v121, v25
    v_dot2c_f32_bf16 v30, v122, v25
    v_dot2c_f32_bf16 v31, v123, v25
    v_dot2c_f32_bf16 v30, v124, v25
    v_dot2c_f32_bf16 v31, v125, v25
    v_dot2c_f32_bf16 v30, v126, v25
    v_dot2c_f32_bf16 v31, v127, v25
    v_subrev_u32 v20, 0xc000, v20
    v_subrev_u32 v21, 0xc000, v21
    v_subrev_u32 v252, 0xc000, v252
    v_mfma_f32_32x32x16_bf16 v[144:159], v[96:99], v[48:51], v[144:159]
    ds_read_b64_tr_b16 v[80:81], v20 offset:0
    ds_read_b64_tr_b16 v[82:83], v20 offset:1536
    ds_read_b64_tr_b16 v[84:85], v20 offset:6144
    v_mfma_f32_32x32x16_bf16 v[144:159], v[100:103], v[52:55], v[144:159]
    ds_read_b64_tr_b16 v[86:87], v20 offset:7680
    ds_read_b64_tr_b16 v[88:89], v20 offset:12288
    ds_read_b64_tr_b16 v[90:91], v20 offset:13824
    v_mfma_f32_32x32x16_bf16 v[144:159], v[104:107], v[56:59], v[144:159]
    ds_read_b64_tr_b16 v[92:93], v20 offset:18432
    ds_read_b64_tr_b16 v[94:95], v20 offset:19968
    ds_read_b64_tr_b16 v[120:121], v252 offset:0
    v_mfma_f32_32x32x16_bf16 v[144:159], v[108:111], v[60:63], v[144:159]
    ds_read_b64_tr_b16 v[122:123], v252 offset:1536
    ds_read_b64_tr_b16 v[124:125], v252 offset:6144
    ds_read_b64_tr_b16 v[126:127], v252 offset:7680
    s_waitcnt lgkmcnt(0)
    v_dot2c_f32_bf16 v30, v120, v25
    v_dot2c_f32_bf16 v31, v121, v25
    v_dot2c_f32_bf16 v30, v122, v25
    v_dot2c_f32_bf16 v31, v123, v25
    v_dot2c_f32_bf16 v30, v124, v25
    v_dot2c_f32_bf16 v31, v125, v25
    v_dot2c_f32_bf16 v30, v126, v25
    v_dot2c_f32_bf16 v31, v127, v25
    v_mfma_f32_32x32x16_bf16 v[128:143], v[80:83], v[64:67], v[128:143]
    ds_read_b64_tr_b16 v[96:97], v21 offset:0
    ds_read_b64_tr_b16 v[98:99], v21 offset:1536
    ds_read_b64_tr_b16 v[100:101], v21 offset:6144
    v_dot2c_f32_bf16 v238, v64, v25
    v_dot2c_f32_bf16 v29, v64, v64
    v_dot2c_f32_bf16 v239, v65, v25
    v_dot2c_f32_bf16 v28, v65, v65
    v_dot2c_f32_bf16 v238, v66, v25
    v_dot2c_f32_bf16 v29, v66, v66
    v_dot2c_f32_bf16 v239, v67, v25
    v_dot2c_f32_bf16 v28, v67, v67
    v_dot2c_f32_bf16 v238, v68, v25
    v_dot2c_f32_bf16 v29, v68, v68
    v_dot2c_f32_bf16 v239, v69, v25
    v_dot2c_f32_bf16 v28, v69, v69
    v_dot2c_f32_bf16 v238, v70, v25
    v_dot2c_f32_bf16 v29, v70, v70
    v_mfma_f32_32x32x16_bf16 v[128:143], v[84:87], v[68:71], v[128:143]
    ds_read_b64_tr_b16 v[102:103], v21 offset:7680
    ds_read_b64_tr_b16 v[104:105], v21 offset:12288
    ds_read_b64_tr_b16 v[106:107], v21 offset:13824
    v_dot2c_f32_bf16 v239, v71, v25
    v_dot2c_f32_bf16 v28, v71, v71
    v_dot2c_f32_bf16 v238, v72, v25
    v_dot2c_f32_bf16 v29, v72, v72
    v_dot2c_f32_bf16 v239, v73, v25
    v_dot2c_f32_bf16 v28, v73, v73
    v_dot2c_f32_bf16 v238, v74, v25
    v_dot2c_f32_bf16 v29, v74, v74
    v_dot2c_f32_bf16 v239, v75, v25
    v_dot2c_f32_bf16 v28, v75, v75
    v_dot2c_f32_bf16 v238, v76, v25
    v_dot2c_f32_bf16 v29, v76, v76
    v_dot2c_f32_bf16 v239, v77, v25
    v_dot2c_f32_bf16 v28, v77, v77
    v_mfma_f32_32x32x16_bf16 v[128:143], v[88:91], v[72:75], v[128:143]
    ds_read_b64_tr_b16 v[108:109], v21 offset:18432
    ds_read_b64_tr_b16 v[110:111], v21 offset:19968
    ds_read_b64_tr_b16 v[120:121], v252 offset:12288
    v_dot2c_f32_bf16 v238, v78, v25
    v_dot2c_f32_bf16 v29, v78, v78
    v_dot2c_f32_bf16 v239, v79, v25
    v_dot2c_f32_bf16 v28, v79, v79
    v_mfma_f32_32x32x16_bf16 v[128:143], v[92:95], v[76:79], v[128:143]
    ds_read_b64_tr_b16 v[122:123], v252 offset:13824
    ds_read_b64_tr_b16 v[124:125], v252 offset:18432
    ds_read_b64_tr_b16 v[126:127], v252 offset:19968
    s_waitcnt lgkmcnt(0)
    v_dot2c_f32_bf16 v30, v120, v25
    v_dot2c_f32_bf16 v31, v121, v25
    v_dot2c_f32_bf16 v30, v122, v25
    v_dot2c_f32_bf16 v31, v123, v25
    v_dot2c_f32_bf16 v30, v124, v25
    v_dot2c_f32_bf16 v31, v125, v25
    v_dot2c_f32_bf16 v30, v126, v25
    v_dot2c_f32_bf16 v31, v127, v25
    v_add_u32 v20, 0xc000, v20
    v_add_u32 v21, 0xc000, v21
    v_add_u32 v252, 0xc000, v252
    v_mfma_f32_32x32x16_bf16 v[144:159], v[96:99], v[64:67], v[144:159]
    ds_read_b64_tr_b16 v[80:81], v20 offset:128
    ds_read_b64_tr_b16 v[82:83], v20 offset:1664
    v_mfma_f32_32x32x16_bf16 v[144:159], v[100:103], v[68:71], v[144:159]
    ds_read_b64_tr_b16 v[84:85], v20 offset:6272
    ds_read_b64_tr_b16 v[86:87], v20 offset:7808
    v_mfma_f32_32x32x16_bf16 v[144:159], v[104:107], v[72:75], v[144:159]
    ds_read_b64_tr_b16 v[88:89], v20 offset:12416
    ds_read_b64_tr_b16 v[90:91], v20 offset:13952
    v_mfma_f32_32x32x16_bf16 v[144:159], v[108:111], v[76:79], v[144:159]
    ds_read_b64_tr_b16 v[92:93], v20 offset:18560
    ds_read_b64_tr_b16 v[94:95], v20 offset:20096
    s_waitcnt lgkmcnt(0)
    v_mfma_f32_32x32x16_bf16 v[160:175], v[80:83], v[32:35], v[160:175]
    ds_read_b64_tr_b16 v[96:97], v20 offset:24704
    ds_read_b64_tr_b16 v[98:99], v20 offset:26240
    s_nop 3
    v_add_f32 v29, v29, v28
    v_add_f32 v30, v30, v31
    v_add_f32 v28, v238, v239
    v_mov_b32 v224, v28
    v_mov_b32 v225, v28
    s_nop 1
    v_permlane32_swap_b32 v224, v225
    s_nop 1
    v_add_f32 v28, v224, v225
    v_mov_b32 v226, v29
    v_mov_b32 v227, v29
    s_nop 1
    v_permlane32_swap_b32 v226, v227
    v_mfma_f32_32x32x16_bf16 v[160:175], v[84:87], v[36:39], v[160:175]
    ds_read_b64_tr_b16 v[100:101], v20 offset:30848
    ds_read_b64_tr_b16 v[102:103], v20 offset:32384
    s_nop 1
    v_add_f32 v29, v226, v227
    v_mov_b32 v228, v30
    v_mov_b32 v229, v30
    s_nop 1
    v_permlane32_swap_b32 v228, v229
    s_nop 1
    v_add_f32 v30, v228, v229
    v_mul_f32 v28, 0x3ae38e39, v28
    v_mul_f32 v29, 0x3ae38e39, v29
    v_fma_f32 v29, -v28, v28, v29
    v_max_f32 v29, 0, v29
    v_mov_b32 v224, v28
    v_cvt_pk_bf16_f32 v224, v224, v224
    v_mfma_f32_32x32x16_bf16 v[160:175], v[88:91], v[40:43], v[160:175]
    ds_read_b64_tr_b16 v[104:105], v20 offset:36992
    ds_read_b64_tr_b16 v[106:107], v20 offset:38528
    v_lshlrev_b32 v224, 16, v224
    v_mov_b32 v225, v29
    v_cvt_pk_bf16_f32 v225, v225, v225
    v_lshlrev_b32 v225, 16, v225
    v_add_f32 v225, 0x3727c5ac, v225
    v_cvt_pk_bf16_f32 v225, v225, v225
    v_lshlrev_b32 v225, 16, v225
    v_sqrt_f32 v225, v225
    s_nop 0
    v_cvt_pk_bf16_f32 v225, v225, v225
    v_lshlrev_b32 v225, 16, v225
    v_rcp_f32 v240, v225
    v_mfma_f32_32x32x16_bf16 v[160:175], v[92:95], v[44:47], v[160:175]
    ds_read_b64_tr_b16 v[108:109], v20 offset:43136
    ds_read_b64_tr_b16 v[110:111], v20 offset:44672
    s_nop 0
    v_mul_f32 v241, v224, v240
    v_sub_f32 v226, v28, v224
    v_mul_f32 v226, v226, v240
    v_cvt_pk_bf16_f32 v226, v226, v226
    v_lshlrev_b32 v226, 16, v226
    v_mul_f32 v227, v240, v240
    v_mul_f32 v227, v227, v29
    v_cvt_pk_bf16_f32 v227, v227, v227
    v_lshlrev_b32 v227, 16, v227
    v_add_f32 v227, 0x3727c5ac, v227
    v_cvt_pk_bf16_f32 v227, v227, v227
    v_lshlrev_b32 v227, 16, v227
    v_sqrt_f32 v227, v227
    s_waitcnt lgkmcnt(0)
    v_subrev_u32 v20, 0xc000, v20
    v_subrev_u32 v21, 0xc000, v21
    v_mfma_f32_32x32x16_bf16 v[160:175], v[96:99], v[48:51], v[160:175]
    ds_read_b64_tr_b16 v[80:81], v20 offset:128
    ds_read_b64_tr_b16 v[82:83], v20 offset:1664
    s_nop 0
    v_cvt_pk_bf16_f32 v227, v227, v227
    v_lshlrev_b32 v227, 16, v227
    v_rcp_f32 v227, v227
    s_nop 0
    v_add_f32 v241, v241, v226
    v_mul_f32 v241, v241, v227
    v_mul_f32 v240, v240, v227
    v_sub_f32 v241, 0, v241
    s_lshl_b32 s42, s26, 7
    s_add_u32 s42, s42, 24576
    v_lshlrev_b32 v228, 2, v3
    v_add_u32 v228, s42, v228
    v_mfma_f32_32x32x16_bf16 v[160:175], v[100:103], v[52:55], v[160:175]
    ds_read_b64_tr_b16 v[84:85], v20 offset:6272
    ds_read_b64_tr_b16 v[86:87], v20 offset:7808
    ds_write_b32 v228, v30
    v_lshlrev_b32 v229, 16, v26
    ds_write_b32 v228, v229 offset:1024
    v_lshlrev_b32 v26, 4, v4
    v_add_u32 v26, 24576, v26
    s_waitcnt lgkmcnt(0)
    s_barrier
    v_mfma_f32_32x32x16_bf16 v[160:175], v[104:107], v[56:59], v[160:175]
    ds_read_b64_tr_b16 v[88:89], v20 offset:12416
    ds_read_b64_tr_b16 v[90:91], v20 offset:13952
    v_mfma_f32_32x32x16_bf16 v[160:175], v[108:111], v[60:63], v[160:175]
    ds_read_b64_tr_b16 v[92:93], v20 offset:18560
    ds_read_b64_tr_b16 v[94:95], v20 offset:20096
    s_waitcnt lgkmcnt(0)
    v_add_u32 v20, 0xc000, v20
    v_add_u32 v21, 0xc000, v21
    v_mfma_f32_32x32x16_bf16 v[160:175], v[80:83], v[64:67], v[160:175]
    ds_read_b64_tr_b16 v[96:97], v21 offset:128
    ds_read_b64_tr_b16 v[98:99], v21 offset:1664
    ds_read_b128 v[224:227], v26 offset:0
    ds_read_b128 v[232:235], v26 offset:1024
    ds_read_b128 v[228:231], v26 offset:32
    ds_read_b128 v[236:239], v26 offset:1056
    s_waitcnt lgkmcnt(0)
    v_fma_f32 v112, v224, v241, v232
    v_fma_f32 v113, v225, v241, v233
    v_fma_f32 v114, v226, v241, v234
    v_fma_f32 v115, v227, v241, v235
    v_fma_f32 v116, v228, v241, v236
    v_fma_f32 v117, v229, v241, v237
    v_fma_f32 v118, v230, v241, v238
    v_fma_f32 v119, v231, v241, v239
    v_fma_f32 v128, v128, v240, v112
    v_mfma_f32_32x32x16_bf16 v[160:175], v[84:87], v[68:71], v[160:175]
    ds_read_b64_tr_b16 v[100:101], v21 offset:6272
    ds_read_b64_tr_b16 v[102:103], v21 offset:7808
    v_fma_f32 v129, v129, v240, v113
    v_fma_f32 v130, v130, v240, v114
    v_fma_f32 v131, v131, v240, v115
    v_fma_f32 v132, v132, v240, v116
    v_fma_f32 v133, v133, v240, v117
    v_fma_f32 v134, v134, v240, v118
    v_fma_f32 v135, v135, v240, v119
    v_mul_f32 v112, v128, v128
    v_mul_f32 v113, v129, v129
    v_mul_f32 v114, v130, v130
    v_mul_f32 v115, v131, v131
    v_mul_f32 v116, v132, v132
    v_mul_f32 v117, v133, v133
    v_mul_f32 v118, v134, v134
    v_mfma_f32_32x32x16_bf16 v[160:175], v[88:91], v[72:75], v[160:175]
    ds_read_b64_tr_b16 v[104:105], v21 offset:12416
    ds_read_b64_tr_b16 v[106:107], v21 offset:13952
    v_mul_f32 v119, v135, v135
    v_fma_f32 v112, v112, s44, v27
    v_fma_f32 v113, v113, s44, v27
    v_fma_f32 v114, v114, s44, v27
    v_fma_f32 v115, v115, s44, v27
    v_fma_f32 v116, v116, s44, v27
    v_fma_f32 v117, v117, s44, v27
    v_fma_f32 v118, v118, s44, v27
    v_fma_f32 v119, v119, s44, v27
    v_mul_f32 v112, v112, v128
    v_mul_f32 v113, v113, v129
    v_mul_f32 v114, v114, v130
    v_mul_f32 v115, v115, v131
    v_mul_f32 v116, v116, v132
    v_mfma_f32_32x32x16_bf16 v[160:175], v[92:95], v[76:79], v[160:175]
    ds_read_b64_tr_b16 v[108:109], v21 offset:18560
    ds_read_b64_tr_b16 v[110:111], v21 offset:20096
    v_mul_f32 v117, v117, v133
    v_mul_f32 v118, v118, v134
    v_mul_f32 v119, v119, v135
    v_exp_f32 v112, v112
    v_exp_f32 v113, v113
    v_exp_f32 v114, v114
    v_exp_f32 v115, v115
    v_exp_f32 v116, v116
    v_exp_f32 v117, v117
    s_waitcnt lgkmcnt(0)
    v_mfma_f32_32x32x16_bf16 v[176:191], v[96:99], v[32:35], v[176:191]
    ds_read_b64_tr_b16 v[80:81], v21 offset:24704
    ds_read_b64_tr_b16 v[82:83], v21 offset:26240
    v_exp_f32 v118, v118
    v_exp_f32 v119, v119
    v_add_f32 v112, 1.0, v112
    v_add_f32 v113, 1.0, v113
    v_add_f32 v114, 1.0, v114
    v_add_f32 v115, 1.0, v115
    v_add_f32 v116, 1.0, v116
    v_add_f32 v117, 1.0, v117
    v_add_f32 v118, 1.0, v118
    v_add_f32 v119, 1.0, v119
    v_rcp_f32 v112, v112
    v_mfma_f32_32x32x16_bf16 v[176:191], v[100:103], v[36:39], v[176:191]
    ds_read_b64_tr_b16 v[84:85], v21 offset:30848
    ds_read_b64_tr_b16 v[86:87], v21 offset:32384
    v_rcp_f32 v113, v113
    v_rcp_f32 v114, v114
    v_rcp_f32 v115, v115
    v_rcp_f32 v116, v116
    v_rcp_f32 v117, v117
    v_rcp_f32 v118, v118
    v_rcp_f32 v119, v119
    v_mfma_f32_32x32x16_bf16 v[176:191], v[104:107], v[40:43], v[176:191]
    ds_read_b64_tr_b16 v[88:89], v21 offset:36992
    ds_read_b64_tr_b16 v[90:91], v21 offset:38528
    v_mul_f32 v128, v112, v128
    v_mul_f32 v129, v113, v129
    v_mul_f32 v130, v114, v130
    v_mul_f32 v131, v115, v131
    v_mul_f32 v132, v116, v132
    v_mul_f32 v133, v117, v133
    v_mul_f32 v134, v118, v134
    v_mul_f32 v135, v119, v135
    v_cvt_pk_bf16_f32 v128, v128, v129
    v_cvt_pk_bf16_f32 v129, v130, v131
    v_cvt_pk_bf16_f32 v130, v132, v133
    v_cvt_pk_bf16_f32 v131, v134, v135
    s_nop 1
    v_permlane32_swap_b32 v128, v130
    v_mfma_f32_32x32x16_bf16 v[176:191], v[108:111], v[44:47], v[176:191]
    ds_read_b64_tr_b16 v[92:93], v21 offset:43136
    ds_read_b64_tr_b16 v[94:95], v21 offset:44672
    v_permlane32_swap_b32 v129, v131
    buffer_store_dwordx4 v[128:131], v24, s[16:19], 0 offen offset:0
    ds_read_b128 v[224:227], v26 offset:64
    ds_read_b128 v[232:235], v26 offset:1088
    ds_read_b128 v[228:231], v26 offset:96
    ds_read_b128 v[236:239], v26 offset:1120
    s_waitcnt lgkmcnt(0)
    v_fma_f32 v112, v224, v241, v232
    v_fma_f32 v113, v225, v241, v233
    v_fma_f32 v114, v226, v241, v234
    v_fma_f32 v115, v227, v241, v235
    v_fma_f32 v116, v228, v241, v236
    v_fma_f32 v117, v229, v241, v237
    v_fma_f32 v118, v230, v241, v238
    s_waitcnt lgkmcnt(0)
    v_subrev_u32 v20, 0xc000, v20
    v_subrev_u32 v21, 0xc000, v21
    v_mfma_f32_32x32x16_bf16 v[176:191], v[80:83], v[48:51], v[176:191]
    ds_read_b64_tr_b16 v[96:97], v21 offset:128
    ds_read_b64_tr_b16 v[98:99], v21 offset:1664
    v_fma_f32 v119, v231, v241, v239
    v_fma_f32 v136, v136, v240, v112
    v_fma_f32 v137, v137, v240, v113
    v_fma_f32 v138, v138, v240, v114
    v_fma_f32 v139, v139, v240, v115
    v_fma_f32 v140, v140, v240, v116
    v_fma_f32 v141, v141, v240, v117
    v_fma_f32 v142, v142, v240, v118
    v_fma_f32 v143, v143, v240, v119
    v_mul_f32 v112, v136, v136
    v_mul_f32 v113, v137, v137
    v_mul_f32 v114, v138, v138
    v_mul_f32 v115, v139, v139
    v_mul_f32 v116, v140, v140
    v_mfma_f32_32x32x16_bf16 v[176:191], v[84:87], v[52:55], v[176:191]
    ds_read_b64_tr_b16 v[100:101], v21 offset:6272
    ds_read_b64_tr_b16 v[102:103], v21 offset:7808
    v_mul_f32 v117, v141, v141
    v_mul_f32 v118, v142, v142
    v_mul_f32 v119, v143, v143
    v_fma_f32 v112, v112, s44, v27
    v_fma_f32 v113, v113, s44, v27
    v_fma_f32 v114, v114, s44, v27
    v_fma_f32 v115, v115, s44, v27
    v_fma_f32 v116, v116, s44, v27
    v_fma_f32 v117, v117, s44, v27
    v_fma_f32 v118, v118, s44, v27
    v_fma_f32 v119, v119, s44, v27
    v_mul_f32 v112, v112, v136
    v_mul_f32 v113, v113, v137
    v_mul_f32 v114, v114, v138
    v_mfma_f32_32x32x16_bf16 v[176:191], v[88:91], v[56:59], v[176:191]
    ds_read_b64_tr_b16 v[104:105], v21 offset:12416
    ds_read_b64_tr_b16 v[106:107], v21 offset:13952
    v_mul_f32 v115, v115, v139
    v_mul_f32 v116, v116, v140
    v_mul_f32 v117, v117, v141
    v_mul_f32 v118, v118, v142
    v_mul_f32 v119, v119, v143
    v_exp_f32 v112, v112
    v_exp_f32 v113, v113
    v_exp_f32 v114, v114
    v_exp_f32 v115, v115
    v_exp_f32 v116, v116
    v_mfma_f32_32x32x16_bf16 v[176:191], v[92:95], v[60:63], v[176:191]
    ds_read_b64_tr_b16 v[108:109], v21 offset:18560
    ds_read_b64_tr_b16 v[110:111], v21 offset:20096
    v_exp_f32 v117, v117
    v_exp_f32 v118, v118
    v_exp_f32 v119, v119
    v_add_f32 v112, 1.0, v112
    v_add_f32 v113, 1.0, v113
    v_add_f32 v114, 1.0, v114
    v_add_f32 v115, 1.0, v115
    v_add_f32 v116, 1.0, v116
    v_add_f32 v117, 1.0, v117
    v_add_f32 v118, 1.0, v118
    v_add_f32 v119, 1.0, v119
    s_waitcnt lgkmcnt(0)
    v_add_u32 v20, 0xc000, v20
    v_add_u32 v21, 0xc000, v21
    v_mfma_f32_32x32x16_bf16 v[176:191], v[96:99], v[64:67], v[176:191]
    ds_read_b64_tr_b16 v[80:81], v20 offset:256
    ds_read_b64_tr_b16 v[82:83], v20 offset:1792
    v_rcp_f32 v112, v112
    v_rcp_f32 v113, v113
    v_rcp_f32 v114, v114
    v_rcp_f32 v115, v115
    v_rcp_f32 v116, v116
    v_rcp_f32 v117, v117
    v_rcp_f32 v118, v118
    v_mfma_f32_32x32x16_bf16 v[176:191], v[100:103], v[68:71], v[176:191]
    ds_read_b64_tr_b16 v[84:85], v20 offset:6400
    ds_read_b64_tr_b16 v[86:87], v20 offset:7936
    v_rcp_f32 v119, v119
    v_mul_f32 v136, v112, v136
    v_mul_f32 v137, v113, v137
    v_mul_f32 v138, v114, v138
    v_mul_f32 v139, v115, v139
    v_mul_f32 v140, v116, v140
    v_mul_f32 v141, v117, v141
    v_mul_f32 v142, v118, v142
    v_mul_f32 v143, v119, v143
    v_cvt_pk_bf16_f32 v136, v136, v137
    v_cvt_pk_bf16_f32 v137, v138, v139
    v_cvt_pk_bf16_f32 v138, v140, v141
    v_cvt_pk_bf16_f32 v139, v142, v143
    v_mfma_f32_32x32x16_bf16 v[176:191], v[104:107], v[72:75], v[176:191]
    ds_read_b64_tr_b16 v[88:89], v20 offset:12544
    ds_read_b64_tr_b16 v[90:91], v20 offset:14080
    s_nop 1
    v_permlane32_swap_b32 v136, v138
    v_permlane32_swap_b32 v137, v139
    buffer_store_dwordx4 v[136:139], v24, s[16:19], 0 offen offset:32
    ds_read_b128 v[224:227], v26 offset:128
    ds_read_b128 v[232:235], v26 offset:1152
    ds_read_b128 v[228:231], v26 offset:160
    ds_read_b128 v[236:239], v26 offset:1184
    s_waitcnt lgkmcnt(0)
    v_fma_f32 v112, v224, v241, v232
    v_fma_f32 v113, v225, v241, v233
    v_fma_f32 v114, v226, v241, v234
    v_fma_f32 v115, v227, v241, v235
    v_fma_f32 v116, v228, v241, v236
    v_mfma_f32_32x32x16_bf16 v[176:191], v[108:111], v[76:79], v[176:191]
    ds_read_b64_tr_b16 v[92:93], v20 offset:18688
    ds_read_b64_tr_b16 v[94:95], v20 offset:20224
    v_fma_f32 v117, v229, v241, v237
    v_fma_f32 v118, v230, v241, v238
    v_fma_f32 v119, v231, v241, v239
    v_fma_f32 v144, v144, v240, v112
    v_fma_f32 v145, v145, v240, v113
    v_fma_f32 v146, v146, v240, v114
    v_fma_f32 v147, v147, v240, v115
    v_fma_f32 v148, v148, v240, v116
    v_fma_f32 v149, v149, v240, v117
    v_fma_f32 v150, v150, v240, v118
    v_fma_f32 v151, v151, v240, v119
    v_mul_f32 v112, v144, v144
    v_mul_f32 v113, v145, v145
    v_mul_f32 v114, v146, v146
    s_waitcnt lgkmcnt(0)
    v_mfma_f32_32x32x16_bf16 v[192:207], v[80:83], v[32:35], v[192:207]
    ds_read_b64_tr_b16 v[96:97], v20 offset:24832
    ds_read_b64_tr_b16 v[98:99], v20 offset:26368
    v_mul_f32 v115, v147, v147
    v_mul_f32 v116, v148, v148
    v_mul_f32 v117, v149, v149
    v_mul_f32 v118, v150, v150
    v_mul_f32 v119, v151, v151
    v_fma_f32 v112, v112, s44, v27
    v_fma_f32 v113, v113, s44, v27
    v_fma_f32 v114, v114, s44, v27
    v_fma_f32 v115, v115, s44, v27
    v_fma_f32 v116, v116, s44, v27
    v_fma_f32 v117, v117, s44, v27
    v_fma_f32 v118, v118, s44, v27
    v_fma_f32 v119, v119, s44, v27
    v_mul_f32 v112, v112, v144
    v_mfma_f32_32x32x16_bf16 v[192:207], v[84:87], v[36:39], v[192:207]
    ds_read_b64_tr_b16 v[100:101], v20 offset:30976
    ds_read_b64_tr_b16 v[102:103], v20 offset:32512
    v_mul_f32 v113, v113, v145
    v_mul_f32 v114, v114, v146
    v_mul_f32 v115, v115, v147
    v_mul_f32 v116, v116, v148
    v_mul_f32 v117, v117, v149
    v_mul_f32 v118, v118, v150
    v_mul_f32 v119, v119, v151
    v_exp_f32 v112, v112
    v_exp_f32 v113, v113
    v_exp_f32 v114, v114
    v_exp_f32 v115, v115
    v_mfma_f32_32x32x16_bf16 v[192:207], v[88:91], v[40:43], v[192:207]
    ds_read_b64_tr_b16 v[104:105], v20 offset:37120
    ds_read_b64_tr_b16 v[106:107], v20 offset:38656
    v_exp_f32 v116, v116
    v_exp_f32 v117, v117
    v_exp_f32 v118, v118
    v_exp_f32 v119, v119
    v_add_f32 v112, 1.0, v112
    v_add_f32 v113, 1.0, v113
    v_add_f32 v114, 1.0, v114
    v_add_f32 v115, 1.0, v115
    v_add_f32 v116, 1.0, v116
    v_add_f32 v117, 1.0, v117
    v_mfma_f32_32x32x16_bf16 v[192:207], v[92:95], v[44:47], v[192:207]
    ds_read_b64_tr_b16 v[108:109], v20 offset:43264
    ds_read_b64_tr_b16 v[110:111], v20 offset:44800
    v_add_f32 v118, 1.0, v118
    v_add_f32 v119, 1.0, v119
    v_rcp_f32 v112, v112
    v_rcp_f32 v113, v113
    v_rcp_f32 v114, v114
    v_rcp_f32 v115, v115
    v_rcp_f32 v116, v116
    v_rcp_f32 v117, v117
    s_waitcnt lgkmcnt(0)
    v_subrev_u32 v20, 0xc000, v20
    v_subrev_u32 v21, 0xc000, v21
    v_mfma_f32_32x32x16_bf16 v[192:207], v[96:99], v[48:51], v[192:207]
    ds_read_b64_tr_b16 v[80:81], v20 offset:256
    ds_read_b64_tr_b16 v[82:83], v20 offset:1792
    v_rcp_f32 v118, v118
    v_rcp_f32 v119, v119
    v_mul_f32 v144, v112, v144
    v_mul_f32 v145, v113, v145
    v_mul_f32 v146, v114, v146
    v_mul_f32 v147, v115, v147
    v_mul_f32 v148, v116, v148
    v_mul_f32 v149, v117, v149
    v_mul_f32 v150, v118, v150
    v_mul_f32 v151, v119, v151
    v_cvt_pk_bf16_f32 v144, v144, v145
    v_cvt_pk_bf16_f32 v145, v146, v147
    v_mfma_f32_32x32x16_bf16 v[192:207], v[100:103], v[52:55], v[192:207]
    ds_read_b64_tr_b16 v[84:85], v20 offset:6400
    ds_read_b64_tr_b16 v[86:87], v20 offset:7936
    v_cvt_pk_bf16_f32 v146, v148, v149
    v_cvt_pk_bf16_f32 v147, v150, v151
    s_nop 1
    v_permlane32_swap_b32 v144, v146
    v_permlane32_swap_b32 v145, v147
    buffer_store_dwordx4 v[144:147], v24, s[16:19], 0 offen offset:64
    ds_read_b128 v[224:227], v26 offset:192
    ds_read_b128 v[232:235], v26 offset:1216
    ds_read_b128 v[228:231], v26 offset:224
    ds_read_b128 v[236:239], v26 offset:1248
    s_waitcnt lgkmcnt(0)
    v_fma_f32 v112, v224, v241, v232
    v_fma_f32 v113, v225, v241, v233
    v_fma_f32 v114, v226, v241, v234
    v_mfma_f32_32x32x16_bf16 v[192:207], v[104:107], v[56:59], v[192:207]
    ds_read_b64_tr_b16 v[88:89], v20 offset:12544
    ds_read_b64_tr_b16 v[90:91], v20 offset:14080
    v_fma_f32 v115, v227, v241, v235
    v_fma_f32 v116, v228, v241, v236
    v_fma_f32 v117, v229, v241, v237
    v_fma_f32 v118, v230, v241, v238
    v_fma_f32 v119, v231, v241, v239
    v_fma_f32 v152, v152, v240, v112
    v_fma_f32 v153, v153, v240, v113
    v_fma_f32 v154, v154, v240, v114
    v_fma_f32 v155, v155, v240, v115
    v_fma_f32 v156, v156, v240, v116
    v_fma_f32 v157, v157, v240, v117
    v_fma_f32 v158, v158, v240, v118
    v_fma_f32 v159, v159, v240, v119
    v_mul_f32 v112, v152, v152
    v_mfma_f32_32x32x16_bf16 v[192:207], v[108:111], v[60:63], v[192:207]
    ds_read_b64_tr_b16 v[92:93], v20 offset:18688
    ds_read_b64_tr_b16 v[94:95], v20 offset:20224
    v_mul_f32 v113, v153, v153
    v_mul_f32 v114, v154, v154
    v_mul_f32 v115, v155, v155
    v_mul_f32 v116, v156, v156
    v_mul_f32 v117, v157, v157
    v_mul_f32 v118, v158, v158
    v_mul_f32 v119, v159, v159
    v_fma_f32 v112, v112, s44, v27
    v_fma_f32 v113, v113, s44, v27
    v_fma_f32 v114, v114, s44, v27
    v_fma_f32 v115, v115, s44, v27
    v_fma_f32 v116, v116, s44, v27
    v_fma_f32 v117, v117, s44, v27
    v_fma_f32 v118, v118, s44, v27
    s_waitcnt lgkmcnt(0)
    v_add_u32 v20, 0xc000, v20
    v_add_u32 v21, 0xc000, v21
    v_mfma_f32_32x32x16_bf16 v[192:207], v[80:83], v[64:67], v[192:207]
    ds_read_b64_tr_b16 v[96:97], v21 offset:256
    ds_read_b64_tr_b16 v[98:99], v21 offset:1792
    v_fma_f32 v119, v119, s44, v27
    v_mul_f32 v112, v112, v152
    v_mul_f32 v113, v113, v153
    v_mul_f32 v114, v114, v154
    v_mul_f32 v115, v115, v155
    v_mul_f32 v116, v116, v156
    v_mul_f32 v117, v117, v157
    v_mul_f32 v118, v118, v158
    v_mul_f32 v119, v119, v159
    v_exp_f32 v112, v112
    v_exp_f32 v113, v113
    v_exp_f32 v114, v114
    v_mfma_f32_32x32x16_bf16 v[192:207], v[84:87], v[68:71], v[192:207]
    ds_read_b64_tr_b16 v[100:101], v21 offset:6400
    ds_read_b64_tr_b16 v[102:103], v21 offset:7936
    v_exp_f32 v115, v115
    v_exp_f32 v116, v116
    v_exp_f32 v117, v117
    v_exp_f32 v118, v118
    v_exp_f32 v119, v119
    v_add_f32 v112, 1.0, v112
    v_add_f32 v113, 1.0, v113
    v_add_f32 v114, 1.0, v114
    v_add_f32 v115, 1.0, v115
    v_mfma_f32_32x32x16_bf16 v[192:207], v[88:91], v[72:75], v[192:207]
    ds_read_b64_tr_b16 v[104:105], v21 offset:12544
    ds_read_b64_tr_b16 v[106:107], v21 offset:14080
    v_add_f32 v116, 1.0, v116
    v_add_f32 v117, 1.0, v117
    v_add_f32 v118, 1.0, v118
    v_add_f32 v119, 1.0, v119
    v_rcp_f32 v112, v112
    v_rcp_f32 v113, v113
    v_rcp_f32 v114, v114
    v_rcp_f32 v115, v115
    v_rcp_f32 v116, v116
    v_mfma_f32_32x32x16_bf16 v[192:207], v[92:95], v[76:79], v[192:207]
    ds_read_b64_tr_b16 v[108:109], v21 offset:18688
    ds_read_b64_tr_b16 v[110:111], v21 offset:20224
    v_rcp_f32 v117, v117
    v_rcp_f32 v118, v118
    v_rcp_f32 v119, v119
    v_mul_f32 v152, v112, v152
    v_mul_f32 v153, v113, v153
    v_mul_f32 v154, v114, v154
    v_mul_f32 v155, v115, v155
    v_mul_f32 v156, v116, v156
    v_mul_f32 v157, v117, v157
    v_mul_f32 v158, v118, v158
    v_mul_f32 v159, v119, v159
    s_waitcnt lgkmcnt(0)
    v_mfma_f32_32x32x16_bf16 v[208:223], v[96:99], v[32:35], v[208:223]
    ds_read_b64_tr_b16 v[80:81], v21 offset:24832
    ds_read_b64_tr_b16 v[82:83], v21 offset:26368
    v_cvt_pk_bf16_f32 v152, v152, v153
    v_cvt_pk_bf16_f32 v153, v154, v155
    v_cvt_pk_bf16_f32 v154, v156, v157
    v_cvt_pk_bf16_f32 v155, v158, v159
    s_nop 1
    v_permlane32_swap_b32 v152, v154
    v_permlane32_swap_b32 v153, v155
    buffer_store_dwordx4 v[152:155], v24, s[16:19], 0 offen offset:96
    ds_read_b128 v[224:227], v26 offset:256
    ds_read_b128 v[232:235], v26 offset:1280
    ds_read_b128 v[228:231], v26 offset:288
    ds_read_b128 v[236:239], v26 offset:1312
    s_waitcnt lgkmcnt(0)
    v_fma_f32 v112, v224, v241, v232
    v_mfma_f32_32x32x16_bf16 v[208:223], v[100:103], v[36:39], v[208:223]
    ds_read_b64_tr_b16 v[84:85], v21 offset:30976
    ds_read_b64_tr_b16 v[86:87], v21 offset:32512
    v_fma_f32 v113, v225, v241, v233
    v_fma_f32 v114, v226, v241, v234
    v_fma_f32 v115, v227, v241, v235
    v_fma_f32 v116, v228, v241, v236
    v_fma_f32 v117, v229, v241, v237
    v_fma_f32 v118, v230, v241, v238
    v_fma_f32 v119, v231, v241, v239
    v_fma_f32 v160, v160, v240, v112
    v_fma_f32 v161, v161, v240, v113
    v_fma_f32 v162, v162, v240, v114
    v_fma_f32 v163, v163, v240, v115
    v_fma_f32 v164, v164, v240, v116
    v_fma_f32 v165, v165, v240, v117
    v_fma_f32 v166, v166, v240, v118
    v_mfma_f32_32x32x16_bf16 v[208:223], v[104:107], v[40:43], v[208:223]
    ds_read_b64_tr_b16 v[88:89], v21 offset:37120
    ds_read_b64_tr_b16 v[90:91], v21 offset:38656
    v_fma_f32 v167, v167, v240, v119
    v_mul_f32 v112, v160, v160
    v_mul_f32 v113, v161, v161
    v_mul_f32 v114, v162, v162
    v_mul_f32 v115, v163, v163
    v_mul_f32 v116, v164, v164
    v_mul_f32 v117, v165, v165
    v_mul_f32 v118, v166, v166
    v_mul_f32 v119, v167, v167
    v_fma_f32 v112, v112, s44, v27
    v_fma_f32 v113, v113, s44, v27
    v_fma_f32 v114, v114, s44, v27
    v_fma_f32 v115, v115, s44, v27
    v_fma_f32 v116, v116, s44, v27
    v_mfma_f32_32x32x16_bf16 v[208:223], v[108:111], v[44:47], v[208:223]
    ds_read_b64_tr_b16 v[92:93], v21 offset:43264
    ds_read_b64_tr_b16 v[94:95], v21 offset:44800
    v_fma_f32 v117, v117, s44, v27
    v_fma_f32 v118, v118, s44, v27
    v_fma_f32 v119, v119, s44, v27
    v_mul_f32 v112, v112, v160
    v_mul_f32 v113, v113, v161
    v_mul_f32 v114, v114, v162
    v_mul_f32 v115, v115, v163
    v_mul_f32 v116, v116, v164
    v_mul_f32 v117, v117, v165
    v_mul_f32 v118, v118, v166
    v_mul_f32 v119, v119, v167
    v_exp_f32 v112, v112
    v_exp_f32 v113, v113
    s_waitcnt lgkmcnt(0)
    v_subrev_u32 v20, 0xc000, v20
    v_subrev_u32 v21, 0xc000, v21
    v_mfma_f32_32x32x16_bf16 v[208:223], v[80:83], v[48:51], v[208:223]
    ds_read_b64_tr_b16 v[96:97], v21 offset:256
    ds_read_b64_tr_b16 v[98:99], v21 offset:1792
    v_exp_f32 v114, v114
    v_exp_f32 v115, v115
    v_exp_f32 v116, v116
    v_exp_f32 v117, v117
    v_exp_f32 v118, v118
    v_exp_f32 v119, v119
    v_add_f32 v112, 1.0, v112
    v_add_f32 v113, 1.0, v113
    v_mfma_f32_32x32x16_bf16 v[208:223], v[84:87], v[52:55], v[208:223]
    ds_read_b64_tr_b16 v[100:101], v21 offset:6400
    ds_read_b64_tr_b16 v[102:103], v21 offset:7936
    v_add_f32 v114, 1.0, v114
    v_add_f32 v115, 1.0, v115
    v_add_f32 v116, 1.0, v116
    v_add_f32 v117, 1.0, v117
    v_add_f32 v118, 1.0, v118
    v_add_f32 v119, 1.0, v119
    v_rcp_f32 v112, v112
    v_rcp_f32 v113, v113
    v_rcp_f32 v114, v114
    v_rcp_f32 v115, v115
    v_mfma_f32_32x32x16_bf16 v[208:223], v[88:91], v[56:59], v[208:223]
    ds_read_b64_tr_b16 v[104:105], v21 offset:12544
    ds_read_b64_tr_b16 v[106:107], v21 offset:14080
    v_rcp_f32 v116, v116
    v_rcp_f32 v117, v117
    v_rcp_f32 v118, v118
    v_rcp_f32 v119, v119
    v_mul_f32 v160, v112, v160
    v_mul_f32 v161, v113, v161
    v_mul_f32 v162, v114, v162
    v_mul_f32 v163, v115, v163
    v_mul_f32 v164, v116, v164
    v_mul_f32 v165, v117, v165
    v_mfma_f32_32x32x16_bf16 v[208:223], v[92:95], v[60:63], v[208:223]
    ds_read_b64_tr_b16 v[108:109], v21 offset:18688
    ds_read_b64_tr_b16 v[110:111], v21 offset:20224
    v_mul_f32 v166, v118, v166
    v_mul_f32 v167, v119, v167
    v_cvt_pk_bf16_f32 v160, v160, v161
    v_cvt_pk_bf16_f32 v161, v162, v163
    v_cvt_pk_bf16_f32 v162, v164, v165
    v_cvt_pk_bf16_f32 v163, v166, v167
    s_nop 1
    v_permlane32_swap_b32 v160, v162
    v_permlane32_swap_b32 v161, v163
    buffer_store_dwordx4 v[160:163], v24, s[16:19], 0 offen offset:128
    ds_read_b128 v[224:227], v26 offset:320
    ds_read_b128 v[232:235], v26 offset:1344
    ds_read_b128 v[228:231], v26 offset:352
    ds_read_b128 v[236:239], v26 offset:1376
    s_waitcnt lgkmcnt(0)
    v_mfma_f32_32x32x16_bf16 v[208:223], v[96:99], v[64:67], v[208:223]
    s_waitcnt lgkmcnt(0)
    v_fma_f32 v112, v224, v241, v232
    v_fma_f32 v113, v225, v241, v233
    v_fma_f32 v114, v226, v241, v234
    v_fma_f32 v115, v227, v241, v235
    v_fma_f32 v116, v228, v241, v236
    v_fma_f32 v117, v229, v241, v237
    v_fma_f32 v118, v230, v241, v238
    v_fma_f32 v119, v231, v241, v239
    v_fma_f32 v168, v168, v240, v112
    v_fma_f32 v169, v169, v240, v113
    v_fma_f32 v170, v170, v240, v114
    v_fma_f32 v171, v171, v240, v115
    v_fma_f32 v172, v172, v240, v116
    v_mfma_f32_32x32x16_bf16 v[208:223], v[100:103], v[68:71], v[208:223]
    v_fma_f32 v173, v173, v240, v117
    v_fma_f32 v174, v174, v240, v118
    v_fma_f32 v175, v175, v240, v119
    v_mul_f32 v112, v168, v168
    v_mul_f32 v113, v169, v169
    v_mul_f32 v114, v170, v170
    v_mul_f32 v115, v171, v171
    v_mul_f32 v116, v172, v172
    v_mul_f32 v117, v173, v173
    v_mul_f32 v118, v174, v174
    v_mul_f32 v119, v175, v175
    v_fma_f32 v112, v112, s44, v27
    v_fma_f32 v113, v113, s44, v27
    v_fma_f32 v114, v114, s44, v27
    v_mfma_f32_32x32x16_bf16 v[208:223], v[104:107], v[72:75], v[208:223]
    v_fma_f32 v115, v115, s44, v27
    v_fma_f32 v116, v116, s44, v27
    v_fma_f32 v117, v117, s44, v27
    v_fma_f32 v118, v118, s44, v27
    v_fma_f32 v119, v119, s44, v27
    v_mul_f32 v112, v112, v168
    v_mul_f32 v113, v113, v169
    v_mul_f32 v114, v114, v170
    v_mul_f32 v115, v115, v171
    v_mul_f32 v116, v116, v172
    v_mul_f32 v117, v117, v173
    v_mul_f32 v118, v118, v174
    v_mul_f32 v119, v119, v175
    v_exp_f32 v112, v112
    v_mfma_f32_32x32x16_bf16 v[208:223], v[108:111], v[76:79], v[208:223]
    v_exp_f32 v113, v113
    v_exp_f32 v114, v114
    v_exp_f32 v115, v115
    v_exp_f32 v116, v116
    v_exp_f32 v117, v117
    v_exp_f32 v118, v118
    v_exp_f32 v119, v119
    v_add_f32 v112, 1.0, v112
    v_add_f32 v113, 1.0, v113
    v_add_f32 v114, 1.0, v114
    v_add_f32 v115, 1.0, v115
    v_add_f32 v116, 1.0, v116
    v_add_f32 v117, 1.0, v117
    v_add_f32 v118, 1.0, v118
    v_add_f32 v119, 1.0, v119
    v_rcp_f32 v112, v112
    v_rcp_f32 v113, v113
    v_rcp_f32 v114, v114
    v_rcp_f32 v115, v115
    v_rcp_f32 v116, v116
    v_rcp_f32 v117, v117
    v_rcp_f32 v118, v118
    v_rcp_f32 v119, v119
    v_mul_f32 v168, v112, v168
    v_mul_f32 v169, v113, v169
    v_mul_f32 v170, v114, v170
    v_mul_f32 v171, v115, v171
    v_mul_f32 v172, v116, v172
    v_mul_f32 v173, v117, v173
    v_mul_f32 v174, v118, v174
    v_mul_f32 v175, v119, v175
    v_cvt_pk_bf16_f32 v168, v168, v169
    v_cvt_pk_bf16_f32 v169, v170, v171
    v_cvt_pk_bf16_f32 v170, v172, v173
    v_cvt_pk_bf16_f32 v171, v174, v175
    s_nop 1
    v_permlane32_swap_b32 v168, v170
    v_permlane32_swap_b32 v169, v171
    buffer_store_dwordx4 v[168:171], v24, s[16:19], 0 offen offset:160
    ds_read_b128 v[224:227], v26 offset:384
    ds_read_b128 v[232:235], v26 offset:1408
    ds_read_b128 v[228:231], v26 offset:416
    ds_read_b128 v[236:239], v26 offset:1440
    s_waitcnt lgkmcnt(0)
    v_fma_f32 v112, v224, v241, v232
    v_fma_f32 v113, v225, v241, v233
    v_fma_f32 v114, v226, v241, v234
    v_fma_f32 v115, v227, v241, v235
    v_fma_f32 v116, v228, v241, v236
    v_fma_f32 v117, v229, v241, v237
    v_fma_f32 v118, v230, v241, v238
    v_fma_f32 v119, v231, v241, v239
    v_fma_f32 v176, v176, v240, v112
    v_fma_f32 v177, v177, v240, v113
    v_fma_f32 v178, v178, v240, v114
    v_fma_f32 v179, v179, v240, v115
    v_fma_f32 v180, v180, v240, v116
    v_fma_f32 v181, v181, v240, v117
    v_fma_f32 v182, v182, v240, v118
    v_fma_f32 v183, v183, v240, v119
    v_mul_f32 v112, v176, v176
    v_mul_f32 v113, v177, v177
    v_mul_f32 v114, v178, v178
    v_mul_f32 v115, v179, v179
    v_mul_f32 v116, v180, v180
    v_mul_f32 v117, v181, v181
    v_mul_f32 v118, v182, v182
    v_mul_f32 v119, v183, v183
    v_fma_f32 v112, v112, s44, v27
    v_fma_f32 v113, v113, s44, v27
    v_fma_f32 v114, v114, s44, v27
    v_fma_f32 v115, v115, s44, v27
    v_fma_f32 v116, v116, s44, v27
    v_fma_f32 v117, v117, s44, v27
    v_fma_f32 v118, v118, s44, v27
    v_fma_f32 v119, v119, s44, v27
    v_mul_f32 v112, v112, v176
    v_mul_f32 v113, v113, v177
    v_mul_f32 v114, v114, v178
    v_mul_f32 v115, v115, v179
    v_mul_f32 v116, v116, v180
    v_mul_f32 v117, v117, v181
    v_mul_f32 v118, v118, v182
    v_mul_f32 v119, v119, v183
    v_exp_f32 v112, v112
    v_exp_f32 v113, v113
    v_exp_f32 v114, v114
    v_exp_f32 v115, v115
    v_exp_f32 v116, v116
    v_exp_f32 v117, v117
    v_exp_f32 v118, v118
    v_exp_f32 v119, v119
    v_add_f32 v112, 1.0, v112
    v_add_f32 v113, 1.0, v113
    v_add_f32 v114, 1.0, v114
    v_add_f32 v115, 1.0, v115
    v_add_f32 v116, 1.0, v116
    v_add_f32 v117, 1.0, v117
    v_add_f32 v118, 1.0, v118
    v_add_f32 v119, 1.0, v119
    v_rcp_f32 v112, v112
    v_rcp_f32 v113, v113
    v_rcp_f32 v114, v114
    v_rcp_f32 v115, v115
    v_rcp_f32 v116, v116
    v_rcp_f32 v117, v117
    v_rcp_f32 v118, v118
    v_rcp_f32 v119, v119
    v_mul_f32 v176, v112, v176
    v_mul_f32 v177, v113, v177
    v_mul_f32 v178, v114, v178
    v_mul_f32 v179, v115, v179
    v_mul_f32 v180, v116, v180
    v_mul_f32 v181, v117, v181
    v_mul_f32 v182, v118, v182
    v_mul_f32 v183, v119, v183
    v_cvt_pk_bf16_f32 v176, v176, v177
    v_cvt_pk_bf16_f32 v177, v178, v179
    v_cvt_pk_bf16_f32 v178, v180, v181
    v_cvt_pk_bf16_f32 v179, v182, v183
    s_nop 1
    v_permlane32_swap_b32 v176, v178
    v_permlane32_swap_b32 v177, v179
    buffer_store_dwordx4 v[176:179], v24, s[16:19], 0 offen offset:192
    ds_read_b128 v[224:227], v26 offset:448
    ds_read_b128 v[232:235], v26 offset:1472
    ds_read_b128 v[228:231], v26 offset:480
    ds_read_b128 v[236:239], v26 offset:1504
    s_waitcnt lgkmcnt(0)
    v_fma_f32 v112, v224, v241, v232
    v_fma_f32 v113, v225, v241, v233
    v_fma_f32 v114, v226, v241, v234
    v_fma_f32 v115, v227, v241, v235
    v_fma_f32 v116, v228, v241, v236
    v_fma_f32 v117, v229, v241, v237
    v_fma_f32 v118, v230, v241, v238
    v_fma_f32 v119, v231, v241, v239
    v_fma_f32 v184, v184, v240, v112
    v_fma_f32 v185, v185, v240, v113
    v_fma_f32 v186, v186, v240, v114
    v_fma_f32 v187, v187, v240, v115
    v_fma_f32 v188, v188, v240, v116
    v_fma_f32 v189, v189, v240, v117
    v_fma_f32 v190, v190, v240, v118
    v_fma_f32 v191, v191, v240, v119
    v_mul_f32 v112, v184, v184
    v_mul_f32 v113, v185, v185
    v_mul_f32 v114, v186, v186
    v_mul_f32 v115, v187, v187
    v_mul_f32 v116, v188, v188
    v_mul_f32 v117, v189, v189
    v_mul_f32 v118, v190, v190
    v_mul_f32 v119, v191, v191
    v_fma_f32 v112, v112, s44, v27
    v_fma_f32 v113, v113, s44, v27
    v_fma_f32 v114, v114, s44, v27
    v_fma_f32 v115, v115, s44, v27
    v_fma_f32 v116, v116, s44, v27
    v_fma_f32 v117, v117, s44, v27
    v_fma_f32 v118, v118, s44, v27
    v_fma_f32 v119, v119, s44, v27
    v_mul_f32 v112, v112, v184
    v_mul_f32 v113, v113, v185
    v_mul_f32 v114, v114, v186
    v_mul_f32 v115, v115, v187
    v_mul_f32 v116, v116, v188
    v_mul_f32 v117, v117, v189
    v_mul_f32 v118, v118, v190
    v_mul_f32 v119, v119, v191
    v_exp_f32 v112, v112
    v_exp_f32 v113, v113
    v_exp_f32 v114, v114
    v_exp_f32 v115, v115
    v_exp_f32 v116, v116
    v_exp_f32 v117, v117
    v_exp_f32 v118, v118
    v_exp_f32 v119, v119
    v_add_f32 v112, 1.0, v112
    v_add_f32 v113, 1.0, v113
    v_add_f32 v114, 1.0, v114
    v_add_f32 v115, 1.0, v115
    v_add_f32 v116, 1.0, v116
    v_add_f32 v117, 1.0, v117
    v_add_f32 v118, 1.0, v118
    v_add_f32 v119, 1.0, v119
    v_rcp_f32 v112, v112
    v_rcp_f32 v113, v113
    v_rcp_f32 v114, v114
    v_rcp_f32 v115, v115
    v_rcp_f32 v116, v116
    v_rcp_f32 v117, v117
    v_rcp_f32 v118, v118
    v_rcp_f32 v119, v119
    v_mul_f32 v184, v112, v184
    v_mul_f32 v185, v113, v185
    v_mul_f32 v186, v114, v186
    v_mul_f32 v187, v115, v187
    v_mul_f32 v188, v116, v188
    v_mul_f32 v189, v117, v189
    v_mul_f32 v190, v118, v190
    v_mul_f32 v191, v119, v191
    v_cvt_pk_bf16_f32 v184, v184, v185
    v_cvt_pk_bf16_f32 v185, v186, v187
    v_cvt_pk_bf16_f32 v186, v188, v189
    v_cvt_pk_bf16_f32 v187, v190, v191
    s_nop 1
    v_permlane32_swap_b32 v184, v186
    v_permlane32_swap_b32 v185, v187
    buffer_store_dwordx4 v[184:187], v24, s[16:19], 0 offen offset:224
    ds_read_b128 v[224:227], v26 offset:512
    ds_read_b128 v[232:235], v26 offset:1536
    ds_read_b128 v[228:231], v26 offset:544
    ds_read_b128 v[236:239], v26 offset:1568
    s_waitcnt lgkmcnt(0)
    v_fma_f32 v112, v224, v241, v232
    v_fma_f32 v113, v225, v241, v233
    v_fma_f32 v114, v226, v241, v234
    v_fma_f32 v115, v227, v241, v235
    v_fma_f32 v116, v228, v241, v236
    v_fma_f32 v117, v229, v241, v237
    v_fma_f32 v118, v230, v241, v238
    v_fma_f32 v119, v231, v241, v239
    v_fma_f32 v192, v192, v240, v112
    v_fma_f32 v193, v193, v240, v113
    v_fma_f32 v194, v194, v240, v114
    v_fma_f32 v195, v195, v240, v115
    v_fma_f32 v196, v196, v240, v116
    v_fma_f32 v197, v197, v240, v117
    v_fma_f32 v198, v198, v240, v118
    v_fma_f32 v199, v199, v240, v119
    v_mul_f32 v112, v192, v192
    v_mul_f32 v113, v193, v193
    v_mul_f32 v114, v194, v194
    v_mul_f32 v115, v195, v195
    v_mul_f32 v116, v196, v196
    v_mul_f32 v117, v197, v197
    v_mul_f32 v118, v198, v198
    v_mul_f32 v119, v199, v199
    v_fma_f32 v112, v112, s44, v27
    v_fma_f32 v113, v113, s44, v27
    v_fma_f32 v114, v114, s44, v27
    v_fma_f32 v115, v115, s44, v27
    v_fma_f32 v116, v116, s44, v27
    v_fma_f32 v117, v117, s44, v27
    v_fma_f32 v118, v118, s44, v27
    v_fma_f32 v119, v119, s44, v27
    v_mul_f32 v112, v112, v192
    v_mul_f32 v113, v113, v193
    v_mul_f32 v114, v114, v194
    v_mul_f32 v115, v115, v195
    v_mul_f32 v116, v116, v196
    v_mul_f32 v117, v117, v197
    v_mul_f32 v118, v118, v198
    v_mul_f32 v119, v119, v199
    v_exp_f32 v112, v112
    v_exp_f32 v113, v113
    v_exp_f32 v114, v114
    v_exp_f32 v115, v115
    v_exp_f32 v116, v116
    v_exp_f32 v117, v117
    v_exp_f32 v118, v118
    v_exp_f32 v119, v119
    v_add_f32 v112, 1.0, v112
    v_add_f32 v113, 1.0, v113
    v_add_f32 v114, 1.0, v114
    v_add_f32 v115, 1.0, v115
    v_add_f32 v116, 1.0, v116
    v_add_f32 v117, 1.0, v117
    v_add_f32 v118, 1.0, v118
    v_add_f32 v119, 1.0, v119
    v_rcp_f32 v112, v112
    v_rcp_f32 v113, v113
    v_rcp_f32 v114, v114
    v_rcp_f32 v115, v115
    v_rcp_f32 v116, v116
    v_rcp_f32 v117, v117
    v_rcp_f32 v118, v118
    v_rcp_f32 v119, v119
    v_mul_f32 v192, v112, v192
    v_mul_f32 v193, v113, v193
    v_mul_f32 v194, v114, v194
    v_mul_f32 v195, v115, v195
    v_mul_f32 v196, v116, v196
    v_mul_f32 v197, v117, v197
    v_mul_f32 v198, v118, v198
    v_mul_f32 v199, v119, v199
    v_cvt_pk_bf16_f32 v192, v192, v193
    v_cvt_pk_bf16_f32 v193, v194, v195
    v_cvt_pk_bf16_f32 v194, v196, v197
    v_cvt_pk_bf16_f32 v195, v198, v199
    s_nop 1
    v_permlane32_swap_b32 v192, v194
    v_permlane32_swap_b32 v193, v195
    buffer_store_dwordx4 v[192:195], v24, s[16:19], 0 offen offset:256
    ds_read_b128 v[224:227], v26 offset:576
    ds_read_b128 v[232:235], v26 offset:1600
    ds_read_b128 v[228:231], v26 offset:608
    ds_read_b128 v[236:239], v26 offset:1632
    s_waitcnt lgkmcnt(0)
    v_fma_f32 v112, v224, v241, v232
    v_fma_f32 v113, v225, v241, v233
    v_fma_f32 v114, v226, v241, v234
    v_fma_f32 v115, v227, v241, v235
    v_fma_f32 v116, v228, v241, v236
    v_fma_f32 v117, v229, v241, v237
    v_fma_f32 v118, v230, v241, v238
    v_fma_f32 v119, v231, v241, v239
    v_fma_f32 v200, v200, v240, v112
    v_fma_f32 v201, v201, v240, v113
    v_fma_f32 v202, v202, v240, v114
    v_fma_f32 v203, v203, v240, v115
    v_fma_f32 v204, v204, v240, v116
    v_fma_f32 v205, v205, v240, v117
    v_fma_f32 v206, v206, v240, v118
    v_fma_f32 v207, v207, v240, v119
    v_mul_f32 v112, v200, v200
    v_mul_f32 v113, v201, v201
    v_mul_f32 v114, v202, v202
    v_mul_f32 v115, v203, v203
    v_mul_f32 v116, v204, v204
    v_mul_f32 v117, v205, v205
    v_mul_f32 v118, v206, v206
    v_mul_f32 v119, v207, v207
    v_fma_f32 v112, v112, s44, v27
    v_fma_f32 v113, v113, s44, v27
    v_fma_f32 v114, v114, s44, v27
    v_fma_f32 v115, v115, s44, v27
    v_fma_f32 v116, v116, s44, v27
    v_fma_f32 v117, v117, s44, v27
    v_fma_f32 v118, v118, s44, v27
    v_fma_f32 v119, v119, s44, v27
    v_mul_f32 v112, v112, v200
    v_mul_f32 v113, v113, v201
    v_mul_f32 v114, v114, v202
    v_mul_f32 v115, v115, v203
    v_mul_f32 v116, v116, v204
    v_mul_f32 v117, v117, v205
    v_mul_f32 v118, v118, v206
    v_mul_f32 v119, v119, v207
    v_exp_f32 v112, v112
    v_exp_f32 v113, v113
    v_exp_f32 v114, v114
    v_exp_f32 v115, v115
    v_exp_f32 v116, v116
    v_exp_f32 v117, v117
    v_exp_f32 v118, v118
    v_exp_f32 v119, v119
    v_add_f32 v112, 1.0, v112
    v_add_f32 v113, 1.0, v113
    v_add_f32 v114, 1.0, v114
    v_add_f32 v115, 1.0, v115
    v_add_f32 v116, 1.0, v116
    v_add_f32 v117, 1.0, v117
    v_add_f32 v118, 1.0, v118
    v_add_f32 v119, 1.0, v119
    v_rcp_f32 v112, v112
    v_rcp_f32 v113, v113
    v_rcp_f32 v114, v114
    v_rcp_f32 v115, v115
    v_rcp_f32 v116, v116
    v_rcp_f32 v117, v117
    v_rcp_f32 v118, v118
    v_rcp_f32 v119, v119
    v_mul_f32 v200, v112, v200
    v_mul_f32 v201, v113, v201
    v_mul_f32 v202, v114, v202
    v_mul_f32 v203, v115, v203
    v_mul_f32 v204, v116, v204
    v_mul_f32 v205, v117, v205
    v_mul_f32 v206, v118, v206
    v_mul_f32 v207, v119, v207
    v_cvt_pk_bf16_f32 v200, v200, v201
    v_cvt_pk_bf16_f32 v201, v202, v203
    v_cvt_pk_bf16_f32 v202, v204, v205
    v_cvt_pk_bf16_f32 v203, v206, v207
    s_nop 1
    v_permlane32_swap_b32 v200, v202
    v_permlane32_swap_b32 v201, v203
    buffer_store_dwordx4 v[200:203], v24, s[16:19], 0 offen offset:288
    s_nop 7
    s_nop 7
    ds_read_b128 v[224:227], v26 offset:640
    ds_read_b128 v[232:235], v26 offset:1664
    ds_read_b128 v[228:231], v26 offset:672
    ds_read_b128 v[236:239], v26 offset:1696
    s_waitcnt lgkmcnt(0)
    v_fma_f32 v112, v224, v241, v232
    v_fma_f32 v113, v225, v241, v233
    v_fma_f32 v114, v226, v241, v234
    v_fma_f32 v115, v227, v241, v235
    v_fma_f32 v116, v228, v241, v236
    v_fma_f32 v117, v229, v241, v237
    v_fma_f32 v118, v230, v241, v238
    v_fma_f32 v119, v231, v241, v239
    v_fma_f32 v208, v208, v240, v112
    v_fma_f32 v209, v209, v240, v113
    v_fma_f32 v210, v210, v240, v114
    v_fma_f32 v211, v211, v240, v115
    v_fma_f32 v212, v212, v240, v116
    v_fma_f32 v213, v213, v240, v117
    v_fma_f32 v214, v214, v240, v118
    v_fma_f32 v215, v215, v240, v119
    v_mul_f32 v112, v208, v208
    v_mul_f32 v113, v209, v209
    v_mul_f32 v114, v210, v210
    v_mul_f32 v115, v211, v211
    v_mul_f32 v116, v212, v212
    v_mul_f32 v117, v213, v213
    v_mul_f32 v118, v214, v214
    v_mul_f32 v119, v215, v215
    v_fma_f32 v112, v112, s44, v27
    v_fma_f32 v113, v113, s44, v27
    v_fma_f32 v114, v114, s44, v27
    v_fma_f32 v115, v115, s44, v27
    v_fma_f32 v116, v116, s44, v27
    v_fma_f32 v117, v117, s44, v27
    v_fma_f32 v118, v118, s44, v27
    v_fma_f32 v119, v119, s44, v27
    v_mul_f32 v112, v112, v208
    v_mul_f32 v113, v113, v209
    v_mul_f32 v114, v114, v210
    v_mul_f32 v115, v115, v211
    v_mul_f32 v116, v116, v212
    v_mul_f32 v117, v117, v213
    v_mul_f32 v118, v118, v214
    v_mul_f32 v119, v119, v215
    v_exp_f32 v112, v112
    v_exp_f32 v113, v113
    v_exp_f32 v114, v114
    v_exp_f32 v115, v115
    v_exp_f32 v116, v116
    v_exp_f32 v117, v117
    v_exp_f32 v118, v118
    v_exp_f32 v119, v119
    v_add_f32 v112, 1.0, v112
    v_add_f32 v113, 1.0, v113
    v_add_f32 v114, 1.0, v114
    v_add_f32 v115, 1.0, v115
    v_add_f32 v116, 1.0, v116
    v_add_f32 v117, 1.0, v117
    v_add_f32 v118, 1.0, v118
    v_add_f32 v119, 1.0, v119
    v_rcp_f32 v112, v112
    v_rcp_f32 v113, v113
    v_rcp_f32 v114, v114
    v_rcp_f32 v115, v115
    v_rcp_f32 v116, v116
    v_rcp_f32 v117, v117
    v_rcp_f32 v118, v118
    v_rcp_f32 v119, v119
    v_mul_f32 v208, v112, v208
    v_mul_f32 v209, v113, v209
    v_mul_f32 v210, v114, v210
    v_mul_f32 v211, v115, v211
    v_mul_f32 v212, v116, v212
    v_mul_f32 v213, v117, v213
    v_mul_f32 v214, v118, v214
    v_mul_f32 v215, v119, v215
    v_cvt_pk_bf16_f32 v208, v208, v209
    v_cvt_pk_bf16_f32 v209, v210, v211
    v_cvt_pk_bf16_f32 v210, v212, v213
    v_cvt_pk_bf16_f32 v211, v214, v215
    s_nop 1
    v_permlane32_swap_b32 v208, v210
    v_permlane32_swap_b32 v209, v211
    buffer_store_dwordx4 v[208:211], v24, s[16:19], 0 offen offset:320
    ds_read_b128 v[224:227], v26 offset:704
    ds_read_b128 v[232:235], v26 offset:1728
    ds_read_b128 v[228:231], v26 offset:736
    ds_read_b128 v[236:239], v26 offset:1760
    s_waitcnt lgkmcnt(0)
    v_fma_f32 v112, v224, v241, v232
    v_fma_f32 v113, v225, v241, v233
    v_fma_f32 v114, v226, v241, v234
    v_fma_f32 v115, v227, v241, v235
    v_fma_f32 v116, v228, v241, v236
    v_fma_f32 v117, v229, v241, v237
    v_fma_f32 v118, v230, v241, v238
    v_fma_f32 v119, v231, v241, v239
    v_fma_f32 v216, v216, v240, v112
    v_fma_f32 v217, v217, v240, v113
    v_fma_f32 v218, v218, v240, v114
    v_fma_f32 v219, v219, v240, v115
    v_fma_f32 v220, v220, v240, v116
    v_fma_f32 v221, v221, v240, v117
    v_fma_f32 v222, v222, v240, v118
    v_fma_f32 v223, v223, v240, v119
    v_mul_f32 v112, v216, v216
    v_mul_f32 v113, v217, v217
    v_mul_f32 v114, v218, v218
    v_mul_f32 v115, v219, v219
    v_mul_f32 v116, v220, v220
    v_mul_f32 v117, v221, v221
    v_mul_f32 v118, v222, v222
    v_mul_f32 v119, v223, v223
    v_fma_f32 v112, v112, s44, v27
    v_fma_f32 v113, v113, s44, v27
    v_fma_f32 v114, v114, s44, v27
    v_fma_f32 v115, v115, s44, v27
    v_fma_f32 v116, v116, s44, v27
    v_fma_f32 v117, v117, s44, v27
    v_fma_f32 v118, v118, s44, v27
    v_fma_f32 v119, v119, s44, v27
    v_mul_f32 v112, v112, v216
    v_mul_f32 v113, v113, v217
    v_mul_f32 v114, v114, v218
    v_mul_f32 v115, v115, v219
    v_mul_f32 v116, v116, v220
    v_mul_f32 v117, v117, v221
    v_mul_f32 v118, v118, v222
    v_mul_f32 v119, v119, v223
    v_exp_f32 v112, v112
    v_exp_f32 v113, v113
    v_exp_f32 v114, v114
    v_exp_f32 v115, v115
    v_exp_f32 v116, v116
    v_exp_f32 v117, v117
    v_exp_f32 v118, v118
    v_exp_f32 v119, v119
    v_add_f32 v112, 1.0, v112
    v_add_f32 v113, 1.0, v113
    v_add_f32 v114, 1.0, v114
    v_add_f32 v115, 1.0, v115
    v_add_f32 v116, 1.0, v116
    v_add_f32 v117, 1.0, v117
    v_add_f32 v118, 1.0, v118
    v_add_f32 v119, 1.0, v119
    v_rcp_f32 v112, v112
    v_rcp_f32 v113, v113
    v_rcp_f32 v114, v114
    v_rcp_f32 v115, v115
    v_rcp_f32 v116, v116
    v_rcp_f32 v117, v117
    v_rcp_f32 v118, v118
    v_rcp_f32 v119, v119
    v_mul_f32 v216, v112, v216
    v_mul_f32 v217, v113, v217
    v_mul_f32 v218, v114, v218
    v_mul_f32 v219, v115, v219
    v_mul_f32 v220, v116, v220
    v_mul_f32 v221, v117, v221
    v_mul_f32 v222, v118, v222
    v_mul_f32 v223, v119, v223
    v_cvt_pk_bf16_f32 v216, v216, v217
    v_cvt_pk_bf16_f32 v217, v218, v219
    v_cvt_pk_bf16_f32 v218, v220, v221
    v_cvt_pk_bf16_f32 v219, v222, v223
    s_nop 1
    v_permlane32_swap_b32 v216, v218
    v_permlane32_swap_b32 v217, v219
    buffer_store_dwordx4 v[216:219], v24, s[16:19], 0 offen offset:352
    s_endpgm
KA_W2T:
    s_load_dwordx2 s[32:33], s[0:1], 64
    s_load_dwordx2 s[6:7], s[0:1], 96
    s_sub_u32 s26, s2, 240
    v_lshrrev_b32 v1, 6, v0
    v_and_b32 v2, 63, v0
    v_mul_u32_u24 v3, 576, v1
    v_add_u32 v3, v3, v2
    v_lshlrev_b32 v4, 4, v3
    v_add_u32 v5, 4096, v4
    v_add_u32 v6, 8192, v4
    v_add_u32 v7, 0, v3
    v_mul_u32_u24 v8, 3641, v7
    v_lshrrev_b32 v8, 18, v8
    v_mul_u32_u24 v9, 72, v8
    v_sub_u32 v9, v7, v9
    v_mul_u32_u24 v10, 3641, v9
    v_lshrrev_b32 v10, 16, v10
    v_mul_u32_u24 v11, 18, v10
    v_sub_u32 v11, v9, v11
    v_and_b32 v12, 0x33, v8
    v_bfe_u32 v13, v8, 2, 1
    v_lshl_add_u32 v12, v13, 3, v12
    v_bfe_u32 v13, v8, 3, 1
    v_lshl_add_u32 v12, v13, 2, v12
    v_mul_u32_u24 v12, 18, v12
    v_add_u32 v12, v12, v11
    v_lshlrev_b32 v12, 4, v12
    v_mul_u32_u24 v10, 663552, v10
    v_add_u32 v16, v12, v10
    v_add_u32 v7, 64, v3
    v_mul_u32_u24 v8, 3641, v7
    v_lshrrev_b32 v8, 18, v8
    v_mul_u32_u24 v9, 72, v8
    v_sub_u32 v9, v7, v9
    v_mul_u32_u24 v10, 3641, v9
    v_lshrrev_b32 v10, 16, v10
    v_mul_u32_u24 v11, 18, v10
    v_sub_u32 v11, v9, v11
    v_and_b32 v12, 0x33, v8
    v_bfe_u32 v13, v8, 2, 1
    v_lshl_add_u32 v12, v13, 3, v12
    v_bfe_u32 v13, v8, 3, 1
    v_lshl_add_u32 v12, v13, 2, v12
    v_mul_u32_u24 v12, 18, v12
    v_add_u32 v12, v12, v11
    v_lshlrev_b32 v12, 4, v12
    v_mul_u32_u24 v10, 663552, v10
    v_add_u32 v17, v12, v10
    v_add_u32 v7, 128, v3
    v_mul_u32_u24 v8, 3641, v7
    v_lshrrev_b32 v8, 18, v8
    v_mul_u32_u24 v9, 72, v8
    v_sub_u32 v9, v7, v9
    v_mul_u32_u24 v10, 3641, v9
    v_lshrrev_b32 v10, 16, v10
    v_mul_u32_u24 v11, 18, v10
    v_sub_u32 v11, v9, v11
    v_and_b32 v12, 0x33, v8
    v_bfe_u32 v13, v8, 2, 1
    v_lshl_add_u32 v12, v13, 3, v12
    v_bfe_u32 v13, v8, 3, 1
    v_lshl_add_u32 v12, v13, 2, v12
    v_mul_u32_u24 v12, 18, v12
    v_add_u32 v12, v12, v11
    v_lshlrev_b32 v12, 4, v12
    v_mul_u32_u24 v10, 663552, v10
    v_add_u32 v18, v12, v10
    v_add_u32 v7, 192, v3
    v_mul_u32_u24 v8, 3641, v7
    v_lshrrev_b32 v8, 18, v8
    v_mul_u32_u24 v9, 72, v8
    v_sub_u32 v9, v7, v9
    v_mul_u32_u24 v10, 3641, v9
    v_lshrrev_b32 v10, 16, v10
    v_mul_u32_u24 v11, 18, v10
    v_sub_u32 v11, v9, v11
    v_and_b32 v12, 0x33, v8
    v_bfe_u32 v13, v8, 2, 1
    v_lshl_add_u32 v12, v13, 3, v12
    v_bfe_u32 v13, v8, 3, 1
    v_lshl_add_u32 v12, v13, 2, v12
    v_mul_u32_u24 v12, 18, v12
    v_add_u32 v12, v12, v11
    v_lshlrev_b32 v12, 4, v12
    v_mul_u32_u24 v10, 663552, v10
    v_add_u32 v19, v12, v10
    v_add_u32 v7, 256, v3
    v_mul_u32_u24 v8, 3641, v7
    v_lshrrev_b32 v8, 18, v8
    v_mul_u32_u24 v9, 72, v8
    v_sub_u32 v9, v7, v9
    v_mul_u32_u24 v10, 3641, v9
    v_lshrrev_b32 v10, 16, v10
    v_mul_u32_u24 v11, 18, v10
    v_sub_u32 v11, v9, v11
    v_and_b32 v12, 0x33, v8
    v_bfe_u32 v13, v8, 2, 1
    v_lshl_add_u32 v12, v13, 3, v12
    v_bfe_u32 v13, v8, 3, 1
    v_lshl_add_u32 v12, v13, 2, v12
    v_mul_u32_u24 v12, 18, v12
    v_add_u32 v12, v12, v11
    v_lshlrev_b32 v12, 4, v12
    v_mul_u32_u24 v10, 663552, v10
    v_add_u32 v20, v12, v10
    v_add_u32 v7, 320, v3
    v_mul_u32_u24 v8, 3641, v7
    v_lshrrev_b32 v8, 18, v8
    v_mul_u32_u24 v9, 72, v8
    v_sub_u32 v9, v7, v9
    v_mul_u32_u24 v10, 3641, v9
    v_lshrrev_b32 v10, 16, v10
    v_mul_u32_u24 v11, 18, v10
    v_sub_u32 v11, v9, v11
    v_and_b32 v12, 0x33, v8
    v_bfe_u32 v13, v8, 2, 1
    v_lshl_add_u32 v12, v13, 3, v12
    v_bfe_u32 v13, v8, 3, 1
    v_lshl_add_u32 v12, v13, 2, v12
    v_mul_u32_u24 v12, 18, v12
    v_add_u32 v12, v12, v11
    v_lshlrev_b32 v12, 4, v12
    v_mul_u32_u24 v10, 663552, v10
    v_add_u32 v21, v12, v10
    v_add_u32 v7, 384, v3
    v_mul_u32_u24 v8, 3641, v7
    v_lshrrev_b32 v8, 18, v8
    v_mul_u32_u24 v9, 72, v8
    v_sub_u32 v9, v7, v9
    v_mul_u32_u24 v10, 3641, v9
    v_lshrrev_b32 v10, 16, v10
    v_mul_u32_u24 v11, 18, v10
    v_sub_u32 v11, v9, v11
    v_and_b32 v12, 0x33, v8
    v_bfe_u32 v13, v8, 2, 1
    v_lshl_add_u32 v12, v13, 3, v12
    v_bfe_u32 v13, v8, 3, 1
    v_lshl_add_u32 v12, v13, 2, v12
    v_mul_u32_u24 v12, 18, v12
    v_add_u32 v12, v12, v11
    v_lshlrev_b32 v12, 4, v12
    v_mul_u32_u24 v10, 663552, v10
    v_add_u32 v22, v12, v10
    v_add_u32 v7, 448, v3
    v_mul_u32_u24 v8, 3641, v7
    v_lshrrev_b32 v8, 18, v8
    v_mul_u32_u24 v9, 72, v8
    v_sub_u32 v9, v7, v9
    v_mul_u32_u24 v10, 3641, v9
    v_lshrrev_b32 v10, 16, v10
    v_mul_u32_u24 v11, 18, v10
    v_sub_u32 v11, v9, v11
    v_and_b32 v12, 0x33, v8
    v_bfe_u32 v13, v8, 2, 1
    v_lshl_add_u32 v12, v13, 3, v12
    v_bfe_u32 v13, v8, 3, 1
    v_lshl_add_u32 v12, v13, 2, v12
    v_mul_u32_u24 v12, 18, v12
    v_add_u32 v12, v12, v11
    v_lshlrev_b32 v12, 4, v12
    v_mul_u32_u24 v10, 663552, v10
    v_add_u32 v23, v12, v10
    v_add_u32 v7, 512, v3
    v_mul_u32_u24 v8, 3641, v7
    v_lshrrev_b32 v8, 18, v8
    v_mul_u32_u24 v9, 72, v8
    v_sub_u32 v9, v7, v9
    v_mul_u32_u24 v10, 3641, v9
    v_lshrrev_b32 v10, 16, v10
    v_mul_u32_u24 v11, 18, v10
    v_sub_u32 v11, v9, v11
    v_and_b32 v12, 0x33, v8
    v_bfe_u32 v13, v8, 2, 1
    v_lshl_add_u32 v12, v13, 3, v12
    v_bfe_u32 v13, v8, 3, 1
    v_lshl_add_u32 v12, v13, 2, v12
    v_mul_u32_u24 v12, 18, v12
    v_add_u32 v12, v12, v11
    v_lshlrev_b32 v12, 4, v12
    v_mul_u32_u24 v10, 663552, v10
    v_add_u32 v24, v12, v10
    s_waitcnt lgkmcnt(0)
    s_add_u32 s8, s6, 0x2f00000
    s_addc_u32 s9, s7, 0
    s_mov_b32 s10, 0x2000
    s_mov_b32 s11, 0x00020000
    v_lshlrev_b32 v28, 4, v0
    v_mov_b32 v32, 0
    v_mov_b32 v33, 0
    v_mov_b32 v34, 0
    v_mov_b32 v35, 0
    s_cmp_lg_u32 s26, 0
    s_cbranch_scc1 KA_NOZERO
    buffer_store_dwordx4 v[32:35], v28, s[8:11], 0 offen
KA_NOZERO:
    s_nop 1
    s_mov_b32 s8, s32
    s_mov_b32 s9, s33
    s_mov_b32 s10, 0x510000
    s_mov_b32 s11, 0x00020000
    s_add_u32 s12, s6, 0x2800000
    s_addc_u32 s13, s7, 0
    s_mov_b32 s14, 0x510000
    s_mov_b32 s15, 0x00020000
    s_add_u32 s16, s26, 0
    s_mul_i32 s16, s16, 73728
    buffer_load_dwordx4 v[32:35], v4, s[8:11], s16 offen offset:0
    buffer_load_dwordx4 v[36:39], v4, s[8:11], s16 offen offset:1024
    buffer_load_dwordx4 v[40:43], v4, s[8:11], s16 offen offset:2048
    buffer_load_dwordx4 v[44:47], v4, s[8:11], s16 offen offset:3072
    buffer_load_dwordx4 v[48:51], v5, s[8:11], s16 offen offset:0
    buffer_load_dwordx4 v[52:55], v5, s[8:11], s16 offen offset:1024
    buffer_load_dwordx4 v[56:59], v5, s[8:11], s16 offen offset:2048
    buffer_load_dwordx4 v[60:63], v5, s[8:11], s16 offen offset:3072
    buffer_load_dwordx4 v[64:67], v6, s[8:11], s16 offen offset:0
    s_add_u32 s16, s26, 16
    s_mul_i32 s16, s16, 73728
    buffer_load_dwordx4 v[68:71], v4, s[8:11], s16 offen offset:0
    buffer_load_dwordx4 v[72:75], v4, s[8:11], s16 offen offset:1024
    buffer_load_dwordx4 v[76:79], v4, s[8:11], s16 offen offset:2048
    buffer_load_dwordx4 v[80:83], v4, s[8:11], s16 offen offset:3072
    buffer_load_dwordx4 v[84:87], v5, s[8:11], s16 offen offset:0
    buffer_load_dwordx4 v[88:91], v5, s[8:11], s16 offen offset:1024
    buffer_load_dwordx4 v[92:95], v5, s[8:11], s16 offen offset:2048
    buffer_load_dwordx4 v[96:99], v5, s[8:11], s16 offen offset:3072
    buffer_load_dwordx4 v[100:103], v6, s[8:11], s16 offen offset:0
    s_add_u32 s16, s26, 32
    s_mul_i32 s16, s16, 73728
    buffer_load_dwordx4 v[104:107], v4, s[8:11], s16 offen offset:0
    buffer_load_dwordx4 v[108:111], v4, s[8:11], s16 offen offset:1024
    buffer_load_dwordx4 v[112:115], v4, s[8:11], s16 offen offset:2048
    buffer_load_dwordx4 v[116:119], v4, s[8:11], s16 offen offset:3072
    buffer_load_dwordx4 v[120:123], v5, s[8:11], s16 offen offset:0
    buffer_load_dwordx4 v[124:127], v5, s[8:11], s16 offen offset:1024
    buffer_load_dwordx4 v[128:131], v5, s[8:11], s16 offen offset:2048
    buffer_load_dwordx4 v[132:135], v5, s[8:11], s16 offen offset:3072
    buffer_load_dwordx4 v[136:139], v6, s[8:11], s16 offen offset:0
    s_add_u32 s16, s26, 48
    s_mul_i32 s16, s16, 73728
    buffer_load_dwordx4 v[140:143], v4, s[8:11], s16 offen offset:0
    buffer_load_dwordx4 v[144:147], v4, s[8:11], s16 offen offset:1024
    buffer_load_dwordx4 v[148:151], v4, s[8:11], s16 offen offset:2048
    buffer_load_dwordx4 v[152:155], v4, s[8:11], s16 offen offset:3072
    buffer_load_dwordx4 v[156:159], v5, s[8:11], s16 offen offset:0
    buffer_load_dwordx4 v[160:163], v5, s[8:11], s16 offen offset:1024
    buffer_load_dwordx4 v[164:167], v5, s[8:11], s16 offen offset:2048
    buffer_load_dwordx4 v[168:171], v5, s[8:11], s16 offen offset:3072
    buffer_load_dwordx4 v[172:175], v6, s[8:11], s16 offen offset:0
    s_add_u32 s16, s26, 64
    s_mul_i32 s16, s16, 73728
    buffer_load_dwordx4 v[176:179], v4, s[8:11], s16 offen offset:0
    buffer_load_dwordx4 v[180:183], v4, s[8:11], s16 offen offset:1024
    buffer_load_dwordx4 v[184:187], v4, s[8:11], s16 offen offset:2048
    buffer_load_dwordx4 v[188:191], v4, s[8:11], s16 offen offset:3072
    buffer_load_dwordx4 v[192:195], v5, s[8:11], s16 offen offset:0
    buffer_load_dwordx4 v[196:199], v5, s[8:11], s16 offen offset:1024
    buffer_load_dwordx4 v[200:203], v5, s[8:11], s16 offen offset:2048
    buffer_load_dwordx4 v[204:207], v5, s[8:11], s16 offen offset:3072
    buffer_load_dwordx4 v[208:211], v6, s[8:11], s16 offen offset:0
    s_add_u32 s16, s26, 0
    s_sub_u32 s17, s16, 36
    s_add_u32 s18, s17, 144
    s_cmp_lt_u32 s16, 36
    s_cselect_b32 s18, s16, s18
    s_add_u32 s17, s16, 216
    s_cmp_lt_u32 s16, 72
    s_cselect_b32 s18, s18, s17
    s_mul_i32 s18, s18, 18432
    s_waitcnt vmcnt(36)
    buffer_store_dwordx4 v[32:35], v16, s[12:15], s18 offen
    buffer_store_dwordx4 v[36:39], v17, s[12:15], s18 offen
    buffer_store_dwordx4 v[40:43], v18, s[12:15], s18 offen
    buffer_store_dwordx4 v[44:47], v19, s[12:15], s18 offen
    buffer_store_dwordx4 v[48:51], v20, s[12:15], s18 offen
    buffer_store_dwordx4 v[52:55], v21, s[12:15], s18 offen
    buffer_store_dwordx4 v[56:59], v22, s[12:15], s18 offen
    buffer_store_dwordx4 v[60:63], v23, s[12:15], s18 offen
    buffer_store_dwordx4 v[64:67], v24, s[12:15], s18 offen
    s_add_u32 s16, s26, 16
    s_sub_u32 s17, s16, 36
    s_add_u32 s18, s17, 144
    s_cmp_lt_u32 s16, 36
    s_cselect_b32 s18, s16, s18
    s_add_u32 s17, s16, 216
    s_cmp_lt_u32 s16, 72
    s_cselect_b32 s18, s18, s17
    s_mul_i32 s18, s18, 18432
    s_waitcnt vmcnt(36)
    buffer_store_dwordx4 v[68:71], v16, s[12:15], s18 offen
    buffer_store_dwordx4 v[72:75], v17, s[12:15], s18 offen
    buffer_store_dwordx4 v[76:79], v18, s[12:15], s18 offen
    buffer_store_dwordx4 v[80:83], v19, s[12:15], s18 offen
    buffer_store_dwordx4 v[84:87], v20, s[12:15], s18 offen
    buffer_store_dwordx4 v[88:91], v21, s[12:15], s18 offen
    buffer_store_dwordx4 v[92:95], v22, s[12:15], s18 offen
    buffer_store_dwordx4 v[96:99], v23, s[12:15], s18 offen
    buffer_store_dwordx4 v[100:103], v24, s[12:15], s18 offen
    s_add_u32 s16, s26, 32
    s_sub_u32 s17, s16, 36
    s_add_u32 s18, s17, 144
    s_cmp_lt_u32 s16, 36
    s_cselect_b32 s18, s16, s18
    s_add_u32 s17, s16, 216
    s_cmp_lt_u32 s16, 72
    s_cselect_b32 s18, s18, s17
    s_mul_i32 s18, s18, 18432
    s_waitcnt vmcnt(36)
    buffer_store_dwordx4 v[104:107], v16, s[12:15], s18 offen
    buffer_store_dwordx4 v[108:111], v17, s[12:15], s18 offen
    buffer_store_dwordx4 v[112:115], v18, s[12:15], s18 offen
    buffer_store_dwordx4 v[116:119], v19, s[12:15], s18 offen
    buffer_store_dwordx4 v[120:123], v20, s[12:15], s18 offen
    buffer_store_dwordx4 v[124:127], v21, s[12:15], s18 offen
    buffer_store_dwordx4 v[128:131], v22, s[12:15], s18 offen
    buffer_store_dwordx4 v[132:135], v23, s[12:15], s18 offen
    buffer_store_dwordx4 v[136:139], v24, s[12:15], s18 offen
    s_add_u32 s16, s26, 48
    s_sub_u32 s17, s16, 36
    s_add_u32 s18, s17, 144
    s_cmp_lt_u32 s16, 36
    s_cselect_b32 s18, s16, s18
    s_add_u32 s17, s16, 216
    s_cmp_lt_u32 s16, 72
    s_cselect_b32 s18, s18, s17
    s_mul_i32 s18, s18, 18432
    s_waitcnt vmcnt(36)
    buffer_store_dwordx4 v[140:143], v16, s[12:15], s18 offen
    buffer_store_dwordx4 v[144:147], v17, s[12:15], s18 offen
    buffer_store_dwordx4 v[148:151], v18, s[12:15], s18 offen
    buffer_store_dwordx4 v[152:155], v19, s[12:15], s18 offen
    buffer_store_dwordx4 v[156:159], v20, s[12:15], s18 offen
    buffer_store_dwordx4 v[160:163], v21, s[12:15], s18 offen
    buffer_store_dwordx4 v[164:167], v22, s[12:15], s18 offen
    buffer_store_dwordx4 v[168:171], v23, s[12:15], s18 offen
    buffer_store_dwordx4 v[172:175], v24, s[12:15], s18 offen
    s_add_u32 s16, s26, 64
    s_sub_u32 s17, s16, 36
    s_add_u32 s18, s17, 144
    s_cmp_lt_u32 s16, 36
    s_cselect_b32 s18, s16, s18
    s_add_u32 s17, s16, 216
    s_cmp_lt_u32 s16, 72
    s_cselect_b32 s18, s18, s17
    s_mul_i32 s18, s18, 18432
    s_waitcnt vmcnt(36)
    buffer_store_dwordx4 v[176:179], v16, s[12:15], s18 offen
    buffer_store_dwordx4 v[180:183], v17, s[12:15], s18 offen
    buffer_store_dwordx4 v[184:187], v18, s[12:15], s18 offen
    buffer_store_dwordx4 v[188:191], v19, s[12:15], s18 offen
    buffer_store_dwordx4 v[192:195], v20, s[12:15], s18 offen
    buffer_store_dwordx4 v[196:199], v21, s[12:15], s18 offen
    buffer_store_dwordx4 v[200:203], v22, s[12:15], s18 offen
    buffer_store_dwordx4 v[204:207], v23, s[12:15], s18 offen
    buffer_store_dwordx4 v[208:211], v24, s[12:15], s18 offen
KA_END:
    s_endpgm
.globl kb_kernel
.p2align 8
.type kb_kernel,@function
kb_kernel:
    s_cmp_ge_u32 s2, 256
    s_cbranch_scc1 KB_END
    s_and_b32 s24, s2, 7
    s_lshr_b32 s25, s24, 1
    s_and_b32 s24, s24, 1
    s_lshr_b32 s26, s2, 3
    s_and_b32 s27, s26, 3
    s_lshr_b32 s26, s26, 2
    s_lshl_b32 s24, s24, 3
    s_add_u32 s26, s26, s24
    s_load_dwordx4 s[28:31], s[0:1], 8
    s_load_dwordx2 s[6:7], s[0:1], 96
    s_load_dwordx2 s[52:53], s[0:1], 0
    s_load_dwordx4 s[56:59], s[0:1], 72
    s_load_dwordx2 s[60:61], s[0:1], 88
    v_lshrrev_b32 v1, 6, v0
    v_and_b32 v2, 63, v0
    s_nop 0
    v_readfirstlane_b32 s50, v1
    s_nop 3
    s_and_b32 s34, s50, 3
    v_and_b32 v3, 15, v2
    v_lshrrev_b32 v4, 4, v2
    v_lshrrev_b32 v7, 3, v2
    v_and_b32 v8, 7, v2
    s_lshl_b32 s35, s26, 7
    s_lshl_b32 s36, s34, 5
    s_add_u32 s36, s36, s35
    v_add_u32 v5, s36, v3
    v_mul_u32_u24 v5, 2304, v5
    v_lshl_add_u32 v5, v4, 4, v5
    s_mul_i32 s37, s27, 576
    s_mul_i32 s38, s25, 0x480000
    s_add_u32 s37, s37, s38
    v_add_u32 v5, s37, v5
    v_add_u32 v6, 36864, v5
    v_lshrrev_b32 v9, 1, v3
    v_xor_b32 v9, v9, v4
    v_lshlrev_b32 v9, 4, v9
    v_lshl_add_u32 v9, v3, 7, v9
    s_lshl_b32 s38, s34, 12
    s_add_u32 s39, s38, 0x0
    v_add_u32 v40, s39, v9
    v_xor_b32 v41, 64, v40
    s_add_u32 s39, s38, 0x8800
    v_add_u32 v42, s39, v9
    v_xor_b32 v43, 64, v42
    s_add_u32 s39, s38, 0x11000
    v_add_u32 v44, s39, v9
    v_xor_b32 v45, 64, v44
    s_add_u32 s39, s38, 0x19800
    v_add_u32 v46, s39, v9
    v_xor_b32 v47, 64, v46
    s_waitcnt lgkmcnt(0)
    s_add_u32 s16, s6, 0x3000000
    s_addc_u32 s17, s7, 0
    s_mov_b32 s18, 0x1200000
    s_mov_b32 s19, 0x00020000
    s_cmp_ge_u32 s25, 2
    s_cbranch_scc1 KB_G4
    s_cmp_eq_u32 s25, 1
    s_cselect_b32 s38, s30, s28
    s_cselect_b32 s39, s31, s29
    s_mov_b32 s8, s38
    s_mov_b32 s9, s39
    s_mov_b32 s10, 0x800000
    s_mov_b32 s11, 0x00020000
    s_add_u32 s12, s6, 0x800000
    s_addc_u32 s13, s7, 0
    s_mov_b32 s14, 0x480000
    s_mov_b32 s15, 0x00020000
    s_mov_b32 s40, 0
    s_mov_b32 s41, 0
    s_lshl_b32 s42, s34, 5
    s_add_u32 s42, s42, 0
    v_add_u32 v10, s42, v7
    v_lshrrev_b32 v11, 1, v10
    v_and_b32 v11, 7, v11
    v_xor_b32 v11, v11, v8
    v_add_u32 v10, s35, v10
    v_mul_u32_u24 v10, 4096, v10
    v_lshl_add_u32 v20, v11, 4, v10
    s_lshl_b32 s42, s34, 5
    s_add_u32 s42, s42, 8
    v_add_u32 v10, s42, v7
    v_lshrrev_b32 v11, 1, v10
    v_and_b32 v11, 7, v11
    v_xor_b32 v11, v11, v8
    v_add_u32 v10, s35, v10
    v_mul_u32_u24 v10, 4096, v10
    v_lshl_add_u32 v21, v11, 4, v10
    s_lshl_b32 s42, s34, 5
    s_add_u32 s42, s42, 16
    v_add_u32 v10, s42, v7
    v_lshrrev_b32 v11, 1, v10
    v_and_b32 v11, 7, v11
    v_xor_b32 v11, v11, v8
    v_add_u32 v10, s35, v10
    v_mul_u32_u24 v10, 4096, v10
    v_lshl_add_u32 v22, v11, 4, v10
    s_lshl_b32 s42, s34, 5
    s_add_u32 s42, s42, 24
    v_add_u32 v10, s42, v7
    v_lshrrev_b32 v11, 1, v10
    v_and_b32 v11, 7, v11
    v_xor_b32 v11, v11, v8
    v_add_u32 v10, s35, v10
    v_mul_u32_u24 v10, 4096, v10
    v_lshl_add_u32 v23, v11, 4, v10
    s_mul_i32 s43, s34, 4608
    s_add_u32 s43, s43, 16384
    s_lshl_b32 s44, s34, 12
    s_mul_i32 s42, s34, 288
    v_add_u32 v10, s42, v2
    v_lshrrev_b32 v11, 3, v10
    v_lshrrev_b32 v12, 1, v11
    v_and_b32 v12, 7, v12
    v_xor_b32 v12, v12, v8
    s_mul_i32 s45, s27, 144
    s_mul_i32 s46, s25, 576
    s_add_u32 s45, s45, s46
    v_add_u32 v11, s45, v11
    v_lshlrev_b32 v11, 12, v11
    v_lshl_add_u32 v24, v12, 4, v11
    v_add_u32 v10, s42, v2
    v_add_u32 v10, 64, v10
    v_lshrrev_b32 v11, 3, v10
    v_lshrrev_b32 v12, 1, v11
    v_and_b32 v12, 7, v12
    v_xor_b32 v12, v12, v8
    s_mul_i32 s45, s27, 144
    s_mul_i32 s46, s25, 576
    s_add_u32 s45, s45, s46
    v_add_u32 v11, s45, v11
    v_lshlrev_b32 v11, 12, v11
    v_lshl_add_u32 v25, v12, 4, v11
    v_add_u32 v10, s42, v2
    v_add_u32 v10, 128, v10
    v_lshrrev_b32 v11, 3, v10
    v_lshrrev_b32 v12, 1, v11
    v_and_b32 v12, 7, v12
    v_xor_b32 v12, v12, v8
    s_mul_i32 s45, s27, 144
    s_mul_i32 s46, s25, 576
    s_add_u32 s45, s45, s46
    v_add_u32 v11, s45, v11
    v_lshlrev_b32 v11, 12, v11
    v_lshl_add_u32 v26, v12, 4, v11
    v_add_u32 v10, s42, v2
    v_add_u32 v10, 192, v10
    v_lshrrev_b32 v11, 3, v10
    v_lshrrev_b32 v12, 1, v11
    v_and_b32 v12, 7, v12
    v_xor_b32 v12, v12, v8
    s_mul_i32 s45, s27, 144
    s_mul_i32 s46, s25, 576
    s_add_u32 s45, s45, s46
    v_add_u32 v11, s45, v11
    v_lshlrev_b32 v11, 12, v11
    v_lshl_add_u32 v27, v12, 4, v11
    v_add_u32 v10, s42, v2
    v_add_u32 v10, 256, v10
    v_lshrrev_b32 v11, 3, v10
    v_lshrrev_b32 v12, 1, v11
    v_and_b32 v12, 7, v12
    v_xor_b32 v12, v12, v8
    s_mul_i32 s45, s27, 144
    s_mul_i32 s46, s25, 576
    s_add_u32 s45, s45, s46
    v_add_u32 v11, s45, v11
    v_lshlrev_b32 v11, 12, v11
    v_lshl_add_u32 v28, v12, 4, v11
    v_add_u32 v48, 0x4000, v9
    v_xor_b32 v49, 64, v48
    v_add_u32 v50, 0xc800, v9
    v_xor_b32 v51, 64, v50
    v_add_u32 v52, 0x15000, v9
    v_xor_b32 v53, 64, v52
    v_add_u32 v54, 0x1d800, v9
    v_xor_b32 v55, 64, v54
    s_cmp_lt_u32 s50, 4
    s_cbranch_scc1 KB_CONS2
    s_setprio 2
    s_add_u32 m0, s44, 0x0
    s_nop 0
    buffer_load_dwordx4 v20, s[8:11], s40 offen lds
    s_add_u32 m0, s44, 0x400
    s_nop 0
    buffer_load_dwordx4 v21, s[8:11], s40 offen lds
    s_add_u32 m0, s44, 0x800
    s_nop 0
    buffer_load_dwordx4 v22, s[8:11], s40 offen lds
    s_add_u32 m0, s44, 0xc00
    s_nop 0
    buffer_load_dwordx4 v23, s[8:11], s40 offen lds
    s_add_u32 m0, s43, 0x0
    s_nop 0
    buffer_load_dwordx4 v24, s[12:15], s41 offen lds
    s_add_u32 m0, s43, 0x400
    s_nop 0
    buffer_load_dwordx4 v25, s[12:15], s41 offen lds
    s_add_u32 m0, s43, 0x800
    s_nop 0
    buffer_load_dwordx4 v26, s[12:15], s41 offen lds
    s_add_u32 m0, s43, 0xc00
    s_nop 0
    buffer_load_dwordx4 v27, s[12:15], s41 offen lds
    s_add_u32 m0, s43, 0x1000
    s_nop 0
    s_mov_b64 exec, 0xffffffff
    buffer_load_dwordx4 v28, s[12:15], s41 offen lds
    s_mov_b64 exec, -1
    s_add_u32 s40, s40, 128
    s_add_u32 s41, s41, 0x80
    s_add_u32 m0, s44, 0x8800
    s_nop 0
    buffer_load_dwordx4 v20, s[8:11], s40 offen lds
    s_add_u32 m0, s44, 0x8c00
    s_nop 0
    buffer_load_dwordx4 v21, s[8:11], s40 offen lds
    s_add_u32 m0, s44, 0x9000
    s_nop 0
    buffer_load_dwordx4 v22, s[8:11], s40 offen lds
    s_add_u32 m0, s44, 0x9400
    s_nop 0
    buffer_load_dwordx4 v23, s[8:11], s40 offen lds
    s_add_u32 m0, s43, 0x8800
    s_nop 0
    buffer_load_dwordx4 v24, s[12:15], s41 offen lds
    s_add_u32 m0, s43, 0x8c00
    s_nop 0
    buffer_load_dwordx4 v25, s[12:15], s41 offen lds
    s_add_u32 m0, s43, 0x9000
    s_nop 0
    buffer_load_dwordx4 v26, s[12:15], s41 offen lds
    s_add_u32 m0, s43, 0x9400
    s_nop 0
    buffer_load_dwordx4 v27, s[12:15], s41 offen lds
    s_add_u32 m0, s43, 0x9800
    s_nop 0
    s_mov_b64 exec, 0xffffffff
    buffer_load_dwordx4 v28, s[12:15], s41 offen lds
    s_mov_b64 exec, -1
    s_add_u32 s40, s40, 128
    s_add_u32 s41, s41, 0x80
    s_add_u32 m0, s44, 0x11000
    s_nop 0
    buffer_load_dwordx4 v20, s[8:11], s40 offen lds
    s_add_u32 m0, s44, 0x11400
    s_nop 0
    buffer_load_dwordx4 v21, s[8:11], s40 offen lds
    s_add_u32 m0, s44, 0x11800
    s_nop 0
    buffer_load_dwordx4 v22, s[8:11], s40 offen lds
    s_add_u32 m0, s44, 0x11c00
    s_nop 0
    buffer_load_dwordx4 v23, s[8:11], s40 offen lds
    s_add_u32 m0, s43, 0x11000
    s_nop 0
    buffer_load_dwordx4 v24, s[12:15], s41 offen lds
    s_add_u32 m0, s43, 0x11400
    s_nop 0
    buffer_load_dwordx4 v25, s[12:15], s41 offen lds
    s_add_u32 m0, s43, 0x11800
    s_nop 0
    buffer_load_dwordx4 v26, s[12:15], s41 offen lds
    s_add_u32 m0, s43, 0x11c00
    s_nop 0
    buffer_load_dwordx4 v27, s[12:15], s41 offen lds
    s_add_u32 m0, s43, 0x12000
    s_nop 0
    s_mov_b64 exec, 0xffffffff
    buffer_load_dwordx4 v28, s[12:15], s41 offen lds
    s_mov_b64 exec, -1
    s_add_u32 s40, s40, 128
    s_add_u32 s41, s41, 0x80
    s_add_u32 m0, s44, 0x19800
    s_nop 0
    buffer_load_dwordx4 v20, s[8:11], s40 offen lds
    s_add_u32 m0, s44, 0x19c00
    s_nop 0
    buffer_load_dwordx4 v21, s[8:11], s40 offen lds
    s_add_u32 m0, s44, 0x1a000
    s_nop 0
    buffer_load_dwordx4 v22, s[8:11], s40 offen lds
    s_add_u32 m0, s44, 0x1a400
    s_nop 0
    buffer_load_dwordx4 v23, s[8:11], s40 offen lds
    s_add_u32 m0, s43, 0x19800
    s_nop 0
    buffer_load_dwordx4 v24, s[12:15], s41 offen lds
    s_add_u32 m0, s43, 0x19c00
    s_nop 0
    buffer_load_dwordx4 v25, s[12:15], s41 offen lds
    s_add_u32 m0, s43, 0x1a000
    s_nop 0
    buffer_load_dwordx4 v26, s[12:15], s41 offen lds
    s_add_u32 m0, s43, 0x1a400
    s_nop 0
    buffer_load_dwordx4 v27, s[12:15], s41 offen lds
    s_add_u32 m0, s43, 0x1a800
    s_nop 0
    s_mov_b64 exec, 0xffffffff
    buffer_load_dwordx4 v28, s[12:15], s41 offen lds
    s_mov_b64 exec, -1
    s_add_u32 s40, s40, 128
    s_add_u32 s41, s41, 0x80
    s_waitcnt vmcnt(27)
    s_barrier
    s_mov_b32 s47, 7
KB_PLOOP2:
    s_waitcnt vmcnt(18)
    s_barrier
    s_add_u32 m0, s44, 0x0
    s_nop 0
    buffer_load_dwordx4 v20, s[8:11], s40 offen lds
    s_add_u32 m0, s44, 0x400
    s_nop 0
    buffer_load_dwordx4 v21, s[8:11], s40 offen lds
    s_add_u32 m0, s44, 0x800
    s_nop 0
    buffer_load_dwordx4 v22, s[8:11], s40 offen lds
    s_add_u32 m0, s44, 0xc00
    s_nop 0
    buffer_load_dwordx4 v23, s[8:11], s40 offen lds
    s_add_u32 m0, s43, 0x0
    s_nop 0
    buffer_load_dwordx4 v24, s[12:15], s41 offen lds
    s_add_u32 m0, s43, 0x400
    s_nop 0
    buffer_load_dwordx4 v25, s[12:15], s41 offen lds
    s_add_u32 m0, s43, 0x800
    s_nop 0
    buffer_load_dwordx4 v26, s[12:15], s41 offen lds
    s_add_u32 m0, s43, 0xc00
    s_nop 0
    buffer_load_dwordx4 v27, s[12:15], s41 offen lds
    s_add_u32 m0, s43, 0x1000
    s_nop 0
    s_mov_b64 exec, 0xffffffff
    buffer_load_dwordx4 v28, s[12:15], s41 offen lds
    s_mov_b64 exec, -1
    s_add_u32 s40, s40, 128
    s_add_u32 s41, s41, 0x80
    s_waitcnt vmcnt(18)
    s_barrier
    s_add_u32 m0, s44, 0x8800
    s_nop 0
    buffer_load_dwordx4 v20, s[8:11], s40 offen lds
    s_add_u32 m0, s44, 0x8c00
    s_nop 0
    buffer_load_dwordx4 v21, s[8:11], s40 offen lds
    s_add_u32 m0, s44, 0x9000
    s_nop 0
    buffer_load_dwordx4 v22, s[8:11], s40 offen lds
    s_add_u32 m0, s44, 0x9400
    s_nop 0
    buffer_load_dwordx4 v23, s[8:11], s40 offen lds
    s_add_u32 m0, s43, 0x8800
    s_nop 0
    buffer_load_dwordx4 v24, s[12:15], s41 offen lds
    s_add_u32 m0, s43, 0x8c00
    s_nop 0
    buffer_load_dwordx4 v25, s[12:15], s41 offen lds
    s_add_u32 m0, s43, 0x9000
    s_nop 0
    buffer_load_dwordx4 v26, s[12:15], s41 offen lds
    s_add_u32 m0, s43, 0x9400
    s_nop 0
    buffer_load_dwordx4 v27, s[12:15], s41 offen lds
    s_add_u32 m0, s43, 0x9800
    s_nop 0
    s_mov_b64 exec, 0xffffffff
    buffer_load_dwordx4 v28, s[12:15], s41 offen lds
    s_mov_b64 exec, -1
    s_add_u32 s40, s40, 128
    s_add_u32 s41, s41, 0x80
    s_waitcnt vmcnt(18)
    s_barrier
    s_add_u32 m0, s44, 0x11000
    s_nop 0
    buffer_load_dwordx4 v20, s[8:11], s40 offen lds
    s_add_u32 m0, s44, 0x11400
    s_nop 0
    buffer_load_dwordx4 v21, s[8:11], s40 offen lds
    s_add_u32 m0, s44, 0x11800
    s_nop 0
    buffer_load_dwordx4 v22, s[8:11], s40 offen lds
    s_add_u32 m0, s44, 0x11c00
    s_nop 0
    buffer_load_dwordx4 v23, s[8:11], s40 offen lds
    s_add_u32 m0, s43, 0x11000
    s_nop 0
    buffer_load_dwordx4 v24, s[12:15], s41 offen lds
    s_add_u32 m0, s43, 0x11400
    s_nop 0
    buffer_load_dwordx4 v25, s[12:15], s41 offen lds
    s_add_u32 m0, s43, 0x11800
    s_nop 0
    buffer_load_dwordx4 v26, s[12:15], s41 offen lds
    s_add_u32 m0, s43, 0x11c00
    s_nop 0
    buffer_load_dwordx4 v27, s[12:15], s41 offen lds
    s_add_u32 m0, s43, 0x12000
    s_nop 0
    s_mov_b64 exec, 0xffffffff
    buffer_load_dwordx4 v28, s[12:15], s41 offen lds
    s_mov_b64 exec, -1
    s_add_u32 s40, s40, 128
    s_add_u32 s41, s41, 0x80
    s_waitcnt vmcnt(18)
    s_barrier
    s_add_u32 m0, s44, 0x19800
    s_nop 0
    buffer_load_dwordx4 v20, s[8:11], s40 offen lds
    s_add_u32 m0, s44, 0x19c00
    s_nop 0
    buffer_load_dwordx4 v21, s[8:11], s40 offen lds
    s_add_u32 m0, s44, 0x1a000
    s_nop 0
    buffer_load_dwordx4 v22, s[8:11], s40 offen lds
    s_add_u32 m0, s44, 0x1a400
    s_nop 0
    buffer_load_dwordx4 v23, s[8:11], s40 offen lds
    s_add_u32 m0, s43, 0x19800
    s_nop 0
    buffer_load_dwordx4 v24, s[12:15], s41 offen lds
    s_add_u32 m0, s43, 0x19c00
    s_nop 0
    buffer_load_dwordx4 v25, s[12:15], s41 offen lds
    s_add_u32 m0, s43, 0x1a000
    s_nop 0
    buffer_load_dwordx4 v26, s[12:15], s41 offen lds
    s_add_u32 m0, s43, 0x1a400
    s_nop 0
    buffer_load_dwordx4 v27, s[12:15], s41 offen lds
    s_add_u32 m0, s43, 0x1a800
    s_nop 0
    s_mov_b64 exec, 0xffffffff
    buffer_load_dwordx4 v28, s[12:15], s41 offen lds
    s_mov_b64 exec, -1
    s_add_u32 s40, s40, 128
    s_add_u32 s41, s41, 0x80
    s_sub_u32 s47, s47, 1
    s_cmp_lg_u32 s47, 0
    s_cbranch_scc1 KB_PLOOP2
    s_waitcnt vmcnt(18)
    s_barrier
    s_waitcnt vmcnt(9)
    s_barrier
    s_waitcnt vmcnt(0)
    s_barrier
    s_endpgm
KB_CONS2:
    v_mov_b32 v160, 0
    v_mov_b32 v161, 0
    v_mov_b32 v162, 0
    v_mov_b32 v163, 0
    v_mov_b32 v164, 0
    v_mov_b32 v165, 0
    v_mov_b32 v166, 0
    v_mov_b32 v167, 0
    v_mov_b32 v168, 0
    v_mov_b32 v169, 0
    v_mov_b32 v170, 0
    v_mov_b32 v171, 0
    v_mov_b32 v172, 0
    v_mov_b32 v173, 0
    v_mov_b32 v174, 0
    v_mov_b32 v175, 0
    v_mov_b32 v176, 0
    v_mov_b32 v177, 0
    v_mov_b32 v178, 0
    v_mov_b32 v179, 0
    v_mov_b32 v180, 0
    v_mov_b32 v181, 0
    v_mov_b32 v182, 0
    v_mov_b32 v183, 0
    v_mov_b32 v184, 0
    v_mov_b32 v185, 0
    v_mov_b32 v186, 0
    v_mov_b32 v187, 0
    v_mov_b32 v188, 0
    v_mov_b32 v189, 0
    v_mov_b32 v190, 0
    v_mov_b32 v191, 0
    v_mov_b32 v192, 0
    v_mov_b32 v193, 0
    v_mov_b32 v194, 0
    v_mov_b32 v195, 0
    v_mov_b32 v196, 0
    v_mov_b32 v197, 0
    v_mov_b32 v198, 0
    v_mov_b32 v199, 0
    v_mov_b32 v200, 0
    v_mov_b32 v201, 0
    v_mov_b32 v202, 0
    v_mov_b32 v203, 0
    v_mov_b32 v204, 0
    v_mov_b32 v205, 0
    v_mov_b32 v206, 0
    v_mov_b32 v207, 0
    v_mov_b32 v208, 0
    v_mov_b32 v209, 0
    v_mov_b32 v210, 0
    v_mov_b32 v211, 0
    v_mov_b32 v212, 0
    v_mov_b32 v213, 0
    v_mov_b32 v214, 0
    v_mov_b32 v215, 0
    v_mov_b32 v216, 0
    v_mov_b32 v217, 0
    v_mov_b32 v218, 0
    v_mov_b32 v219, 0
    v_mov_b32 v220, 0
    v_mov_b32 v221, 0
    v_mov_b32 v222, 0
    v_mov_b32 v223, 0
    v_mov_b32 v224, 0
    v_mov_b32 v225, 0
    v_mov_b32 v226, 0
    v_mov_b32 v227, 0
    v_mov_b32 v228, 0
    v_mov_b32 v229, 0
    v_mov_b32 v230, 0
    v_mov_b32 v231, 0
    s_barrier
    ds_read_b128 v[64:67], v40 offset:0
    ds_read_b128 v[68:71], v40 offset:2048
    ds_read_b128 v[72:75], v48 offset:0
    ds_read_b128 v[76:79], v48 offset:2048
    ds_read_b128 v[80:83], v48 offset:4096
    ds_read_b128 v[84:87], v48 offset:6144
    ds_read_b128 v[88:91], v48 offset:8192
    ds_read_b128 v[92:95], v48 offset:10240
    ds_read_b128 v[96:99], v48 offset:12288
    ds_read_b128 v[100:103], v48 offset:14336
    ds_read_b128 v[104:107], v48 offset:16384
    s_mov_b32 s47, 7
KB_LOOP2:
    s_waitcnt lgkmcnt(0)
    v_mfma_f32_16x16x32_bf16 v[160:163], v[72:75], v[64:67], v[160:163]
    ds_read_b128 v[112:115], v41 offset:0
    v_mfma_f32_16x16x32_bf16 v[164:167], v[72:75], v[68:71], v[164:167]
    ds_read_b128 v[116:119], v41 offset:2048
    v_mfma_f32_16x16x32_bf16 v[168:171], v[76:79], v[64:67], v[168:171]
    ds_read_b128 v[120:123], v49 offset:0
    v_mfma_f32_16x16x32_bf16 v[172:175], v[76:79], v[68:71], v[172:175]
    ds_read_b128 v[124:127], v49 offset:2048
    v_mfma_f32_16x16x32_bf16 v[176:179], v[80:83], v[64:67], v[176:179]
    ds_read_b128 v[128:131], v49 offset:4096
    v_mfma_f32_16x16x32_bf16 v[180:183], v[80:83], v[68:71], v[180:183]
    ds_read_b128 v[132:135], v49 offset:6144
    v_mfma_f32_16x16x32_bf16 v[184:187], v[84:87], v[64:67], v[184:187]
    ds_read_b128 v[136:139], v49 offset:8192
    v_mfma_f32_16x16x32_bf16 v[188:191], v[84:87], v[68:71], v[188:191]
    ds_read_b128 v[140:143], v49 offset:10240
    v_mfma_f32_16x16x32_bf16 v[192:195], v[88:91], v[64:67], v[192:195]
    ds_read_b128 v[144:147], v49 offset:12288
    v_mfma_f32_16x16x32_bf16 v[196:199], v[88:91], v[68:71], v[196:199]
    ds_read_b128 v[148:151], v49 offset:14336
    v_mfma_f32_16x16x32_bf16 v[200:203], v[92:95], v[64:67], v[200:203]
    ds_read_b128 v[152:155], v49 offset:16384
    v_mfma_f32_16x16x32_bf16 v[204:207], v[92:95], v[68:71], v[204:207]
    v_mfma_f32_16x16x32_bf16 v[208:211], v[96:99], v[64:67], v[208:211]
    v_mfma_f32_16x16x32_bf16 v[212:215], v[96:99], v[68:71], v[212:215]
    v_mfma_f32_16x16x32_bf16 v[216:219], v[100:103], v[64:67], v[216:219]
    v_mfma_f32_16x16x32_bf16 v[220:223], v[100:103], v[68:71], v[220:223]
    v_mfma_f32_16x16x32_bf16 v[224:227], v[104:107], v[64:67], v[224:227]
    v_mfma_f32_16x16x32_bf16 v[228:231], v[104:107], v[68:71], v[228:231]
    s_waitcnt lgkmcnt(0)
    s_barrier
    v_mfma_f32_16x16x32_bf16 v[160:163], v[120:123], v[112:115], v[160:163]
    ds_read_b128 v[64:67], v42 offset:0
    v_mfma_f32_16x16x32_bf16 v[164:167], v[120:123], v[116:119], v[164:167]
    ds_read_b128 v[68:71], v42 offset:2048
    v_mfma_f32_16x16x32_bf16 v[168:171], v[124:127], v[112:115], v[168:171]
    ds_read_b128 v[72:75], v50 offset:0
    v_mfma_f32_16x16x32_bf16 v[172:175], v[124:127], v[116:119], v[172:175]
    ds_read_b128 v[76:79], v50 offset:2048
    v_mfma_f32_16x16x32_bf16 v[176:179], v[128:131], v[112:115], v[176:179]
    ds_read_b128 v[80:83], v50 offset:4096
    v_mfma_f32_16x16x32_bf16 v[180:183], v[128:131], v[116:119], v[180:183]
    ds_read_b128 v[84:87], v50 offset:6144
    v_mfma_f32_16x16x32_bf16 v[184:187], v[132:135], v[112:115], v[184:187]
    ds_read_b128 v[88:91], v50 offset:8192
    v_mfma_f32_16x16x32_bf16 v[188:191], v[132:135], v[116:119], v[188:191]
    ds_read_b128 v[92:95], v50 offset:10240
    v_mfma_f32_16x16x32_bf16 v[192:195], v[136:139], v[112:115], v[192:195]
    ds_read_b128 v[96:99], v50 offset:12288
    v_mfma_f32_16x16x32_bf16 v[196:199], v[136:139], v[116:119], v[196:199]
    ds_read_b128 v[100:103], v50 offset:14336
    v_mfma_f32_16x16x32_bf16 v[200:203], v[140:143], v[112:115], v[200:203]
    ds_read_b128 v[104:107], v50 offset:16384
    v_mfma_f32_16x16x32_bf16 v[204:207], v[140:143], v[116:119], v[204:207]
    v_mfma_f32_16x16x32_bf16 v[208:211], v[144:147], v[112:115], v[208:211]
    v_mfma_f32_16x16x32_bf16 v[212:215], v[144:147], v[116:119], v[212:215]
    v_mfma_f32_16x16x32_bf16 v[216:219], v[148:151], v[112:115], v[216:219]
    v_mfma_f32_16x16x32_bf16 v[220:223], v[148:151], v[116:119], v[220:223]
    v_mfma_f32_16x16x32_bf16 v[224:227], v[152:155], v[112:115], v[224:227]
    v_mfma_f32_16x16x32_bf16 v[228:231], v[152:155], v[116:119], v[228:231]
    s_waitcnt lgkmcnt(0)
    v_mfma_f32_16x16x32_bf16 v[160:163], v[72:75], v[64:67], v[160:163]
    ds_read_b128 v[112:115], v43 offset:0
    v_mfma_f32_16x16x32_bf16 v[164:167], v[72:75], v[68:71], v[164:167]
    ds_read_b128 v[116:119], v43 offset:2048
    v_mfma_f32_16x16x32_bf16 v[168:171], v[76:79], v[64:67], v[168:171]
    ds_read_b128 v[120:123], v51 offset:0
    v_mfma_f32_16x16x32_bf16 v[172:175], v[76:79], v[68:71], v[172:175]
    ds_read_b128 v[124:127], v51 offset:2048
    v_mfma_f32_16x16x32_bf16 v[176:179], v[80:83], v[64:67], v[176:179]
    ds_read_b128 v[128:131], v51 offset:4096
    v_mfma_f32_16x16x32_bf16 v[180:183], v[80:83], v[68:71], v[180:183]
    ds_read_b128 v[132:135], v51 offset:6144
    v_mfma_f32_16x16x32_bf16 v[184:187], v[84:87], v[64:67], v[184:187]
    ds_read_b128 v[136:139], v51 offset:8192
    v_mfma_f32_16x16x32_bf16 v[188:191], v[84:87], v[68:71], v[188:191]
    ds_read_b128 v[140:143], v51 offset:10240
    v_mfma_f32_16x16x32_bf16 v[192:195], v[88:91], v[64:67], v[192:195]
    ds_read_b128 v[144:147], v51 offset:12288
    v_mfma_f32_16x16x32_bf16 v[196:199], v[88:91], v[68:71], v[196:199]
    ds_read_b128 v[148:151], v51 offset:14336
    v_mfma_f32_16x16x32_bf16 v[200:203], v[92:95], v[64:67], v[200:203]
    ds_read_b128 v[152:155], v51 offset:16384
    v_mfma_f32_16x16x32_bf16 v[204:207], v[92:95], v[68:71], v[204:207]
    v_mfma_f32_16x16x32_bf16 v[208:211], v[96:99], v[64:67], v[208:211]
    v_mfma_f32_16x16x32_bf16 v[212:215], v[96:99], v[68:71], v[212:215]
    v_mfma_f32_16x16x32_bf16 v[216:219], v[100:103], v[64:67], v[216:219]
    v_mfma_f32_16x16x32_bf16 v[220:223], v[100:103], v[68:71], v[220:223]
    v_mfma_f32_16x16x32_bf16 v[224:227], v[104:107], v[64:67], v[224:227]
    v_mfma_f32_16x16x32_bf16 v[228:231], v[104:107], v[68:71], v[228:231]
    s_waitcnt lgkmcnt(0)
    s_barrier
    v_mfma_f32_16x16x32_bf16 v[160:163], v[120:123], v[112:115], v[160:163]
    ds_read_b128 v[64:67], v44 offset:0
    v_mfma_f32_16x16x32_bf16 v[164:167], v[120:123], v[116:119], v[164:167]
    ds_read_b128 v[68:71], v44 offset:2048
    v_mfma_f32_16x16x32_bf16 v[168:171], v[124:127], v[112:115], v[168:171]
    ds_read_b128 v[72:75], v52 offset:0
    v_mfma_f32_16x16x32_bf16 v[172:175], v[124:127], v[116:119], v[172:175]
    ds_read_b128 v[76:79], v52 offset:2048
    v_mfma_f32_16x16x32_bf16 v[176:179], v[128:131], v[112:115], v[176:179]
    ds_read_b128 v[80:83], v52 offset:4096
    v_mfma_f32_16x16x32_bf16 v[180:183], v[128:131], v[116:119], v[180:183]
    ds_read_b128 v[84:87], v52 offset:6144
    v_mfma_f32_16x16x32_bf16 v[184:187], v[132:135], v[112:115], v[184:187]
    ds_read_b128 v[88:91], v52 offset:8192
    v_mfma_f32_16x16x32_bf16 v[188:191], v[132:135], v[116:119], v[188:191]
    ds_read_b128 v[92:95], v52 offset:10240
    v_mfma_f32_16x16x32_bf16 v[192:195], v[136:139], v[112:115], v[192:195]
    ds_read_b128 v[96:99], v52 offset:12288
    v_mfma_f32_16x16x32_bf16 v[196:199], v[136:139], v[116:119], v[196:199]
    ds_read_b128 v[100:103], v52 offset:14336
    v_mfma_f32_16x16x32_bf16 v[200:203], v[140:143], v[112:115], v[200:203]
    ds_read_b128 v[104:107], v52 offset:16384
    v_mfma_f32_16x16x32_bf16 v[204:207], v[140:143], v[116:119], v[204:207]
    v_mfma_f32_16x16x32_bf16 v[208:211], v[144:147], v[112:115], v[208:211]
    v_mfma_f32_16x16x32_bf16 v[212:215], v[144:147], v[116:119], v[212:215]
    v_mfma_f32_16x16x32_bf16 v[216:219], v[148:151], v[112:115], v[216:219]
    v_mfma_f32_16x16x32_bf16 v[220:223], v[148:151], v[116:119], v[220:223]
    v_mfma_f32_16x16x32_bf16 v[224:227], v[152:155], v[112:115], v[224:227]
    v_mfma_f32_16x16x32_bf16 v[228:231], v[152:155], v[116:119], v[228:231]
    s_waitcnt lgkmcnt(0)
    v_mfma_f32_16x16x32_bf16 v[160:163], v[72:75], v[64:67], v[160:163]
    ds_read_b128 v[112:115], v45 offset:0
    v_mfma_f32_16x16x32_bf16 v[164:167], v[72:75], v[68:71], v[164:167]
    ds_read_b128 v[116:119], v45 offset:2048
    v_mfma_f32_16x16x32_bf16 v[168:171], v[76:79], v[64:67], v[168:171]
    ds_read_b128 v[120:123], v53 offset:0
    v_mfma_f32_16x16x32_bf16 v[172:175], v[76:79], v[68:71], v[172:175]
    ds_read_b128 v[124:127], v53 offset:2048
    v_mfma_f32_16x16x32_bf16 v[176:179], v[80:83], v[64:67], v[176:179]
    ds_read_b128 v[128:131], v53 offset:4096
    v_mfma_f32_16x16x32_bf16 v[180:183], v[80:83], v[68:71], v[180:183]
    ds_read_b128 v[132:135], v53 offset:6144
    v_mfma_f32_16x16x32_bf16 v[184:187], v[84:87], v[64:67], v[184:187]
    ds_read_b128 v[136:139], v53 offset:8192
    v_mfma_f32_16x16x32_bf16 v[188:191], v[84:87], v[68:71], v[188:191]
    ds_read_b128 v[140:143], v53 offset:10240
    v_mfma_f32_16x16x32_bf16 v[192:195], v[88:91], v[64:67], v[192:195]
    ds_read_b128 v[144:147], v53 offset:12288
    v_mfma_f32_16x16x32_bf16 v[196:199], v[88:91], v[68:71], v[196:199]
    ds_read_b128 v[148:151], v53 offset:14336
    v_mfma_f32_16x16x32_bf16 v[200:203], v[92:95], v[64:67], v[200:203]
    ds_read_b128 v[152:155], v53 offset:16384
    v_mfma_f32_16x16x32_bf16 v[204:207], v[92:95], v[68:71], v[204:207]
    v_mfma_f32_16x16x32_bf16 v[208:211], v[96:99], v[64:67], v[208:211]
    v_mfma_f32_16x16x32_bf16 v[212:215], v[96:99], v[68:71], v[212:215]
    v_mfma_f32_16x16x32_bf16 v[216:219], v[100:103], v[64:67], v[216:219]
    v_mfma_f32_16x16x32_bf16 v[220:223], v[100:103], v[68:71], v[220:223]
    v_mfma_f32_16x16x32_bf16 v[224:227], v[104:107], v[64:67], v[224:227]
    v_mfma_f32_16x16x32_bf16 v[228:231], v[104:107], v[68:71], v[228:231]
    s_waitcnt lgkmcnt(0)
    s_barrier
    v_mfma_f32_16x16x32_bf16 v[160:163], v[120:123], v[112:115], v[160:163]
    ds_read_b128 v[64:67], v46 offset:0
    v_mfma_f32_16x16x32_bf16 v[164:167], v[120:123], v[116:119], v[164:167]
    ds_read_b128 v[68:71], v46 offset:2048
    v_mfma_f32_16x16x32_bf16 v[168:171], v[124:127], v[112:115], v[168:171]
    ds_read_b128 v[72:75], v54 offset:0
    v_mfma_f32_16x16x32_bf16 v[172:175], v[124:127], v[116:119], v[172:175]
    ds_read_b128 v[76:79], v54 offset:2048
    v_mfma_f32_16x16x32_bf16 v[176:179], v[128:131], v[112:115], v[176:179]
    ds_read_b128 v[80:83], v54 offset:4096
    v_mfma_f32_16x16x32_bf16 v[180:183], v[128:131], v[116:119], v[180:183]
    ds_read_b128 v[84:87], v54 offset:6144
    v_mfma_f32_16x16x32_bf16 v[184:187], v[132:135], v[112:115], v[184:187]
    ds_read_b128 v[88:91], v54 offset:8192
    v_mfma_f32_16x16x32_bf16 v[188:191], v[132:135], v[116:119], v[188:191]
    ds_read_b128 v[92:95], v54 offset:10240
    v_mfma_f32_16x16x32_bf16 v[192:195], v[136:139], v[112:115], v[192:195]
    ds_read_b128 v[96:99], v54 offset:12288
    v_mfma_f32_16x16x32_bf16 v[196:199], v[136:139], v[116:119], v[196:199]
    ds_read_b128 v[100:103], v54 offset:14336
    v_mfma_f32_16x16x32_bf16 v[200:203], v[140:143], v[112:115], v[200:203]
    ds_read_b128 v[104:107], v54 offset:16384
    v_mfma_f32_16x16x32_bf16 v[204:207], v[140:143], v[116:119], v[204:207]
    v_mfma_f32_16x16x32_bf16 v[208:211], v[144:147], v[112:115], v[208:211]
    v_mfma_f32_16x16x32_bf16 v[212:215], v[144:147], v[116:119], v[212:215]
    v_mfma_f32_16x16x32_bf16 v[216:219], v[148:151], v[112:115], v[216:219]
    v_mfma_f32_16x16x32_bf16 v[220:223], v[148:151], v[116:119], v[220:223]
    v_mfma_f32_16x16x32_bf16 v[224:227], v[152:155], v[112:115], v[224:227]
    v_mfma_f32_16x16x32_bf16 v[228:231], v[152:155], v[116:119], v[228:231]
    s_waitcnt lgkmcnt(0)
    v_mfma_f32_16x16x32_bf16 v[160:163], v[72:75], v[64:67], v[160:163]
    ds_read_b128 v[112:115], v47 offset:0
    v_mfma_f32_16x16x32_bf16 v[164:167], v[72:75], v[68:71], v[164:167]
    ds_read_b128 v[116:119], v47 offset:2048
    v_mfma_f32_16x16x32_bf16 v[168:171], v[76:79], v[64:67], v[168:171]
    ds_read_b128 v[120:123], v55 offset:0
    v_mfma_f32_16x16x32_bf16 v[172:175], v[76:79], v[68:71], v[172:175]
    ds_read_b128 v[124:127], v55 offset:2048
    v_mfma_f32_16x16x32_bf16 v[176:179], v[80:83], v[64:67], v[176:179]
    ds_read_b128 v[128:131], v55 offset:4096
    v_mfma_f32_16x16x32_bf16 v[180:183], v[80:83], v[68:71], v[180:183]
    ds_read_b128 v[132:135], v55 offset:6144
    v_mfma_f32_16x16x32_bf16 v[184:187], v[84:87], v[64:67], v[184:187]
    ds_read_b128 v[136:139], v55 offset:8192
    v_mfma_f32_16x16x32_bf16 v[188:191], v[84:87], v[68:71], v[188:191]
    ds_read_b128 v[140:143], v55 offset:10240
    v_mfma_f32_16x16x32_bf16 v[192:195], v[88:91], v[64:67], v[192:195]
    ds_read_b128 v[144:147], v55 offset:12288
    v_mfma_f32_16x16x32_bf16 v[196:199], v[88:91], v[68:71], v[196:199]
    ds_read_b128 v[148:151], v55 offset:14336
    v_mfma_f32_16x16x32_bf16 v[200:203], v[92:95], v[64:67], v[200:203]
    ds_read_b128 v[152:155], v55 offset:16384
    v_mfma_f32_16x16x32_bf16 v[204:207], v[92:95], v[68:71], v[204:207]
    v_mfma_f32_16x16x32_bf16 v[208:211], v[96:99], v[64:67], v[208:211]
    v_mfma_f32_16x16x32_bf16 v[212:215], v[96:99], v[68:71], v[212:215]
    v_mfma_f32_16x16x32_bf16 v[216:219], v[100:103], v[64:67], v[216:219]
    v_mfma_f32_16x16x32_bf16 v[220:223], v[100:103], v[68:71], v[220:223]
    v_mfma_f32_16x16x32_bf16 v[224:227], v[104:107], v[64:67], v[224:227]
    v_mfma_f32_16x16x32_bf16 v[228:231], v[104:107], v[68:71], v[228:231]
    s_waitcnt lgkmcnt(0)
    s_barrier
    v_mfma_f32_16x16x32_bf16 v[160:163], v[120:123], v[112:115], v[160:163]
    ds_read_b128 v[64:67], v40 offset:0
    v_mfma_f32_16x16x32_bf16 v[164:167], v[120:123], v[116:119], v[164:167]
    ds_read_b128 v[68:71], v40 offset:2048
    v_mfma_f32_16x16x32_bf16 v[168:171], v[124:127], v[112:115], v[168:171]
    ds_read_b128 v[72:75], v48 offset:0
    v_mfma_f32_16x16x32_bf16 v[172:175], v[124:127], v[116:119], v[172:175]
    ds_read_b128 v[76:79], v48 offset:2048
    v_mfma_f32_16x16x32_bf16 v[176:179], v[128:131], v[112:115], v[176:179]
    ds_read_b128 v[80:83], v48 offset:4096
    v_mfma_f32_16x16x32_bf16 v[180:183], v[128:131], v[116:119], v[180:183]
    ds_read_b128 v[84:87], v48 offset:6144
    v_mfma_f32_16x16x32_bf16 v[184:187], v[132:135], v[112:115], v[184:187]
    ds_read_b128 v[88:91], v48 offset:8192
    v_mfma_f32_16x16x32_bf16 v[188:191], v[132:135], v[116:119], v[188:191]
    ds_read_b128 v[92:95], v48 offset:10240
    v_mfma_f32_16x16x32_bf16 v[192:195], v[136:139], v[112:115], v[192:195]
    ds_read_b128 v[96:99], v48 offset:12288
    v_mfma_f32_16x16x32_bf16 v[196:199], v[136:139], v[116:119], v[196:199]
    ds_read_b128 v[100:103], v48 offset:14336
    v_mfma_f32_16x16x32_bf16 v[200:203], v[140:143], v[112:115], v[200:203]
    ds_read_b128 v[104:107], v48 offset:16384
    v_mfma_f32_16x16x32_bf16 v[204:207], v[140:143], v[116:119], v[204:207]
    v_mfma_f32_16x16x32_bf16 v[208:211], v[144:147], v[112:115], v[208:211]
    v_mfma_f32_16x16x32_bf16 v[212:215], v[144:147], v[116:119], v[212:215]
    v_mfma_f32_16x16x32_bf16 v[216:219], v[148:151], v[112:115], v[216:219]
    v_mfma_f32_16x16x32_bf16 v[220:223], v[148:151], v[116:119], v[220:223]
    v_mfma_f32_16x16x32_bf16 v[224:227], v[152:155], v[112:115], v[224:227]
    v_mfma_f32_16x16x32_bf16 v[228:231], v[152:155], v[116:119], v[228:231]
    s_sub_u32 s47, s47, 1
    s_cmp_lg_u32 s47, 0
    s_cbranch_scc1 KB_LOOP2
    s_waitcnt lgkmcnt(0)
    v_mfma_f32_16x16x32_bf16 v[160:163], v[72:75], v[64:67], v[160:163]
    ds_read_b128 v[112:115], v41 offset:0
    v_mfma_f32_16x16x32_bf16 v[164:167], v[72:75], v[68:71], v[164:167]
    ds_read_b128 v[116:119], v41 offset:2048
    v_mfma_f32_16x16x32_bf16 v[168:171], v[76:79], v[64:67], v[168:171]
    ds_read_b128 v[120:123], v49 offset:0
    v_mfma_f32_16x16x32_bf16 v[172:175], v[76:79], v[68:71], v[172:175]
    ds_read_b128 v[124:127], v49 offset:2048
    v_mfma_f32_16x16x32_bf16 v[176:179], v[80:83], v[64:67], v[176:179]
    ds_read_b128 v[128:131], v49 offset:4096
    v_mfma_f32_16x16x32_bf16 v[180:183], v[80:83], v[68:71], v[180:183]
    ds_read_b128 v[132:135], v49 offset:6144
    v_mfma_f32_16x16x32_bf16 v[184:187], v[84:87], v[64:67], v[184:187]
    ds_read_b128 v[136:139], v49 offset:8192
    v_mfma_f32_16x16x32_bf16 v[188:191], v[84:87], v[68:71], v[188:191]
    ds_read_b128 v[140:143], v49 offset:10240
    v_mfma_f32_16x16x32_bf16 v[192:195], v[88:91], v[64:67], v[192:195]
    ds_read_b128 v[144:147], v49 offset:12288
    v_mfma_f32_16x16x32_bf16 v[196:199], v[88:91], v[68:71], v[196:199]
    ds_read_b128 v[148:151], v49 offset:14336
    v_mfma_f32_16x16x32_bf16 v[200:203], v[92:95], v[64:67], v[200:203]
    ds_read_b128 v[152:155], v49 offset:16384
    v_mfma_f32_16x16x32_bf16 v[204:207], v[92:95], v[68:71], v[204:207]
    v_mfma_f32_16x16x32_bf16 v[208:211], v[96:99], v[64:67], v[208:211]
    v_mfma_f32_16x16x32_bf16 v[212:215], v[96:99], v[68:71], v[212:215]
    v_mfma_f32_16x16x32_bf16 v[216:219], v[100:103], v[64:67], v[216:219]
    v_mfma_f32_16x16x32_bf16 v[220:223], v[100:103], v[68:71], v[220:223]
    v_mfma_f32_16x16x32_bf16 v[224:227], v[104:107], v[64:67], v[224:227]
    v_mfma_f32_16x16x32_bf16 v[228:231], v[104:107], v[68:71], v[228:231]
    s_waitcnt lgkmcnt(0)
    s_barrier
    v_mfma_f32_16x16x32_bf16 v[160:163], v[120:123], v[112:115], v[160:163]
    ds_read_b128 v[64:67], v42 offset:0
    v_mfma_f32_16x16x32_bf16 v[164:167], v[120:123], v[116:119], v[164:167]
    ds_read_b128 v[68:71], v42 offset:2048
    v_mfma_f32_16x16x32_bf16 v[168:171], v[124:127], v[112:115], v[168:171]
    ds_read_b128 v[72:75], v50 offset:0
    v_mfma_f32_16x16x32_bf16 v[172:175], v[124:127], v[116:119], v[172:175]
    ds_read_b128 v[76:79], v50 offset:2048
    v_mfma_f32_16x16x32_bf16 v[176:179], v[128:131], v[112:115], v[176:179]
    ds_read_b128 v[80:83], v50 offset:4096
    v_mfma_f32_16x16x32_bf16 v[180:183], v[128:131], v[116:119], v[180:183]
    ds_read_b128 v[84:87], v50 offset:6144
    v_mfma_f32_16x16x32_bf16 v[184:187], v[132:135], v[112:115], v[184:187]
    ds_read_b128 v[88:91], v50 offset:8192
    v_mfma_f32_16x16x32_bf16 v[188:191], v[132:135], v[116:119], v[188:191]
    ds_read_b128 v[92:95], v50 offset:10240
    v_mfma_f32_16x16x32_bf16 v[192:195], v[136:139], v[112:115], v[192:195]
    ds_read_b128 v[96:99], v50 offset:12288
    v_mfma_f32_16x16x32_bf16 v[196:199], v[136:139], v[116:119], v[196:199]
    ds_read_b128 v[100:103], v50 offset:14336
    v_mfma_f32_16x16x32_bf16 v[200:203], v[140:143], v[112:115], v[200:203]
    ds_read_b128 v[104:107], v50 offset:16384
    v_mfma_f32_16x16x32_bf16 v[204:207], v[140:143], v[116:119], v[204:207]
    v_mfma_f32_16x16x32_bf16 v[208:211], v[144:147], v[112:115], v[208:211]
    v_mfma_f32_16x16x32_bf16 v[212:215], v[144:147], v[116:119], v[212:215]
    v_mfma_f32_16x16x32_bf16 v[216:219], v[148:151], v[112:115], v[216:219]
    v_mfma_f32_16x16x32_bf16 v[220:223], v[148:151], v[116:119], v[220:223]
    v_mfma_f32_16x16x32_bf16 v[224:227], v[152:155], v[112:115], v[224:227]
    v_mfma_f32_16x16x32_bf16 v[228:231], v[152:155], v[116:119], v[228:231]
    s_waitcnt lgkmcnt(0)
    v_mfma_f32_16x16x32_bf16 v[160:163], v[72:75], v[64:67], v[160:163]
    ds_read_b128 v[112:115], v43 offset:0
    v_mfma_f32_16x16x32_bf16 v[164:167], v[72:75], v[68:71], v[164:167]
    ds_read_b128 v[116:119], v43 offset:2048
    v_mfma_f32_16x16x32_bf16 v[168:171], v[76:79], v[64:67], v[168:171]
    ds_read_b128 v[120:123], v51 offset:0
    v_mfma_f32_16x16x32_bf16 v[172:175], v[76:79], v[68:71], v[172:175]
    ds_read_b128 v[124:127], v51 offset:2048
    v_mfma_f32_16x16x32_bf16 v[176:179], v[80:83], v[64:67], v[176:179]
    ds_read_b128 v[128:131], v51 offset:4096
    v_mfma_f32_16x16x32_bf16 v[180:183], v[80:83], v[68:71], v[180:183]
    ds_read_b128 v[132:135], v51 offset:6144
    v_mfma_f32_16x16x32_bf16 v[184:187], v[84:87], v[64:67], v[184:187]
    ds_read_b128 v[136:139], v51 offset:8192
    v_mfma_f32_16x16x32_bf16 v[188:191], v[84:87], v[68:71], v[188:191]
    ds_read_b128 v[140:143], v51 offset:10240
    v_mfma_f32_16x16x32_bf16 v[192:195], v[88:91], v[64:67], v[192:195]
    ds_read_b128 v[144:147], v51 offset:12288
    v_mfma_f32_16x16x32_bf16 v[196:199], v[88:91], v[68:71], v[196:199]
    ds_read_b128 v[148:151], v51 offset:14336
    v_mfma_f32_16x16x32_bf16 v[200:203], v[92:95], v[64:67], v[200:203]
    ds_read_b128 v[152:155], v51 offset:16384
    v_mfma_f32_16x16x32_bf16 v[204:207], v[92:95], v[68:71], v[204:207]
    v_mfma_f32_16x16x32_bf16 v[208:211], v[96:99], v[64:67], v[208:211]
    v_mfma_f32_16x16x32_bf16 v[212:215], v[96:99], v[68:71], v[212:215]
    v_mfma_f32_16x16x32_bf16 v[216:219], v[100:103], v[64:67], v[216:219]
    v_mfma_f32_16x16x32_bf16 v[220:223], v[100:103], v[68:71], v[220:223]
    v_mfma_f32_16x16x32_bf16 v[224:227], v[104:107], v[64:67], v[224:227]
    v_mfma_f32_16x16x32_bf16 v[228:231], v[104:107], v[68:71], v[228:231]
    s_waitcnt lgkmcnt(0)
    s_barrier
    v_mfma_f32_16x16x32_bf16 v[160:163], v[120:123], v[112:115], v[160:163]
    ds_read_b128 v[64:67], v44 offset:0
    v_mfma_f32_16x16x32_bf16 v[164:167], v[120:123], v[116:119], v[164:167]
    ds_read_b128 v[68:71], v44 offset:2048
    v_mfma_f32_16x16x32_bf16 v[168:171], v[124:127], v[112:115], v[168:171]
    ds_read_b128 v[72:75], v52 offset:0
    v_mfma_f32_16x16x32_bf16 v[172:175], v[124:127], v[116:119], v[172:175]
    ds_read_b128 v[76:79], v52 offset:2048
    v_mfma_f32_16x16x32_bf16 v[176:179], v[128:131], v[112:115], v[176:179]
    ds_read_b128 v[80:83], v52 offset:4096
    v_mfma_f32_16x16x32_bf16 v[180:183], v[128:131], v[116:119], v[180:183]
    ds_read_b128 v[84:87], v52 offset:6144
    v_mfma_f32_16x16x32_bf16 v[184:187], v[132:135], v[112:115], v[184:187]
    ds_read_b128 v[88:91], v52 offset:8192
    v_mfma_f32_16x16x32_bf16 v[188:191], v[132:135], v[116:119], v[188:191]
    ds_read_b128 v[92:95], v52 offset:10240
    v_mfma_f32_16x16x32_bf16 v[192:195], v[136:139], v[112:115], v[192:195]
    ds_read_b128 v[96:99], v52 offset:12288
    v_mfma_f32_16x16x32_bf16 v[196:199], v[136:139], v[116:119], v[196:199]
    ds_read_b128 v[100:103], v52 offset:14336
    v_mfma_f32_16x16x32_bf16 v[200:203], v[140:143], v[112:115], v[200:203]
    ds_read_b128 v[104:107], v52 offset:16384
    v_mfma_f32_16x16x32_bf16 v[204:207], v[140:143], v[116:119], v[204:207]
    v_mfma_f32_16x16x32_bf16 v[208:211], v[144:147], v[112:115], v[208:211]
    v_mfma_f32_16x16x32_bf16 v[212:215], v[144:147], v[116:119], v[212:215]
    v_mfma_f32_16x16x32_bf16 v[216:219], v[148:151], v[112:115], v[216:219]
    v_mfma_f32_16x16x32_bf16 v[220:223], v[148:151], v[116:119], v[220:223]
    v_mfma_f32_16x16x32_bf16 v[224:227], v[152:155], v[112:115], v[224:227]
    v_mfma_f32_16x16x32_bf16 v[228:231], v[152:155], v[116:119], v[228:231]
    s_waitcnt lgkmcnt(0)
    v_mfma_f32_16x16x32_bf16 v[160:163], v[72:75], v[64:67], v[160:163]
    ds_read_b128 v[112:115], v45 offset:0
    v_mfma_f32_16x16x32_bf16 v[164:167], v[72:75], v[68:71], v[164:167]
    ds_read_b128 v[116:119], v45 offset:2048
    v_mfma_f32_16x16x32_bf16 v[168:171], v[76:79], v[64:67], v[168:171]
    ds_read_b128 v[120:123], v53 offset:0
    v_mfma_f32_16x16x32_bf16 v[172:175], v[76:79], v[68:71], v[172:175]
    ds_read_b128 v[124:127], v53 offset:2048
    v_mfma_f32_16x16x32_bf16 v[176:179], v[80:83], v[64:67], v[176:179]
    ds_read_b128 v[128:131], v53 offset:4096
    v_mfma_f32_16x16x32_bf16 v[180:183], v[80:83], v[68:71], v[180:183]
    ds_read_b128 v[132:135], v53 offset:6144
    v_mfma_f32_16x16x32_bf16 v[184:187], v[84:87], v[64:67], v[184:187]
    ds_read_b128 v[136:139], v53 offset:8192
    v_mfma_f32_16x16x32_bf16 v[188:191], v[84:87], v[68:71], v[188:191]
    ds_read_b128 v[140:143], v53 offset:10240
    v_mfma_f32_16x16x32_bf16 v[192:195], v[88:91], v[64:67], v[192:195]
    ds_read_b128 v[144:147], v53 offset:12288
    v_mfma_f32_16x16x32_bf16 v[196:199], v[88:91], v[68:71], v[196:199]
    ds_read_b128 v[148:151], v53 offset:14336
    v_mfma_f32_16x16x32_bf16 v[200:203], v[92:95], v[64:67], v[200:203]
    ds_read_b128 v[152:155], v53 offset:16384
    v_mfma_f32_16x16x32_bf16 v[204:207], v[92:95], v[68:71], v[204:207]
    v_mfma_f32_16x16x32_bf16 v[208:211], v[96:99], v[64:67], v[208:211]
    v_mfma_f32_16x16x32_bf16 v[212:215], v[96:99], v[68:71], v[212:215]
    v_mfma_f32_16x16x32_bf16 v[216:219], v[100:103], v[64:67], v[216:219]
    v_mfma_f32_16x16x32_bf16 v[220:223], v[100:103], v[68:71], v[220:223]
    v_mfma_f32_16x16x32_bf16 v[224:227], v[104:107], v[64:67], v[224:227]
    v_mfma_f32_16x16x32_bf16 v[228:231], v[104:107], v[68:71], v[228:231]
    s_waitcnt lgkmcnt(0)
    s_barrier
    v_mfma_f32_16x16x32_bf16 v[160:163], v[120:123], v[112:115], v[160:163]
    ds_read_b128 v[64:67], v46 offset:0
    v_mfma_f32_16x16x32_bf16 v[164:167], v[120:123], v[116:119], v[164:167]
    ds_read_b128 v[68:71], v46 offset:2048
    v_mfma_f32_16x16x32_bf16 v[168:171], v[124:127], v[112:115], v[168:171]
    ds_read_b128 v[72:75], v54 offset:0
    v_mfma_f32_16x16x32_bf16 v[172:175], v[124:127], v[116:119], v[172:175]
    ds_read_b128 v[76:79], v54 offset:2048
    v_mfma_f32_16x16x32_bf16 v[176:179], v[128:131], v[112:115], v[176:179]
    ds_read_b128 v[80:83], v54 offset:4096
    v_mfma_f32_16x16x32_bf16 v[180:183], v[128:131], v[116:119], v[180:183]
    ds_read_b128 v[84:87], v54 offset:6144
    v_mfma_f32_16x16x32_bf16 v[184:187], v[132:135], v[112:115], v[184:187]
    ds_read_b128 v[88:91], v54 offset:8192
    v_mfma_f32_16x16x32_bf16 v[188:191], v[132:135], v[116:119], v[188:191]
    ds_read_b128 v[92:95], v54 offset:10240
    v_mfma_f32_16x16x32_bf16 v[192:195], v[136:139], v[112:115], v[192:195]
    ds_read_b128 v[96:99], v54 offset:12288
    v_mfma_f32_16x16x32_bf16 v[196:199], v[136:139], v[116:119], v[196:199]
    ds_read_b128 v[100:103], v54 offset:14336
    v_mfma_f32_16x16x32_bf16 v[200:203], v[140:143], v[112:115], v[200:203]
    ds_read_b128 v[104:107], v54 offset:16384
    v_mfma_f32_16x16x32_bf16 v[204:207], v[140:143], v[116:119], v[204:207]
    v_mfma_f32_16x16x32_bf16 v[208:211], v[144:147], v[112:115], v[208:211]
    v_mfma_f32_16x16x32_bf16 v[212:215], v[144:147], v[116:119], v[212:215]
    v_mfma_f32_16x16x32_bf16 v[216:219], v[148:151], v[112:115], v[216:219]
    v_mfma_f32_16x16x32_bf16 v[220:223], v[148:151], v[116:119], v[220:223]
    v_mfma_f32_16x16x32_bf16 v[224:227], v[152:155], v[112:115], v[224:227]
    v_mfma_f32_16x16x32_bf16 v[228:231], v[152:155], v[116:119], v[228:231]
    s_waitcnt lgkmcnt(0)
    v_mfma_f32_16x16x32_bf16 v[160:163], v[72:75], v[64:67], v[160:163]
    ds_read_b128 v[112:115], v47 offset:0
    v_mfma_f32_16x16x32_bf16 v[164:167], v[72:75], v[68:71], v[164:167]
    ds_read_b128 v[116:119], v47 offset:2048
    v_mfma_f32_16x16x32_bf16 v[168:171], v[76:79], v[64:67], v[168:171]
    ds_read_b128 v[120:123], v55 offset:0
    v_mfma_f32_16x16x32_bf16 v[172:175], v[76:79], v[68:71], v[172:175]
    ds_read_b128 v[124:127], v55 offset:2048
    v_mfma_f32_16x16x32_bf16 v[176:179], v[80:83], v[64:67], v[176:179]
    ds_read_b128 v[128:131], v55 offset:4096
    v_mfma_f32_16x16x32_bf16 v[180:183], v[80:83], v[68:71], v[180:183]
    ds_read_b128 v[132:135], v55 offset:6144
    v_mfma_f32_16x16x32_bf16 v[184:187], v[84:87], v[64:67], v[184:187]
    ds_read_b128 v[136:139], v55 offset:8192
    v_mfma_f32_16x16x32_bf16 v[188:191], v[84:87], v[68:71], v[188:191]
    ds_read_b128 v[140:143], v55 offset:10240
    v_mfma_f32_16x16x32_bf16 v[192:195], v[88:91], v[64:67], v[192:195]
    ds_read_b128 v[144:147], v55 offset:12288
    v_mfma_f32_16x16x32_bf16 v[196:199], v[88:91], v[68:71], v[196:199]
    ds_read_b128 v[148:151], v55 offset:14336
    v_mfma_f32_16x16x32_bf16 v[200:203], v[92:95], v[64:67], v[200:203]
    ds_read_b128 v[152:155], v55 offset:16384
    v_mfma_f32_16x16x32_bf16 v[204:207], v[92:95], v[68:71], v[204:207]
    v_mfma_f32_16x16x32_bf16 v[208:211], v[96:99], v[64:67], v[208:211]
    v_mfma_f32_16x16x32_bf16 v[212:215], v[96:99], v[68:71], v[212:215]
    v_mfma_f32_16x16x32_bf16 v[216:219], v[100:103], v[64:67], v[216:219]
    v_mfma_f32_16x16x32_bf16 v[220:223], v[100:103], v[68:71], v[220:223]
    v_mfma_f32_16x16x32_bf16 v[224:227], v[104:107], v[64:67], v[224:227]
    v_mfma_f32_16x16x32_bf16 v[228:231], v[104:107], v[68:71], v[228:231]
    s_waitcnt lgkmcnt(0)
    v_mfma_f32_16x16x32_bf16 v[160:163], v[120:123], v[112:115], v[160:163]
    v_mfma_f32_16x16x32_bf16 v[164:167], v[120:123], v[116:119], v[164:167]
    v_mfma_f32_16x16x32_bf16 v[168:171], v[124:127], v[112:115], v[168:171]
    v_mfma_f32_16x16x32_bf16 v[172:175], v[124:127], v[116:119], v[172:175]
    v_mfma_f32_16x16x32_bf16 v[176:179], v[128:131], v[112:115], v[176:179]
    v_mfma_f32_16x16x32_bf16 v[180:183], v[128:131], v[116:119], v[180:183]
    v_mfma_f32_16x16x32_bf16 v[184:187], v[132:135], v[112:115], v[184:187]
    v_mfma_f32_16x16x32_bf16 v[188:191], v[132:135], v[116:119], v[188:191]
    v_mfma_f32_16x16x32_bf16 v[192:195], v[136:139], v[112:115], v[192:195]
    v_mfma_f32_16x16x32_bf16 v[196:199], v[136:139], v[116:119], v[196:199]
    v_mfma_f32_16x16x32_bf16 v[200:203], v[140:143], v[112:115], v[200:203]
    v_mfma_f32_16x16x32_bf16 v[204:207], v[140:143], v[116:119], v[204:207]
    v_mfma_f32_16x16x32_bf16 v[208:211], v[144:147], v[112:115], v[208:211]
    v_mfma_f32_16x16x32_bf16 v[212:215], v[144:147], v[116:119], v[212:215]
    v_mfma_f32_16x16x32_bf16 v[216:219], v[148:151], v[112:115], v[216:219]
    v_mfma_f32_16x16x32_bf16 v[220:223], v[148:151], v[116:119], v[220:223]
    v_mfma_f32_16x16x32_bf16 v[224:227], v[152:155], v[112:115], v[224:227]
    v_mfma_f32_16x16x32_bf16 v[228:231], v[152:155], v[116:119], v[228:231]
    s_mov_b32 s20, s58
    s_mov_b32 s21, s59
    s_mov_b32 s22, 0x240000
    s_mov_b32 s23, 0x00020000
    s_add_u32 s40, s6, 0x2f00000
    s_addc_u32 s41, s7, 0
    s_mov_b32 s42, 0x2000
    s_mov_b32 s43, 0x00020000
    s_lshl_b32 s44, s26, 2
    s_add_u32 s44, s44, s27
    v_lshlrev_b32 v7, 4, v2
    v_lshlrev_b32 v14, 3, v2
    s_lshl_b32 s45, s44, 7
    v_mov_b32 v11, s45
    v_mov_b32 v12, 1
    s_mov_b32 s30, 0xffff0000
    s_mov_b32 s31, 0xbfb8aa3b
    s_lshl_b32 s46, s44, 4
    s_add_u32 s46, s46, s34
    s_mul_i32 s46, s46, 18432
    s_mul_i32 s45, s25, 73728
    s_add_u32 s48, s46, s45
    s_lshl_b32 s49, s25, 2
    s_add_u32 s47, s48, 0x0
    v_cvt_pk_bf16_f32 v160, v160, v161
    v_cvt_pk_bf16_f32 v161, v162, v163
    buffer_store_dwordx2 v[160:161], v14, s[16:19], s47 offen offset:0 sc1
    s_add_u32 s47, s48, 0x0
    v_cvt_pk_bf16_f32 v164, v164, v165
    v_cvt_pk_bf16_f32 v165, v166, v167
    buffer_store_dwordx2 v[164:165], v14, s[16:19], s47 offen offset:1024 sc1
    s_add_u32 s47, s48, 0x0
    v_cvt_pk_bf16_f32 v168, v168, v169
    v_cvt_pk_bf16_f32 v169, v170, v171
    buffer_store_dwordx2 v[168:169], v14, s[16:19], s47 offen offset:2048 sc1
    s_add_u32 s47, s48, 0x0
    v_cvt_pk_bf16_f32 v172, v172, v173
    v_cvt_pk_bf16_f32 v173, v174, v175
    buffer_store_dwordx2 v[172:173], v14, s[16:19], s47 offen offset:3072 sc1
    s_add_u32 s47, s48, 0x1000
    v_cvt_pk_bf16_f32 v176, v176, v177
    v_cvt_pk_bf16_f32 v177, v178, v179
    buffer_store_dwordx2 v[176:177], v14, s[16:19], s47 offen offset:0 sc1
    s_add_u32 s47, s48, 0x1000
    v_cvt_pk_bf16_f32 v180, v180, v181
    v_cvt_pk_bf16_f32 v181, v182, v183
    buffer_store_dwordx2 v[180:181], v14, s[16:19], s47 offen offset:1024 sc1
    s_add_u32 s47, s48, 0x1000
    v_cvt_pk_bf16_f32 v184, v184, v185
    v_cvt_pk_bf16_f32 v185, v186, v187
    buffer_store_dwordx2 v[184:185], v14, s[16:19], s47 offen offset:2048 sc1
    s_add_u32 s47, s48, 0x1000
    v_cvt_pk_bf16_f32 v188, v188, v189
    v_cvt_pk_bf16_f32 v189, v190, v191
    buffer_store_dwordx2 v[188:189], v14, s[16:19], s47 offen offset:3072 sc1
    s_add_u32 s47, s48, 0x2000
    v_cvt_pk_bf16_f32 v192, v192, v193
    v_cvt_pk_bf16_f32 v193, v194, v195
    buffer_store_dwordx2 v[192:193], v14, s[16:19], s47 offen offset:0 sc1
    s_add_u32 s47, s48, 0x2000
    v_cvt_pk_bf16_f32 v196, v196, v197
    v_cvt_pk_bf16_f32 v197, v198, v199
    buffer_store_dwordx2 v[196:197], v14, s[16:19], s47 offen offset:1024 sc1
    s_add_u32 s47, s48, 0x2000
    v_cvt_pk_bf16_f32 v200, v200, v201
    v_cvt_pk_bf16_f32 v201, v202, v203
    buffer_store_dwordx2 v[200:201], v14, s[16:19], s47 offen offset:2048 sc1
    s_add_u32 s47, s48, 0x2000
    v_cvt_pk_bf16_f32 v204, v204, v205
    v_cvt_pk_bf16_f32 v205, v206, v207
    buffer_store_dwordx2 v[204:205], v14, s[16:19], s47 offen offset:3072 sc1
    s_add_u32 s47, s48, 0x3000
    v_cvt_pk_bf16_f32 v208, v208, v209
    v_cvt_pk_bf16_f32 v209, v210, v211
    buffer_store_dwordx2 v[208:209], v14, s[16:19], s47 offen offset:0 sc1
    s_add_u32 s47, s48, 0x3000
    v_cvt_pk_bf16_f32 v212, v212, v213
    v_cvt_pk_bf16_f32 v213, v214, v215
    buffer_store_dwordx2 v[212:213], v14, s[16:19], s47 offen offset:1024 sc1
    s_add_u32 s47, s48, 0x3000
    v_cvt_pk_bf16_f32 v216, v216, v217
    v_cvt_pk_bf16_f32 v217, v218, v219
    buffer_store_dwordx2 v[216:217], v14, s[16:19], s47 offen offset:2048 sc1
    s_add_u32 s47, s48, 0x3000
    v_cvt_pk_bf16_f32 v220, v220, v221
    v_cvt_pk_bf16_f32 v221, v222, v223
    buffer_store_dwordx2 v[220:221], v14, s[16:19], s47 offen offset:3072 sc1
    s_add_u32 s47, s48, 0x4000
    v_cvt_pk_bf16_f32 v224, v224, v225
    v_cvt_pk_bf16_f32 v225, v226, v227
    buffer_store_dwordx2 v[224:225], v14, s[16:19], s47 offen offset:0 sc1
    s_add_u32 s47, s48, 0x4000
    v_cvt_pk_bf16_f32 v228, v228, v229
    v_cvt_pk_bf16_f32 v229, v230, v231
    buffer_store_dwordx2 v[228:229], v14, s[16:19], s47 offen offset:1024 sc1
    s_waitcnt vmcnt(0)
    s_barrier
    s_cmp_lg_u32 s34, 0
    s_cbranch_scc1 KB_DONE2
    s_mov_b64 exec, 1
    buffer_store_dword v12, v11, s[40:43], s49 offen sc1
    s_mov_b64 exec, -1
KB_DONE2:
    s_endpgm
KB_G4:
    s_add_u32 s8, s6, 0x1000000
    s_addc_u32 s9, s7, 0
    s_mov_b32 s10, 0x1200000
    s_mov_b32 s11, 0x00020000
    s_add_u32 s12, s6, 0x2800000
    s_addc_u32 s13, s7, 0
    s_mov_b32 s14, 0x510000
    s_mov_b32 s15, 0x00020000
    s_sub_u32 s38, s25, 2
    s_mul_i32 s40, s38, 4608
    s_mul_i32 s41, s38, 2654208
    s_lshl_b32 s42, s34, 5
    s_add_u32 s42, s42, 0
    v_add_u32 v10, s42, v7
    v_lshrrev_b32 v11, 1, v10
    v_and_b32 v11, 7, v11
    v_xor_b32 v11, v11, v8
    v_add_u32 v10, s35, v10
    v_mul_u32_u24 v10, 9216, v10
    v_lshl_add_u32 v20, v11, 4, v10
    s_lshl_b32 s42, s34, 5
    s_add_u32 s42, s42, 8
    v_add_u32 v10, s42, v7
    v_lshrrev_b32 v11, 1, v10
    v_and_b32 v11, 7, v11
    v_xor_b32 v11, v11, v8
    v_add_u32 v10, s35, v10
    v_mul_u32_u24 v10, 9216, v10
    v_lshl_add_u32 v21, v11, 4, v10
    s_lshl_b32 s42, s34, 5
    s_add_u32 s42, s42, 16
    v_add_u32 v10, s42, v7
    v_lshrrev_b32 v11, 1, v10
    v_and_b32 v11, 7, v11
    v_xor_b32 v11, v11, v8
    v_add_u32 v10, s35, v10
    v_mul_u32_u24 v10, 9216, v10
    v_lshl_add_u32 v22, v11, 4, v10
    s_lshl_b32 s42, s34, 5
    s_add_u32 s42, s42, 24
    v_add_u32 v10, s42, v7
    v_lshrrev_b32 v11, 1, v10
    v_and_b32 v11, 7, v11
    v_xor_b32 v11, v11, v8
    v_add_u32 v10, s35, v10
    v_mul_u32_u24 v10, 9216, v10
    v_lshl_add_u32 v23, v11, 4, v10
    s_mul_i32 s43, s34, 4608
    s_add_u32 s43, s43, 16384
    s_lshl_b32 s44, s34, 12
    s_mul_i32 s42, s34, 288
    v_add_u32 v10, s42, v2
    s_mul_i32 s45, s27, 663552
    v_lshlrev_b32 v13, 4, v10
    v_add_u32 v24, s45, v13
    v_add_u32 v10, s42, v2
    v_add_u32 v10, 64, v10
    s_mul_i32 s45, s27, 663552
    v_lshlrev_b32 v13, 4, v10
    v_add_u32 v25, s45, v13
    v_add_u32 v10, s42, v2
    v_add_u32 v10, 128, v10
    s_mul_i32 s45, s27, 663552
    v_lshlrev_b32 v13, 4, v10
    v_add_u32 v26, s45, v13
    v_add_u32 v10, s42, v2
    v_add_u32 v10, 192, v10
    s_mul_i32 s45, s27, 663552
    v_lshlrev_b32 v13, 4, v10
    v_add_u32 v27, s45, v13
    v_add_u32 v10, s42, v2
    v_add_u32 v10, 256, v10
    s_mul_i32 s45, s27, 663552
    v_lshlrev_b32 v13, 4, v10
    v_add_u32 v28, s45, v13
    v_bfe_u32 v10, v2, 2, 2
    v_bfe_u32 v11, v2, 4, 1
    v_lshl_add_u32 v10, v11, 2, v10
    v_bfe_u32 v11, v2, 5, 1
    v_lshl_add_u32 v10, v11, 4, v10
    v_mul_u32_u24 v10, 288, v10
    v_and_b32 v11, 3, v2
    v_lshl_add_u32 v10, v11, 3, v10
    v_add_u32 v48, 0x4000, v10
    v_add_u32 v50, 0xc800, v10
    v_add_u32 v52, 0x15000, v10
    v_add_u32 v54, 0x1d800, v10
    s_cmp_lt_u32 s50, 4
    s_cbranch_scc1 KB_CONS4
    s_setprio 2
    s_add_u32 m0, s44, 0x0
    s_nop 0
    buffer_load_dwordx4 v20, s[8:11], s40 offen lds
    s_add_u32 m0, s44, 0x400
    s_nop 0
    buffer_load_dwordx4 v21, s[8:11], s40 offen lds
    s_add_u32 m0, s44, 0x800
    s_nop 0
    buffer_load_dwordx4 v22, s[8:11], s40 offen lds
    s_add_u32 m0, s44, 0xc00
    s_nop 0
    buffer_load_dwordx4 v23, s[8:11], s40 offen lds
    s_add_u32 m0, s43, 0x0
    s_nop 0
    buffer_load_dwordx4 v24, s[12:15], s41 offen lds
    s_add_u32 m0, s43, 0x400
    s_nop 0
    buffer_load_dwordx4 v25, s[12:15], s41 offen lds
    s_add_u32 m0, s43, 0x800
    s_nop 0
    buffer_load_dwordx4 v26, s[12:15], s41 offen lds
    s_add_u32 m0, s43, 0xc00
    s_nop 0
    buffer_load_dwordx4 v27, s[12:15], s41 offen lds
    s_add_u32 m0, s43, 0x1000
    s_nop 0
    s_mov_b64 exec, 0xffffffff
    buffer_load_dwordx4 v28, s[12:15], s41 offen lds
    s_mov_b64 exec, -1
    s_add_u32 s40, s40, 128
    s_add_u32 s41, s41, 0x4800
    s_add_u32 m0, s44, 0x8800
    s_nop 0
    buffer_load_dwordx4 v20, s[8:11], s40 offen lds
    s_add_u32 m0, s44, 0x8c00
    s_nop 0
    buffer_load_dwordx4 v21, s[8:11], s40 offen lds
    s_add_u32 m0, s44, 0x9000
    s_nop 0
    buffer_load_dwordx4 v22, s[8:11], s40 offen lds
    s_add_u32 m0, s44, 0x9400
    s_nop 0
    buffer_load_dwordx4 v23, s[8:11], s40 offen lds
    s_add_u32 m0, s43, 0x8800
    s_nop 0
    buffer_load_dwordx4 v24, s[12:15], s41 offen lds
    s_add_u32 m0, s43, 0x8c00
    s_nop 0
    buffer_load_dwordx4 v25, s[12:15], s41 offen lds
    s_add_u32 m0, s43, 0x9000
    s_nop 0
    buffer_load_dwordx4 v26, s[12:15], s41 offen lds
    s_add_u32 m0, s43, 0x9400
    s_nop 0
    buffer_load_dwordx4 v27, s[12:15], s41 offen lds
    s_add_u32 m0, s43, 0x9800
    s_nop 0
    s_mov_b64 exec, 0xffffffff
    buffer_load_dwordx4 v28, s[12:15], s41 offen lds
    s_mov_b64 exec, -1
    s_add_u32 s40, s40, 128
    s_add_u32 s41, s41, 0x4800
    s_add_u32 m0, s44, 0x11000
    s_nop 0
    buffer_load_dwordx4 v20, s[8:11], s40 offen lds
    s_add_u32 m0, s44, 0x11400
    s_nop 0
    buffer_load_dwordx4 v21, s[8:11], s40 offen lds
    s_add_u32 m0, s44, 0x11800
    s_nop 0
    buffer_load_dwordx4 v22, s[8:11], s40 offen lds
    s_add_u32 m0, s44, 0x11c00
    s_nop 0
    buffer_load_dwordx4 v23, s[8:11], s40 offen lds
    s_add_u32 m0, s43, 0x11000
    s_nop 0
    buffer_load_dwordx4 v24, s[12:15], s41 offen lds
    s_add_u32 m0, s43, 0x11400
    s_nop 0
    buffer_load_dwordx4 v25, s[12:15], s41 offen lds
    s_add_u32 m0, s43, 0x11800
    s_nop 0
    buffer_load_dwordx4 v26, s[12:15], s41 offen lds
    s_add_u32 m0, s43, 0x11c00
    s_nop 0
    buffer_load_dwordx4 v27, s[12:15], s41 offen lds
    s_add_u32 m0, s43, 0x12000
    s_nop 0
    s_mov_b64 exec, 0xffffffff
    buffer_load_dwordx4 v28, s[12:15], s41 offen lds
    s_mov_b64 exec, -1
    s_add_u32 s40, s40, 128
    s_add_u32 s41, s41, 0x4800
    s_add_u32 m0, s44, 0x19800
    s_nop 0
    buffer_load_dwordx4 v20, s[8:11], s40 offen lds
    s_add_u32 m0, s44, 0x19c00
    s_nop 0
    buffer_load_dwordx4 v21, s[8:11], s40 offen lds
    s_add_u32 m0, s44, 0x1a000
    s_nop 0
    buffer_load_dwordx4 v22, s[8:11], s40 offen lds
    s_add_u32 m0, s44, 0x1a400
    s_nop 0
    buffer_load_dwordx4 v23, s[8:11], s40 offen lds
    s_add_u32 m0, s43, 0x19800
    s_nop 0
    buffer_load_dwordx4 v24, s[12:15], s41 offen lds
    s_add_u32 m0, s43, 0x19c00
    s_nop 0
    buffer_load_dwordx4 v25, s[12:15], s41 offen lds
    s_add_u32 m0, s43, 0x1a000
    s_nop 0
    buffer_load_dwordx4 v26, s[12:15], s41 offen lds
    s_add_u32 m0, s43, 0x1a400
    s_nop 0
    buffer_load_dwordx4 v27, s[12:15], s41 offen lds
    s_add_u32 m0, s43, 0x1a800
    s_nop 0
    s_mov_b64 exec, 0xffffffff
    buffer_load_dwordx4 v28, s[12:15], s41 offen lds
    s_mov_b64 exec, -1
    s_add_u32 s40, s40, 128
    s_add_u32 s41, s41, 0x4800
    s_waitcnt vmcnt(27)
    s_barrier
    s_mov_b32 s47, 8
KB_PLOOP4:
    s_waitcnt vmcnt(18)
    s_barrier
    s_add_u32 m0, s44, 0x0
    s_nop 0
    buffer_load_dwordx4 v20, s[8:11], s40 offen lds
    s_add_u32 m0, s44, 0x400
    s_nop 0
    buffer_load_dwordx4 v21, s[8:11], s40 offen lds
    s_add_u32 m0, s44, 0x800
    s_nop 0
    buffer_load_dwordx4 v22, s[8:11], s40 offen lds
    s_add_u32 m0, s44, 0xc00
    s_nop 0
    buffer_load_dwordx4 v23, s[8:11], s40 offen lds
    s_add_u32 m0, s43, 0x0
    s_nop 0
    buffer_load_dwordx4 v24, s[12:15], s41 offen lds
    s_add_u32 m0, s43, 0x400
    s_nop 0
    buffer_load_dwordx4 v25, s[12:15], s41 offen lds
    s_add_u32 m0, s43, 0x800
    s_nop 0
    buffer_load_dwordx4 v26, s[12:15], s41 offen lds
    s_add_u32 m0, s43, 0xc00
    s_nop 0
    buffer_load_dwordx4 v27, s[12:15], s41 offen lds
    s_add_u32 m0, s43, 0x1000
    s_nop 0
    s_mov_b64 exec, 0xffffffff
    buffer_load_dwordx4 v28, s[12:15], s41 offen lds
    s_mov_b64 exec, -1
    s_add_u32 s40, s40, 128
    s_add_u32 s41, s41, 0x4800
    s_waitcnt vmcnt(18)
    s_barrier
    s_add_u32 m0, s44, 0x8800
    s_nop 0
    buffer_load_dwordx4 v20, s[8:11], s40 offen lds
    s_add_u32 m0, s44, 0x8c00
    s_nop 0
    buffer_load_dwordx4 v21, s[8:11], s40 offen lds
    s_add_u32 m0, s44, 0x9000
    s_nop 0
    buffer_load_dwordx4 v22, s[8:11], s40 offen lds
    s_add_u32 m0, s44, 0x9400
    s_nop 0
    buffer_load_dwordx4 v23, s[8:11], s40 offen lds
    s_add_u32 m0, s43, 0x8800
    s_nop 0
    buffer_load_dwordx4 v24, s[12:15], s41 offen lds
    s_add_u32 m0, s43, 0x8c00
    s_nop 0
    buffer_load_dwordx4 v25, s[12:15], s41 offen lds
    s_add_u32 m0, s43, 0x9000
    s_nop 0
    buffer_load_dwordx4 v26, s[12:15], s41 offen lds
    s_add_u32 m0, s43, 0x9400
    s_nop 0
    buffer_load_dwordx4 v27, s[12:15], s41 offen lds
    s_add_u32 m0, s43, 0x9800
    s_nop 0
    s_mov_b64 exec, 0xffffffff
    buffer_load_dwordx4 v28, s[12:15], s41 offen lds
    s_mov_b64 exec, -1
    s_add_u32 s40, s40, 128
    s_add_u32 s41, s41, 0x4800
    s_waitcnt vmcnt(18)
    s_barrier
    s_add_u32 m0, s44, 0x11000
    s_nop 0
    buffer_load_dwordx4 v20, s[8:11], s40 offen lds
    s_add_u32 m0, s44, 0x11400
    s_nop 0
    buffer_load_dwordx4 v21, s[8:11], s40 offen lds
    s_add_u32 m0, s44, 0x11800
    s_nop 0
    buffer_load_dwordx4 v22, s[8:11], s40 offen lds
    s_add_u32 m0, s44, 0x11c00
    s_nop 0
    buffer_load_dwordx4 v23, s[8:11], s40 offen lds
    s_add_u32 m0, s43, 0x11000
    s_nop 0
    buffer_load_dwordx4 v24, s[12:15], s41 offen lds
    s_add_u32 m0, s43, 0x11400
    s_nop 0
    buffer_load_dwordx4 v25, s[12:15], s41 offen lds
    s_add_u32 m0, s43, 0x11800
    s_nop 0
    buffer_load_dwordx4 v26, s[12:15], s41 offen lds
    s_add_u32 m0, s43, 0x11c00
    s_nop 0
    buffer_load_dwordx4 v27, s[12:15], s41 offen lds
    s_add_u32 m0, s43, 0x12000
    s_nop 0
    s_mov_b64 exec, 0xffffffff
    buffer_load_dwordx4 v28, s[12:15], s41 offen lds
    s_mov_b64 exec, -1
    s_add_u32 s40, s40, 128
    s_add_u32 s41, s41, 0x4800
    s_waitcnt vmcnt(18)
    s_barrier
    s_add_u32 m0, s44, 0x19800
    s_nop 0
    buffer_load_dwordx4 v20, s[8:11], s40 offen lds
    s_add_u32 m0, s44, 0x19c00
    s_nop 0
    buffer_load_dwordx4 v21, s[8:11], s40 offen lds
    s_add_u32 m0, s44, 0x1a000
    s_nop 0
    buffer_load_dwordx4 v22, s[8:11], s40 offen lds
    s_add_u32 m0, s44, 0x1a400
    s_nop 0
    buffer_load_dwordx4 v23, s[8:11], s40 offen lds
    s_add_u32 m0, s43, 0x19800
    s_nop 0
    buffer_load_dwordx4 v24, s[12:15], s41 offen lds
    s_add_u32 m0, s43, 0x19c00
    s_nop 0
    buffer_load_dwordx4 v25, s[12:15], s41 offen lds
    s_add_u32 m0, s43, 0x1a000
    s_nop 0
    buffer_load_dwordx4 v26, s[12:15], s41 offen lds
    s_add_u32 m0, s43, 0x1a400
    s_nop 0
    buffer_load_dwordx4 v27, s[12:15], s41 offen lds
    s_add_u32 m0, s43, 0x1a800
    s_nop 0
    s_mov_b64 exec, 0xffffffff
    buffer_load_dwordx4 v28, s[12:15], s41 offen lds
    s_mov_b64 exec, -1
    s_add_u32 s40, s40, 128
    s_add_u32 s41, s41, 0x4800
    s_sub_u32 s47, s47, 1
    s_cmp_lg_u32 s47, 0
    s_cbranch_scc1 KB_PLOOP4
    s_waitcnt vmcnt(18)
    s_barrier
    s_waitcnt vmcnt(9)
    s_barrier
    s_waitcnt vmcnt(0)
    s_barrier
    s_endpgm
KB_CONS4:
    s_mov_b32 s8, s52
    s_mov_b32 s9, s53
    s_mov_b32 s10, 0x240000
    s_mov_b32 s11, 0x00020000
    s_mov_b32 s12, s56
    s_mov_b32 s13, s57
    s_mov_b32 s14, 0x480
    s_mov_b32 s15, 0x00020000
    v_add_u32 v8, s36, v3
    v_mul_u32_u24 v8, 1152, v8
    v_lshl_add_u32 v8, v4, 3, v8
    s_mul_i32 s45, s27, 288
    s_and_b32 s46, s25, 1
    s_mul_i32 s46, s46, 18432
    s_add_u32 s46, s46, s45
    v_add_u32 v8, s46, v8
    v_lshlrev_b32 v10, 3, v4
    v_add_u32 v10, s45, v10
    buffer_load_dwordx2 v[232:233], v8, s[8:11], 0 offen offset:0
    buffer_load_dwordx2 v[250:251], v10, s[12:15], 0 offen offset:0
    buffer_load_dwordx2 v[234:235], v8, s[8:11], 0 offen offset:32
    buffer_load_dwordx2 v[252:253], v10, s[12:15], 0 offen offset:32
    buffer_load_dwordx2 v[236:237], v8, s[8:11], 0 offen offset:64
    buffer_load_dwordx2 v[254:255], v10, s[12:15], 0 offen offset:64
    buffer_load_dwordx2 v[238:239], v8, s[8:11], 0 offen offset:96
    buffer_load_dwordx2 v[56:57], v10, s[12:15], 0 offen offset:96
    buffer_load_dwordx2 v[240:241], v8, s[8:11], 0 offen offset:128
    buffer_load_dwordx2 v[58:59], v10, s[12:15], 0 offen offset:128
    buffer_load_dwordx2 v[242:243], v8, s[8:11], 0 offen offset:160
    buffer_load_dwordx2 v[60:61], v10, s[12:15], 0 offen offset:160
    buffer_load_dwordx2 v[244:245], v8, s[8:11], 0 offen offset:192
    buffer_load_dwordx2 v[62:63], v10, s[12:15], 0 offen offset:192
    buffer_load_dwordx2 v[246:247], v8, s[8:11], 0 offen offset:224
    buffer_load_dwordx2 v[30:31], v10, s[12:15], 0 offen offset:224
    buffer_load_dwordx2 v[248:249], v8, s[8:11], 0 offen offset:256
    buffer_load_dwordx2 v[32:33], v10, s[12:15], 0 offen offset:256
    v_mov_b32 v160, 0
    v_mov_b32 v161, 0
    v_mov_b32 v162, 0
    v_mov_b32 v163, 0
    v_mov_b32 v164, 0
    v_mov_b32 v165, 0
    v_mov_b32 v166, 0
    v_mov_b32 v167, 0
    v_mov_b32 v168, 0
    v_mov_b32 v169, 0
    v_mov_b32 v170, 0
    v_mov_b32 v171, 0
    v_mov_b32 v172, 0
    v_mov_b32 v173, 0
    v_mov_b32 v174, 0
    v_mov_b32 v175, 0
    v_mov_b32 v176, 0
    v_mov_b32 v177, 0
    v_mov_b32 v178, 0
    v_mov_b32 v179, 0
    v_mov_b32 v180, 0
    v_mov_b32 v181, 0
    v_mov_b32 v182, 0
    v_mov_b32 v183, 0
    v_mov_b32 v184, 0
    v_mov_b32 v185, 0
    v_mov_b32 v186, 0
    v_mov_b32 v187, 0
    v_mov_b32 v188, 0
    v_mov_b32 v189, 0
    v_mov_b32 v190, 0
    v_mov_b32 v191, 0
    v_mov_b32 v192, 0
    v_mov_b32 v193, 0
    v_mov_b32 v194, 0
    v_mov_b32 v195, 0
    v_mov_b32 v196, 0
    v_mov_b32 v197, 0
    v_mov_b32 v198, 0
    v_mov_b32 v199, 0
    v_mov_b32 v200, 0
    v_mov_b32 v201, 0
    v_mov_b32 v202, 0
    v_mov_b32 v203, 0
    v_mov_b32 v204, 0
    v_mov_b32 v205, 0
    v_mov_b32 v206, 0
    v_mov_b32 v207, 0
    v_mov_b32 v208, 0
    v_mov_b32 v209, 0
    v_mov_b32 v210, 0
    v_mov_b32 v211, 0
    v_mov_b32 v212, 0
    v_mov_b32 v213, 0
    v_mov_b32 v214, 0
    v_mov_b32 v215, 0
    v_mov_b32 v216, 0
    v_mov_b32 v217, 0
    v_mov_b32 v218, 0
    v_mov_b32 v219, 0
    v_mov_b32 v220, 0
    v_mov_b32 v221, 0
    v_mov_b32 v222, 0
    v_mov_b32 v223, 0
    v_mov_b32 v224, 0
    v_mov_b32 v225, 0
    v_mov_b32 v226, 0
    v_mov_b32 v227, 0
    v_mov_b32 v228, 0
    v_mov_b32 v229, 0
    v_mov_b32 v230, 0
    v_mov_b32 v231, 0
    s_barrier
    ds_read_b128 v[64:67], v40 offset:0
    ds_read_b128 v[68:71], v40 offset:2048
    ds_read_b64_tr_b16 v[72:73], v48 offset:0
    ds_read_b64_tr_b16 v[74:75], v48 offset:2304
    ds_read_b64_tr_b16 v[76:77], v48 offset:32
    ds_read_b64_tr_b16 v[78:79], v48 offset:2336
    ds_read_b64_tr_b16 v[80:81], v48 offset:64
    ds_read_b64_tr_b16 v[82:83], v48 offset:2368
    ds_read_b64_tr_b16 v[84:85], v48 offset:96
    ds_read_b64_tr_b16 v[86:87], v48 offset:2400
    ds_read_b64_tr_b16 v[88:89], v48 offset:128
    ds_read_b64_tr_b16 v[90:91], v48 offset:2432
    ds_read_b64_tr_b16 v[92:93], v48 offset:160
    ds_read_b64_tr_b16 v[94:95], v48 offset:2464
    ds_read_b64_tr_b16 v[96:97], v48 offset:192
    ds_read_b64_tr_b16 v[98:99], v48 offset:2496
    ds_read_b64_tr_b16 v[100:101], v48 offset:224
    ds_read_b64_tr_b16 v[102:103], v48 offset:2528
    ds_read_b64_tr_b16 v[104:105], v48 offset:256
    ds_read_b64_tr_b16 v[106:107], v48 offset:2560
    s_mov_b32 s47, 8
KB_LOOP4:
    s_waitcnt lgkmcnt(0)
    v_mfma_f32_16x16x32_bf16 v[160:163], v[72:75], v[64:67], v[160:163]
    ds_read_b128 v[112:115], v41 offset:0
    ds_read_b128 v[116:119], v41 offset:2048
    v_mfma_f32_16x16x32_bf16 v[164:167], v[72:75], v[68:71], v[164:167]
    ds_read_b64_tr_b16 v[120:121], v48 offset:9216
    ds_read_b64_tr_b16 v[122:123], v48 offset:11520
    v_mfma_f32_16x16x32_bf16 v[168:171], v[76:79], v[64:67], v[168:171]
    ds_read_b64_tr_b16 v[124:125], v48 offset:9248
    ds_read_b64_tr_b16 v[126:127], v48 offset:11552
    v_mfma_f32_16x16x32_bf16 v[172:175], v[76:79], v[68:71], v[172:175]
    ds_read_b64_tr_b16 v[128:129], v48 offset:9280
    ds_read_b64_tr_b16 v[130:131], v48 offset:11584
    v_mfma_f32_16x16x32_bf16 v[176:179], v[80:83], v[64:67], v[176:179]
    ds_read_b64_tr_b16 v[132:133], v48 offset:9312
    ds_read_b64_tr_b16 v[134:135], v48 offset:11616
    v_mfma_f32_16x16x32_bf16 v[180:183], v[80:83], v[68:71], v[180:183]
    ds_read_b64_tr_b16 v[136:137], v48 offset:9344
    ds_read_b64_tr_b16 v[138:139], v48 offset:11648
    v_mfma_f32_16x16x32_bf16 v[184:187], v[84:87], v[64:67], v[184:187]
    ds_read_b64_tr_b16 v[140:141], v48 offset:9376
    ds_read_b64_tr_b16 v[142:143], v48 offset:11680
    v_mfma_f32_16x16x32_bf16 v[188:191], v[84:87], v[68:71], v[188:191]
    ds_read_b64_tr_b16 v[144:145], v48 offset:9408
    ds_read_b64_tr_b16 v[146:147], v48 offset:11712
    v_mfma_f32_16x16x32_bf16 v[192:195], v[88:91], v[64:67], v[192:195]
    ds_read_b64_tr_b16 v[148:149], v48 offset:9440
    ds_read_b64_tr_b16 v[150:151], v48 offset:11744
    v_mfma_f32_16x16x32_bf16 v[196:199], v[88:91], v[68:71], v[196:199]
    ds_read_b64_tr_b16 v[152:153], v48 offset:9472
    ds_read_b64_tr_b16 v[154:155], v48 offset:11776
    v_mfma_f32_16x16x32_bf16 v[200:203], v[92:95], v[64:67], v[200:203]
    v_mfma_f32_16x16x32_bf16 v[204:207], v[92:95], v[68:71], v[204:207]
    v_mfma_f32_16x16x32_bf16 v[208:211], v[96:99], v[64:67], v[208:211]
    v_mfma_f32_16x16x32_bf16 v[212:215], v[96:99], v[68:71], v[212:215]
    v_mfma_f32_16x16x32_bf16 v[216:219], v[100:103], v[64:67], v[216:219]
    v_mfma_f32_16x16x32_bf16 v[220:223], v[100:103], v[68:71], v[220:223]
    v_mfma_f32_16x16x32_bf16 v[224:227], v[104:107], v[64:67], v[224:227]
    v_mfma_f32_16x16x32_bf16 v[228:231], v[104:107], v[68:71], v[228:231]
    s_waitcnt lgkmcnt(0)
    s_barrier
    v_mfma_f32_16x16x32_bf16 v[160:163], v[120:123], v[112:115], v[160:163]
    ds_read_b128 v[64:67], v42 offset:0
    ds_read_b128 v[68:71], v42 offset:2048
    v_mfma_f32_16x16x32_bf16 v[164:167], v[120:123], v[116:119], v[164:167]
    ds_read_b64_tr_b16 v[72:73], v50 offset:0
    ds_read_b64_tr_b16 v[74:75], v50 offset:2304
    v_mfma_f32_16x16x32_bf16 v[168:171], v[124:127], v[112:115], v[168:171]
    ds_read_b64_tr_b16 v[76:77], v50 offset:32
    ds_read_b64_tr_b16 v[78:79], v50 offset:2336
    v_mfma_f32_16x16x32_bf16 v[172:175], v[124:127], v[116:119], v[172:175]
    ds_read_b64_tr_b16 v[80:81], v50 offset:64
    ds_read_b64_tr_b16 v[82:83], v50 offset:2368
    v_mfma_f32_16x16x32_bf16 v[176:179], v[128:131], v[112:115], v[176:179]
    ds_read_b64_tr_b16 v[84:85], v50 offset:96
    ds_read_b64_tr_b16 v[86:87], v50 offset:2400
    v_mfma_f32_16x16x32_bf16 v[180:183], v[128:131], v[116:119], v[180:183]
    ds_read_b64_tr_b16 v[88:89], v50 offset:128
    ds_read_b64_tr_b16 v[90:91], v50 offset:2432
    v_mfma_f32_16x16x32_bf16 v[184:187], v[132:135], v[112:115], v[184:187]
    ds_read_b64_tr_b16 v[92:93], v50 offset:160
    ds_read_b64_tr_b16 v[94:95], v50 offset:2464
    v_mfma_f32_16x16x32_bf16 v[188:191], v[132:135], v[116:119], v[188:191]
    ds_read_b64_tr_b16 v[96:97], v50 offset:192
    ds_read_b64_tr_b16 v[98:99], v50 offset:2496
    v_mfma_f32_16x16x32_bf16 v[192:195], v[136:139], v[112:115], v[192:195]
    ds_read_b64_tr_b16 v[100:101], v50 offset:224
    ds_read_b64_tr_b16 v[102:103], v50 offset:2528
    v_mfma_f32_16x16x32_bf16 v[196:199], v[136:139], v[116:119], v[196:199]
    ds_read_b64_tr_b16 v[104:105], v50 offset:256
    ds_read_b64_tr_b16 v[106:107], v50 offset:2560
    v_mfma_f32_16x16x32_bf16 v[200:203], v[140:143], v[112:115], v[200:203]
    v_mfma_f32_16x16x32_bf16 v[204:207], v[140:143], v[116:119], v[204:207]
    v_mfma_f32_16x16x32_bf16 v[208:211], v[144:147], v[112:115], v[208:211]
    v_mfma_f32_16x16x32_bf16 v[212:215], v[144:147], v[116:119], v[212:215]
    v_mfma_f32_16x16x32_bf16 v[216:219], v[148:151], v[112:115], v[216:219]
    v_mfma_f32_16x16x32_bf16 v[220:223], v[148:151], v[116:119], v[220:223]
    v_mfma_f32_16x16x32_bf16 v[224:227], v[152:155], v[112:115], v[224:227]
    v_mfma_f32_16x16x32_bf16 v[228:231], v[152:155], v[116:119], v[228:231]
    s_waitcnt lgkmcnt(0)
    v_mfma_f32_16x16x32_bf16 v[160:163], v[72:75], v[64:67], v[160:163]
    ds_read_b128 v[112:115], v43 offset:0
    ds_read_b128 v[116:119], v43 offset:2048
    v_mfma_f32_16x16x32_bf16 v[164:167], v[72:75], v[68:71], v[164:167]
    ds_read_b64_tr_b16 v[120:121], v50 offset:9216
    ds_read_b64_tr_b16 v[122:123], v50 offset:11520
    v_mfma_f32_16x16x32_bf16 v[168:171], v[76:79], v[64:67], v[168:171]
    ds_read_b64_tr_b16 v[124:125], v50 offset:9248
    ds_read_b64_tr_b16 v[126:127], v50 offset:11552
    v_mfma_f32_16x16x32_bf16 v[172:175], v[76:79], v[68:71], v[172:175]
    ds_read_b64_tr_b16 v[128:129], v50 offset:9280
    ds_read_b64_tr_b16 v[130:131], v50 offset:11584
    v_mfma_f32_16x16x32_bf16 v[176:179], v[80:83], v[64:67], v[176:179]
    ds_read_b64_tr_b16 v[132:133], v50 offset:9312
    ds_read_b64_tr_b16 v[134:135], v50 offset:11616
    v_mfma_f32_16x16x32_bf16 v[180:183], v[80:83], v[68:71], v[180:183]
    ds_read_b64_tr_b16 v[136:137], v50 offset:9344
    ds_read_b64_tr_b16 v[138:139], v50 offset:11648
    v_mfma_f32_16x16x32_bf16 v[184:187], v[84:87], v[64:67], v[184:187]
    ds_read_b64_tr_b16 v[140:141], v50 offset:9376
    ds_read_b64_tr_b16 v[142:143], v50 offset:11680
    v_mfma_f32_16x16x32_bf16 v[188:191], v[84:87], v[68:71], v[188:191]
    ds_read_b64_tr_b16 v[144:145], v50 offset:9408
    ds_read_b64_tr_b16 v[146:147], v50 offset:11712
    v_mfma_f32_16x16x32_bf16 v[192:195], v[88:91], v[64:67], v[192:195]
    ds_read_b64_tr_b16 v[148:149], v50 offset:9440
    ds_read_b64_tr_b16 v[150:151], v50 offset:11744
    v_mfma_f32_16x16x32_bf16 v[196:199], v[88:91], v[68:71], v[196:199]
    ds_read_b64_tr_b16 v[152:153], v50 offset:9472
    ds_read_b64_tr_b16 v[154:155], v50 offset:11776
    v_mfma_f32_16x16x32_bf16 v[200:203], v[92:95], v[64:67], v[200:203]
    v_mfma_f32_16x16x32_bf16 v[204:207], v[92:95], v[68:71], v[204:207]
    v_mfma_f32_16x16x32_bf16 v[208:211], v[96:99], v[64:67], v[208:211]
    v_mfma_f32_16x16x32_bf16 v[212:215], v[96:99], v[68:71], v[212:215]
    v_mfma_f32_16x16x32_bf16 v[216:219], v[100:103], v[64:67], v[216:219]
    v_mfma_f32_16x16x32_bf16 v[220:223], v[100:103], v[68:71], v[220:223]
    v_mfma_f32_16x16x32_bf16 v[224:227], v[104:107], v[64:67], v[224:227]
    v_mfma_f32_16x16x32_bf16 v[228:231], v[104:107], v[68:71], v[228:231]
    s_waitcnt lgkmcnt(0)
    s_barrier
    v_mfma_f32_16x16x32_bf16 v[160:163], v[120:123], v[112:115], v[160:163]
    ds_read_b128 v[64:67], v44 offset:0
    ds_read_b128 v[68:71], v44 offset:2048
    v_mfma_f32_16x16x32_bf16 v[164:167], v[120:123], v[116:119], v[164:167]
    ds_read_b64_tr_b16 v[72:73], v52 offset:0
    ds_read_b64_tr_b16 v[74:75], v52 offset:2304
    v_mfma_f32_16x16x32_bf16 v[168:171], v[124:127], v[112:115], v[168:171]
    ds_read_b64_tr_b16 v[76:77], v52 offset:32
    ds_read_b64_tr_b16 v[78:79], v52 offset:2336
    v_mfma_f32_16x16x32_bf16 v[172:175], v[124:127], v[116:119], v[172:175]
    ds_read_b64_tr_b16 v[80:81], v52 offset:64
    ds_read_b64_tr_b16 v[82:83], v52 offset:2368
    v_mfma_f32_16x16x32_bf16 v[176:179], v[128:131], v[112:115], v[176:179]
    ds_read_b64_tr_b16 v[84:85], v52 offset:96
    ds_read_b64_tr_b16 v[86:87], v52 offset:2400
    v_mfma_f32_16x16x32_bf16 v[180:183], v[128:131], v[116:119], v[180:183]
    ds_read_b64_tr_b16 v[88:89], v52 offset:128
    ds_read_b64_tr_b16 v[90:91], v52 offset:2432
    v_mfma_f32_16x16x32_bf16 v[184:187], v[132:135], v[112:115], v[184:187]
    ds_read_b64_tr_b16 v[92:93], v52 offset:160
    ds_read_b64_tr_b16 v[94:95], v52 offset:2464
    v_mfma_f32_16x16x32_bf16 v[188:191], v[132:135], v[116:119], v[188:191]
    ds_read_b64_tr_b16 v[96:97], v52 offset:192
    ds_read_b64_tr_b16 v[98:99], v52 offset:2496
    v_mfma_f32_16x16x32_bf16 v[192:195], v[136:139], v[112:115], v[192:195]
    ds_read_b64_tr_b16 v[100:101], v52 offset:224
    ds_read_b64_tr_b16 v[102:103], v52 offset:2528
    v_mfma_f32_16x16x32_bf16 v[196:199], v[136:139], v[116:119], v[196:199]
    ds_read_b64_tr_b16 v[104:105], v52 offset:256
    ds_read_b64_tr_b16 v[106:107], v52 offset:2560
    v_mfma_f32_16x16x32_bf16 v[200:203], v[140:143], v[112:115], v[200:203]
    v_mfma_f32_16x16x32_bf16 v[204:207], v[140:143], v[116:119], v[204:207]
    v_mfma_f32_16x16x32_bf16 v[208:211], v[144:147], v[112:115], v[208:211]
    v_mfma_f32_16x16x32_bf16 v[212:215], v[144:147], v[116:119], v[212:215]
    v_mfma_f32_16x16x32_bf16 v[216:219], v[148:151], v[112:115], v[216:219]
    v_mfma_f32_16x16x32_bf16 v[220:223], v[148:151], v[116:119], v[220:223]
    v_mfma_f32_16x16x32_bf16 v[224:227], v[152:155], v[112:115], v[224:227]
    v_mfma_f32_16x16x32_bf16 v[228:231], v[152:155], v[116:119], v[228:231]
    s_waitcnt lgkmcnt(0)
    v_mfma_f32_16x16x32_bf16 v[160:163], v[72:75], v[64:67], v[160:163]
    ds_read_b128 v[112:115], v45 offset:0
    ds_read_b128 v[116:119], v45 offset:2048
    v_mfma_f32_16x16x32_bf16 v[164:167], v[72:75], v[68:71], v[164:167]
    ds_read_b64_tr_b16 v[120:121], v52 offset:9216
    ds_read_b64_tr_b16 v[122:123], v52 offset:11520
    v_mfma_f32_16x16x32_bf16 v[168:171], v[76:79], v[64:67], v[168:171]
    ds_read_b64_tr_b16 v[124:125], v52 offset:9248
    ds_read_b64_tr_b16 v[126:127], v52 offset:11552
    v_mfma_f32_16x16x32_bf16 v[172:175], v[76:79], v[68:71], v[172:175]
    ds_read_b64_tr_b16 v[128:129], v52 offset:9280
    ds_read_b64_tr_b16 v[130:131], v52 offset:11584
    v_mfma_f32_16x16x32_bf16 v[176:179], v[80:83], v[64:67], v[176:179]
    ds_read_b64_tr_b16 v[132:133], v52 offset:9312
    ds_read_b64_tr_b16 v[134:135], v52 offset:11616
    v_mfma_f32_16x16x32_bf16 v[180:183], v[80:83], v[68:71], v[180:183]
    ds_read_b64_tr_b16 v[136:137], v52 offset:9344
    ds_read_b64_tr_b16 v[138:139], v52 offset:11648
    v_mfma_f32_16x16x32_bf16 v[184:187], v[84:87], v[64:67], v[184:187]
    ds_read_b64_tr_b16 v[140:141], v52 offset:9376
    ds_read_b64_tr_b16 v[142:143], v52 offset:11680
    v_mfma_f32_16x16x32_bf16 v[188:191], v[84:87], v[68:71], v[188:191]
    ds_read_b64_tr_b16 v[144:145], v52 offset:9408
    ds_read_b64_tr_b16 v[146:147], v52 offset:11712
    v_mfma_f32_16x16x32_bf16 v[192:195], v[88:91], v[64:67], v[192:195]
    ds_read_b64_tr_b16 v[148:149], v52 offset:9440
    ds_read_b64_tr_b16 v[150:151], v52 offset:11744
    v_mfma_f32_16x16x32_bf16 v[196:199], v[88:91], v[68:71], v[196:199]
    ds_read_b64_tr_b16 v[152:153], v52 offset:9472
    ds_read_b64_tr_b16 v[154:155], v52 offset:11776
    v_mfma_f32_16x16x32_bf16 v[200:203], v[92:95], v[64:67], v[200:203]
    v_mfma_f32_16x16x32_bf16 v[204:207], v[92:95], v[68:71], v[204:207]
    v_mfma_f32_16x16x32_bf16 v[208:211], v[96:99], v[64:67], v[208:211]
    v_mfma_f32_16x16x32_bf16 v[212:215], v[96:99], v[68:71], v[212:215]
    v_mfma_f32_16x16x32_bf16 v[216:219], v[100:103], v[64:67], v[216:219]
    v_mfma_f32_16x16x32_bf16 v[220:223], v[100:103], v[68:71], v[220:223]
    v_mfma_f32_16x16x32_bf16 v[224:227], v[104:107], v[64:67], v[224:227]
    v_mfma_f32_16x16x32_bf16 v[228:231], v[104:107], v[68:71], v[228:231]
    s_waitcnt lgkmcnt(0)
    s_barrier
    v_mfma_f32_16x16x32_bf16 v[160:163], v[120:123], v[112:115], v[160:163]
    ds_read_b128 v[64:67], v46 offset:0
    ds_read_b128 v[68:71], v46 offset:2048
    v_mfma_f32_16x16x32_bf16 v[164:167], v[120:123], v[116:119], v[164:167]
    ds_read_b64_tr_b16 v[72:73], v54 offset:0
    ds_read_b64_tr_b16 v[74:75], v54 offset:2304
    v_mfma_f32_16x16x32_bf16 v[168:171], v[124:127], v[112:115], v[168:171]
    ds_read_b64_tr_b16 v[76:77], v54 offset:32
    ds_read_b64_tr_b16 v[78:79], v54 offset:2336
    v_mfma_f32_16x16x32_bf16 v[172:175], v[124:127], v[116:119], v[172:175]
    ds_read_b64_tr_b16 v[80:81], v54 offset:64
    ds_read_b64_tr_b16 v[82:83], v54 offset:2368
    v_mfma_f32_16x16x32_bf16 v[176:179], v[128:131], v[112:115], v[176:179]
    ds_read_b64_tr_b16 v[84:85], v54 offset:96
    ds_read_b64_tr_b16 v[86:87], v54 offset:2400
    v_mfma_f32_16x16x32_bf16 v[180:183], v[128:131], v[116:119], v[180:183]
    ds_read_b64_tr_b16 v[88:89], v54 offset:128
    ds_read_b64_tr_b16 v[90:91], v54 offset:2432
    v_mfma_f32_16x16x32_bf16 v[184:187], v[132:135], v[112:115], v[184:187]
    ds_read_b64_tr_b16 v[92:93], v54 offset:160
    ds_read_b64_tr_b16 v[94:95], v54 offset:2464
    v_mfma_f32_16x16x32_bf16 v[188:191], v[132:135], v[116:119], v[188:191]
    ds_read_b64_tr_b16 v[96:97], v54 offset:192
    ds_read_b64_tr_b16 v[98:99], v54 offset:2496
    v_mfma_f32_16x16x32_bf16 v[192:195], v[136:139], v[112:115], v[192:195]
    ds_read_b64_tr_b16 v[100:101], v54 offset:224
    ds_read_b64_tr_b16 v[102:103], v54 offset:2528
    v_mfma_f32_16x16x32_bf16 v[196:199], v[136:139], v[116:119], v[196:199]
    ds_read_b64_tr_b16 v[104:105], v54 offset:256
    ds_read_b64_tr_b16 v[106:107], v54 offset:2560
    v_mfma_f32_16x16x32_bf16 v[200:203], v[140:143], v[112:115], v[200:203]
    v_mfma_f32_16x16x32_bf16 v[204:207], v[140:143], v[116:119], v[204:207]
    v_mfma_f32_16x16x32_bf16 v[208:211], v[144:147], v[112:115], v[208:211]
    v_mfma_f32_16x16x32_bf16 v[212:215], v[144:147], v[116:119], v[212:215]
    v_mfma_f32_16x16x32_bf16 v[216:219], v[148:151], v[112:115], v[216:219]
    v_mfma_f32_16x16x32_bf16 v[220:223], v[148:151], v[116:119], v[220:223]
    v_mfma_f32_16x16x32_bf16 v[224:227], v[152:155], v[112:115], v[224:227]
    v_mfma_f32_16x16x32_bf16 v[228:231], v[152:155], v[116:119], v[228:231]
    s_waitcnt lgkmcnt(0)
    v_mfma_f32_16x16x32_bf16 v[160:163], v[72:75], v[64:67], v[160:163]
    ds_read_b128 v[112:115], v47 offset:0
    ds_read_b128 v[116:119], v47 offset:2048
    v_mfma_f32_16x16x32_bf16 v[164:167], v[72:75], v[68:71], v[164:167]
    ds_read_b64_tr_b16 v[120:121], v54 offset:9216
    ds_read_b64_tr_b16 v[122:123], v54 offset:11520
    v_mfma_f32_16x16x32_bf16 v[168:171], v[76:79], v[64:67], v[168:171]
    ds_read_b64_tr_b16 v[124:125], v54 offset:9248
    ds_read_b64_tr_b16 v[126:127], v54 offset:11552
    v_mfma_f32_16x16x32_bf16 v[172:175], v[76:79], v[68:71], v[172:175]
    ds_read_b64_tr_b16 v[128:129], v54 offset:9280
    ds_read_b64_tr_b16 v[130:131], v54 offset:11584
    v_mfma_f32_16x16x32_bf16 v[176:179], v[80:83], v[64:67], v[176:179]
    ds_read_b64_tr_b16 v[132:133], v54 offset:9312
    ds_read_b64_tr_b16 v[134:135], v54 offset:11616
    v_mfma_f32_16x16x32_bf16 v[180:183], v[80:83], v[68:71], v[180:183]
    ds_read_b64_tr_b16 v[136:137], v54 offset:9344
    ds_read_b64_tr_b16 v[138:139], v54 offset:11648
    v_mfma_f32_16x16x32_bf16 v[184:187], v[84:87], v[64:67], v[184:187]
    ds_read_b64_tr_b16 v[140:141], v54 offset:9376
    ds_read_b64_tr_b16 v[142:143], v54 offset:11680
    v_mfma_f32_16x16x32_bf16 v[188:191], v[84:87], v[68:71], v[188:191]
    ds_read_b64_tr_b16 v[144:145], v54 offset:9408
    ds_read_b64_tr_b16 v[146:147], v54 offset:11712
    v_mfma_f32_16x16x32_bf16 v[192:195], v[88:91], v[64:67], v[192:195]
    ds_read_b64_tr_b16 v[148:149], v54 offset:9440
    ds_read_b64_tr_b16 v[150:151], v54 offset:11744
    v_mfma_f32_16x16x32_bf16 v[196:199], v[88:91], v[68:71], v[196:199]
    ds_read_b64_tr_b16 v[152:153], v54 offset:9472
    ds_read_b64_tr_b16 v[154:155], v54 offset:11776
    v_mfma_f32_16x16x32_bf16 v[200:203], v[92:95], v[64:67], v[200:203]
    v_mfma_f32_16x16x32_bf16 v[204:207], v[92:95], v[68:71], v[204:207]
    v_mfma_f32_16x16x32_bf16 v[208:211], v[96:99], v[64:67], v[208:211]
    v_mfma_f32_16x16x32_bf16 v[212:215], v[96:99], v[68:71], v[212:215]
    v_mfma_f32_16x16x32_bf16 v[216:219], v[100:103], v[64:67], v[216:219]
    v_mfma_f32_16x16x32_bf16 v[220:223], v[100:103], v[68:71], v[220:223]
    v_mfma_f32_16x16x32_bf16 v[224:227], v[104:107], v[64:67], v[224:227]
    v_mfma_f32_16x16x32_bf16 v[228:231], v[104:107], v[68:71], v[228:231]
    s_waitcnt lgkmcnt(0)
    s_barrier
    v_mfma_f32_16x16x32_bf16 v[160:163], v[120:123], v[112:115], v[160:163]
    ds_read_b128 v[64:67], v40 offset:0
    ds_read_b128 v[68:71], v40 offset:2048
    v_mfma_f32_16x16x32_bf16 v[164:167], v[120:123], v[116:119], v[164:167]
    ds_read_b64_tr_b16 v[72:73], v48 offset:0
    ds_read_b64_tr_b16 v[74:75], v48 offset:2304
    v_mfma_f32_16x16x32_bf16 v[168:171], v[124:127], v[112:115], v[168:171]
    ds_read_b64_tr_b16 v[76:77], v48 offset:32
    ds_read_b64_tr_b16 v[78:79], v48 offset:2336
    v_mfma_f32_16x16x32_bf16 v[172:175], v[124:127], v[116:119], v[172:175]
    ds_read_b64_tr_b16 v[80:81], v48 offset:64
    ds_read_b64_tr_b16 v[82:83], v48 offset:2368
    v_mfma_f32_16x16x32_bf16 v[176:179], v[128:131], v[112:115], v[176:179]
    ds_read_b64_tr_b16 v[84:85], v48 offset:96
    ds_read_b64_tr_b16 v[86:87], v48 offset:2400
    v_mfma_f32_16x16x32_bf16 v[180:183], v[128:131], v[116:119], v[180:183]
    ds_read_b64_tr_b16 v[88:89], v48 offset:128
    ds_read_b64_tr_b16 v[90:91], v48 offset:2432
    v_mfma_f32_16x16x32_bf16 v[184:187], v[132:135], v[112:115], v[184:187]
    ds_read_b64_tr_b16 v[92:93], v48 offset:160
    ds_read_b64_tr_b16 v[94:95], v48 offset:2464
    v_mfma_f32_16x16x32_bf16 v[188:191], v[132:135], v[116:119], v[188:191]
    ds_read_b64_tr_b16 v[96:97], v48 offset:192
    ds_read_b64_tr_b16 v[98:99], v48 offset:2496
    v_mfma_f32_16x16x32_bf16 v[192:195], v[136:139], v[112:115], v[192:195]
    ds_read_b64_tr_b16 v[100:101], v48 offset:224
    ds_read_b64_tr_b16 v[102:103], v48 offset:2528
    v_mfma_f32_16x16x32_bf16 v[196:199], v[136:139], v[116:119], v[196:199]
    ds_read_b64_tr_b16 v[104:105], v48 offset:256
    ds_read_b64_tr_b16 v[106:107], v48 offset:2560
    v_mfma_f32_16x16x32_bf16 v[200:203], v[140:143], v[112:115], v[200:203]
    v_mfma_f32_16x16x32_bf16 v[204:207], v[140:143], v[116:119], v[204:207]
    v_mfma_f32_16x16x32_bf16 v[208:211], v[144:147], v[112:115], v[208:211]
    v_mfma_f32_16x16x32_bf16 v[212:215], v[144:147], v[116:119], v[212:215]
    v_mfma_f32_16x16x32_bf16 v[216:219], v[148:151], v[112:115], v[216:219]
    v_mfma_f32_16x16x32_bf16 v[220:223], v[148:151], v[116:119], v[220:223]
    v_mfma_f32_16x16x32_bf16 v[224:227], v[152:155], v[112:115], v[224:227]
    v_mfma_f32_16x16x32_bf16 v[228:231], v[152:155], v[116:119], v[228:231]
    s_sub_u32 s47, s47, 1
    s_cmp_lg_u32 s47, 0
    s_cbranch_scc1 KB_LOOP4
    s_waitcnt lgkmcnt(0)
    v_mfma_f32_16x16x32_bf16 v[160:163], v[72:75], v[64:67], v[160:163]
    ds_read_b128 v[112:115], v41 offset:0
    ds_read_b128 v[116:119], v41 offset:2048
    v_mfma_f32_16x16x32_bf16 v[164:167], v[72:75], v[68:71], v[164:167]
    ds_read_b64_tr_b16 v[120:121], v48 offset:9216
    ds_read_b64_tr_b16 v[122:123], v48 offset:11520
    v_mfma_f32_16x16x32_bf16 v[168:171], v[76:79], v[64:67], v[168:171]
    ds_read_b64_tr_b16 v[124:125], v48 offset:9248
    ds_read_b64_tr_b16 v[126:127], v48 offset:11552
    v_mfma_f32_16x16x32_bf16 v[172:175], v[76:79], v[68:71], v[172:175]
    ds_read_b64_tr_b16 v[128:129], v48 offset:9280
    ds_read_b64_tr_b16 v[130:131], v48 offset:11584
    v_mfma_f32_16x16x32_bf16 v[176:179], v[80:83], v[64:67], v[176:179]
    ds_read_b64_tr_b16 v[132:133], v48 offset:9312
    ds_read_b64_tr_b16 v[134:135], v48 offset:11616
    v_mfma_f32_16x16x32_bf16 v[180:183], v[80:83], v[68:71], v[180:183]
    ds_read_b64_tr_b16 v[136:137], v48 offset:9344
    ds_read_b64_tr_b16 v[138:139], v48 offset:11648
    v_mfma_f32_16x16x32_bf16 v[184:187], v[84:87], v[64:67], v[184:187]
    ds_read_b64_tr_b16 v[140:141], v48 offset:9376
    ds_read_b64_tr_b16 v[142:143], v48 offset:11680
    v_mfma_f32_16x16x32_bf16 v[188:191], v[84:87], v[68:71], v[188:191]
    ds_read_b64_tr_b16 v[144:145], v48 offset:9408
    ds_read_b64_tr_b16 v[146:147], v48 offset:11712
    v_mfma_f32_16x16x32_bf16 v[192:195], v[88:91], v[64:67], v[192:195]
    ds_read_b64_tr_b16 v[148:149], v48 offset:9440
    ds_read_b64_tr_b16 v[150:151], v48 offset:11744
    v_mfma_f32_16x16x32_bf16 v[196:199], v[88:91], v[68:71], v[196:199]
    ds_read_b64_tr_b16 v[152:153], v48 offset:9472
    ds_read_b64_tr_b16 v[154:155], v48 offset:11776
    v_mfma_f32_16x16x32_bf16 v[200:203], v[92:95], v[64:67], v[200:203]
    v_mfma_f32_16x16x32_bf16 v[204:207], v[92:95], v[68:71], v[204:207]
    v_mfma_f32_16x16x32_bf16 v[208:211], v[96:99], v[64:67], v[208:211]
    v_mfma_f32_16x16x32_bf16 v[212:215], v[96:99], v[68:71], v[212:215]
    v_mfma_f32_16x16x32_bf16 v[216:219], v[100:103], v[64:67], v[216:219]
    v_mfma_f32_16x16x32_bf16 v[220:223], v[100:103], v[68:71], v[220:223]
    v_mfma_f32_16x16x32_bf16 v[224:227], v[104:107], v[64:67], v[224:227]
    v_mfma_f32_16x16x32_bf16 v[228:231], v[104:107], v[68:71], v[228:231]
    s_waitcnt lgkmcnt(0)
    s_barrier
    v_mfma_f32_16x16x32_bf16 v[160:163], v[120:123], v[112:115], v[160:163]
    ds_read_b128 v[64:67], v42 offset:0
    ds_read_b128 v[68:71], v42 offset:2048
    v_mfma_f32_16x16x32_bf16 v[164:167], v[120:123], v[116:119], v[164:167]
    ds_read_b64_tr_b16 v[72:73], v50 offset:0
    ds_read_b64_tr_b16 v[74:75], v50 offset:2304
    v_mfma_f32_16x16x32_bf16 v[168:171], v[124:127], v[112:115], v[168:171]
    ds_read_b64_tr_b16 v[76:77], v50 offset:32
    ds_read_b64_tr_b16 v[78:79], v50 offset:2336
    v_mfma_f32_16x16x32_bf16 v[172:175], v[124:127], v[116:119], v[172:175]
    ds_read_b64_tr_b16 v[80:81], v50 offset:64
    ds_read_b64_tr_b16 v[82:83], v50 offset:2368
    v_mfma_f32_16x16x32_bf16 v[176:179], v[128:131], v[112:115], v[176:179]
    ds_read_b64_tr_b16 v[84:85], v50 offset:96
    ds_read_b64_tr_b16 v[86:87], v50 offset:2400
    v_mfma_f32_16x16x32_bf16 v[180:183], v[128:131], v[116:119], v[180:183]
    ds_read_b64_tr_b16 v[88:89], v50 offset:128
    ds_read_b64_tr_b16 v[90:91], v50 offset:2432
    v_mfma_f32_16x16x32_bf16 v[184:187], v[132:135], v[112:115], v[184:187]
    ds_read_b64_tr_b16 v[92:93], v50 offset:160
    ds_read_b64_tr_b16 v[94:95], v50 offset:2464
    v_mfma_f32_16x16x32_bf16 v[188:191], v[132:135], v[116:119], v[188:191]
    ds_read_b64_tr_b16 v[96:97], v50 offset:192
    ds_read_b64_tr_b16 v[98:99], v50 offset:2496
    v_mfma_f32_16x16x32_bf16 v[192:195], v[136:139], v[112:115], v[192:195]
    ds_read_b64_tr_b16 v[100:101], v50 offset:224
    ds_read_b64_tr_b16 v[102:103], v50 offset:2528
    v_mfma_f32_16x16x32_bf16 v[196:199], v[136:139], v[116:119], v[196:199]
    ds_read_b64_tr_b16 v[104:105], v50 offset:256
    ds_read_b64_tr_b16 v[106:107], v50 offset:2560
    v_mfma_f32_16x16x32_bf16 v[200:203], v[140:143], v[112:115], v[200:203]
    v_mfma_f32_16x16x32_bf16 v[204:207], v[140:143], v[116:119], v[204:207]
    v_mfma_f32_16x16x32_bf16 v[208:211], v[144:147], v[112:115], v[208:211]
    v_mfma_f32_16x16x32_bf16 v[212:215], v[144:147], v[116:119], v[212:215]
    v_mfma_f32_16x16x32_bf16 v[216:219], v[148:151], v[112:115], v[216:219]
    v_mfma_f32_16x16x32_bf16 v[220:223], v[148:151], v[116:119], v[220:223]
    v_mfma_f32_16x16x32_bf16 v[224:227], v[152:155], v[112:115], v[224:227]
    v_mfma_f32_16x16x32_bf16 v[228:231], v[152:155], v[116:119], v[228:231]
    s_waitcnt lgkmcnt(0)
    v_mfma_f32_16x16x32_bf16 v[160:163], v[72:75], v[64:67], v[160:163]
    ds_read_b128 v[112:115], v43 offset:0
    ds_read_b128 v[116:119], v43 offset:2048
    v_mfma_f32_16x16x32_bf16 v[164:167], v[72:75], v[68:71], v[164:167]
    ds_read_b64_tr_b16 v[120:121], v50 offset:9216
    ds_read_b64_tr_b16 v[122:123], v50 offset:11520
    v_mfma_f32_16x16x32_bf16 v[168:171], v[76:79], v[64:67], v[168:171]
    ds_read_b64_tr_b16 v[124:125], v50 offset:9248
    ds_read_b64_tr_b16 v[126:127], v50 offset:11552
    v_mfma_f32_16x16x32_bf16 v[172:175], v[76:79], v[68:71], v[172:175]
    ds_read_b64_tr_b16 v[128:129], v50 offset:9280
    ds_read_b64_tr_b16 v[130:131], v50 offset:11584
    v_mfma_f32_16x16x32_bf16 v[176:179], v[80:83], v[64:67], v[176:179]
    ds_read_b64_tr_b16 v[132:133], v50 offset:9312
    ds_read_b64_tr_b16 v[134:135], v50 offset:11616
    v_mfma_f32_16x16x32_bf16 v[180:183], v[80:83], v[68:71], v[180:183]
    ds_read_b64_tr_b16 v[136:137], v50 offset:9344
    ds_read_b64_tr_b16 v[138:139], v50 offset:11648
    v_mfma_f32_16x16x32_bf16 v[184:187], v[84:87], v[64:67], v[184:187]
    ds_read_b64_tr_b16 v[140:141], v50 offset:9376
    ds_read_b64_tr_b16 v[142:143], v50 offset:11680
    v_mfma_f32_16x16x32_bf16 v[188:191], v[84:87], v[68:71], v[188:191]
    ds_read_b64_tr_b16 v[144:145], v50 offset:9408
    ds_read_b64_tr_b16 v[146:147], v50 offset:11712
    v_mfma_f32_16x16x32_bf16 v[192:195], v[88:91], v[64:67], v[192:195]
    ds_read_b64_tr_b16 v[148:149], v50 offset:9440
    ds_read_b64_tr_b16 v[150:151], v50 offset:11744
    v_mfma_f32_16x16x32_bf16 v[196:199], v[88:91], v[68:71], v[196:199]
    ds_read_b64_tr_b16 v[152:153], v50 offset:9472
    ds_read_b64_tr_b16 v[154:155], v50 offset:11776
    v_mfma_f32_16x16x32_bf16 v[200:203], v[92:95], v[64:67], v[200:203]
    v_mfma_f32_16x16x32_bf16 v[204:207], v[92:95], v[68:71], v[204:207]
    v_mfma_f32_16x16x32_bf16 v[208:211], v[96:99], v[64:67], v[208:211]
    v_mfma_f32_16x16x32_bf16 v[212:215], v[96:99], v[68:71], v[212:215]
    v_mfma_f32_16x16x32_bf16 v[216:219], v[100:103], v[64:67], v[216:219]
    v_mfma_f32_16x16x32_bf16 v[220:223], v[100:103], v[68:71], v[220:223]
    v_mfma_f32_16x16x32_bf16 v[224:227], v[104:107], v[64:67], v[224:227]
    v_mfma_f32_16x16x32_bf16 v[228:231], v[104:107], v[68:71], v[228:231]
    s_waitcnt lgkmcnt(0)
    s_barrier
    v_mfma_f32_16x16x32_bf16 v[160:163], v[120:123], v[112:115], v[160:163]
    ds_read_b128 v[64:67], v44 offset:0
    ds_read_b128 v[68:71], v44 offset:2048
    v_mfma_f32_16x16x32_bf16 v[164:167], v[120:123], v[116:119], v[164:167]
    ds_read_b64_tr_b16 v[72:73], v52 offset:0
    ds_read_b64_tr_b16 v[74:75], v52 offset:2304
    v_mfma_f32_16x16x32_bf16 v[168:171], v[124:127], v[112:115], v[168:171]
    ds_read_b64_tr_b16 v[76:77], v52 offset:32
    ds_read_b64_tr_b16 v[78:79], v52 offset:2336
    v_mfma_f32_16x16x32_bf16 v[172:175], v[124:127], v[116:119], v[172:175]
    ds_read_b64_tr_b16 v[80:81], v52 offset:64
    ds_read_b64_tr_b16 v[82:83], v52 offset:2368
    v_mfma_f32_16x16x32_bf16 v[176:179], v[128:131], v[112:115], v[176:179]
    ds_read_b64_tr_b16 v[84:85], v52 offset:96
    ds_read_b64_tr_b16 v[86:87], v52 offset:2400
    v_mfma_f32_16x16x32_bf16 v[180:183], v[128:131], v[116:119], v[180:183]
    ds_read_b64_tr_b16 v[88:89], v52 offset:128
    ds_read_b64_tr_b16 v[90:91], v52 offset:2432
    v_mfma_f32_16x16x32_bf16 v[184:187], v[132:135], v[112:115], v[184:187]
    ds_read_b64_tr_b16 v[92:93], v52 offset:160
    ds_read_b64_tr_b16 v[94:95], v52 offset:2464
    v_mfma_f32_16x16x32_bf16 v[188:191], v[132:135], v[116:119], v[188:191]
    ds_read_b64_tr_b16 v[96:97], v52 offset:192
    ds_read_b64_tr_b16 v[98:99], v52 offset:2496
    v_mfma_f32_16x16x32_bf16 v[192:195], v[136:139], v[112:115], v[192:195]
    ds_read_b64_tr_b16 v[100:101], v52 offset:224
    ds_read_b64_tr_b16 v[102:103], v52 offset:2528
    v_mfma_f32_16x16x32_bf16 v[196:199], v[136:139], v[116:119], v[196:199]
    ds_read_b64_tr_b16 v[104:105], v52 offset:256
    ds_read_b64_tr_b16 v[106:107], v52 offset:2560
    v_mfma_f32_16x16x32_bf16 v[200:203], v[140:143], v[112:115], v[200:203]
    v_mfma_f32_16x16x32_bf16 v[204:207], v[140:143], v[116:119], v[204:207]
    v_mfma_f32_16x16x32_bf16 v[208:211], v[144:147], v[112:115], v[208:211]
    v_mfma_f32_16x16x32_bf16 v[212:215], v[144:147], v[116:119], v[212:215]
    v_mfma_f32_16x16x32_bf16 v[216:219], v[148:151], v[112:115], v[216:219]
    v_mfma_f32_16x16x32_bf16 v[220:223], v[148:151], v[116:119], v[220:223]
    v_mfma_f32_16x16x32_bf16 v[224:227], v[152:155], v[112:115], v[224:227]
    v_mfma_f32_16x16x32_bf16 v[228:231], v[152:155], v[116:119], v[228:231]
    s_waitcnt lgkmcnt(0)
    v_mfma_f32_16x16x32_bf16 v[160:163], v[72:75], v[64:67], v[160:163]
    ds_read_b128 v[112:115], v45 offset:0
    ds_read_b128 v[116:119], v45 offset:2048
    v_mfma_f32_16x16x32_bf16 v[164:167], v[72:75], v[68:71], v[164:167]
    ds_read_b64_tr_b16 v[120:121], v52 offset:9216
    ds_read_b64_tr_b16 v[122:123], v52 offset:11520
    v_mfma_f32_16x16x32_bf16 v[168:171], v[76:79], v[64:67], v[168:171]
    ds_read_b64_tr_b16 v[124:125], v52 offset:9248
    ds_read_b64_tr_b16 v[126:127], v52 offset:11552
    v_mfma_f32_16x16x32_bf16 v[172:175], v[76:79], v[68:71], v[172:175]
    ds_read_b64_tr_b16 v[128:129], v52 offset:9280
    ds_read_b64_tr_b16 v[130:131], v52 offset:11584
    v_mfma_f32_16x16x32_bf16 v[176:179], v[80:83], v[64:67], v[176:179]
    ds_read_b64_tr_b16 v[132:133], v52 offset:9312
    ds_read_b64_tr_b16 v[134:135], v52 offset:11616
    v_mfma_f32_16x16x32_bf16 v[180:183], v[80:83], v[68:71], v[180:183]
    ds_read_b64_tr_b16 v[136:137], v52 offset:9344
    ds_read_b64_tr_b16 v[138:139], v52 offset:11648
    v_mfma_f32_16x16x32_bf16 v[184:187], v[84:87], v[64:67], v[184:187]
    ds_read_b64_tr_b16 v[140:141], v52 offset:9376
    ds_read_b64_tr_b16 v[142:143], v52 offset:11680
    v_mfma_f32_16x16x32_bf16 v[188:191], v[84:87], v[68:71], v[188:191]
    ds_read_b64_tr_b16 v[144:145], v52 offset:9408
    ds_read_b64_tr_b16 v[146:147], v52 offset:11712
    v_mfma_f32_16x16x32_bf16 v[192:195], v[88:91], v[64:67], v[192:195]
    ds_read_b64_tr_b16 v[148:149], v52 offset:9440
    ds_read_b64_tr_b16 v[150:151], v52 offset:11744
    v_mfma_f32_16x16x32_bf16 v[196:199], v[88:91], v[68:71], v[196:199]
    ds_read_b64_tr_b16 v[152:153], v52 offset:9472
    ds_read_b64_tr_b16 v[154:155], v52 offset:11776
    v_mfma_f32_16x16x32_bf16 v[200:203], v[92:95], v[64:67], v[200:203]
    v_mfma_f32_16x16x32_bf16 v[204:207], v[92:95], v[68:71], v[204:207]
    v_mfma_f32_16x16x32_bf16 v[208:211], v[96:99], v[64:67], v[208:211]
    v_mfma_f32_16x16x32_bf16 v[212:215], v[96:99], v[68:71], v[212:215]
    v_mfma_f32_16x16x32_bf16 v[216:219], v[100:103], v[64:67], v[216:219]
    v_mfma_f32_16x16x32_bf16 v[220:223], v[100:103], v[68:71], v[220:223]
    v_mfma_f32_16x16x32_bf16 v[224:227], v[104:107], v[64:67], v[224:227]
    v_mfma_f32_16x16x32_bf16 v[228:231], v[104:107], v[68:71], v[228:231]
    s_waitcnt lgkmcnt(0)
    s_barrier
    v_mfma_f32_16x16x32_bf16 v[160:163], v[120:123], v[112:115], v[160:163]
    ds_read_b128 v[64:67], v46 offset:0
    ds_read_b128 v[68:71], v46 offset:2048
    v_mfma_f32_16x16x32_bf16 v[164:167], v[120:123], v[116:119], v[164:167]
    ds_read_b64_tr_b16 v[72:73], v54 offset:0
    ds_read_b64_tr_b16 v[74:75], v54 offset:2304
    v_mfma_f32_16x16x32_bf16 v[168:171], v[124:127], v[112:115], v[168:171]
    ds_read_b64_tr_b16 v[76:77], v54 offset:32
    ds_read_b64_tr_b16 v[78:79], v54 offset:2336
    v_mfma_f32_16x16x32_bf16 v[172:175], v[124:127], v[116:119], v[172:175]
    ds_read_b64_tr_b16 v[80:81], v54 offset:64
    ds_read_b64_tr_b16 v[82:83], v54 offset:2368
    v_mfma_f32_16x16x32_bf16 v[176:179], v[128:131], v[112:115], v[176:179]
    ds_read_b64_tr_b16 v[84:85], v54 offset:96
    ds_read_b64_tr_b16 v[86:87], v54 offset:2400
    v_mfma_f32_16x16x32_bf16 v[180:183], v[128:131], v[116:119], v[180:183]
    ds_read_b64_tr_b16 v[88:89], v54 offset:128
    ds_read_b64_tr_b16 v[90:91], v54 offset:2432
    v_mfma_f32_16x16x32_bf16 v[184:187], v[132:135], v[112:115], v[184:187]
    ds_read_b64_tr_b16 v[92:93], v54 offset:160
    ds_read_b64_tr_b16 v[94:95], v54 offset:2464
    v_mfma_f32_16x16x32_bf16 v[188:191], v[132:135], v[116:119], v[188:191]
    ds_read_b64_tr_b16 v[96:97], v54 offset:192
    ds_read_b64_tr_b16 v[98:99], v54 offset:2496
    v_mfma_f32_16x16x32_bf16 v[192:195], v[136:139], v[112:115], v[192:195]
    ds_read_b64_tr_b16 v[100:101], v54 offset:224
    ds_read_b64_tr_b16 v[102:103], v54 offset:2528
    v_mfma_f32_16x16x32_bf16 v[196:199], v[136:139], v[116:119], v[196:199]
    ds_read_b64_tr_b16 v[104:105], v54 offset:256
    ds_read_b64_tr_b16 v[106:107], v54 offset:2560
    v_mfma_f32_16x16x32_bf16 v[200:203], v[140:143], v[112:115], v[200:203]
    v_mfma_f32_16x16x32_bf16 v[204:207], v[140:143], v[116:119], v[204:207]
    v_mfma_f32_16x16x32_bf16 v[208:211], v[144:147], v[112:115], v[208:211]
    v_mfma_f32_16x16x32_bf16 v[212:215], v[144:147], v[116:119], v[212:215]
    v_mfma_f32_16x16x32_bf16 v[216:219], v[148:151], v[112:115], v[216:219]
    v_mfma_f32_16x16x32_bf16 v[220:223], v[148:151], v[116:119], v[220:223]
    v_mfma_f32_16x16x32_bf16 v[224:227], v[152:155], v[112:115], v[224:227]
    v_mfma_f32_16x16x32_bf16 v[228:231], v[152:155], v[116:119], v[228:231]
    s_waitcnt lgkmcnt(0)
    v_mfma_f32_16x16x32_bf16 v[160:163], v[72:75], v[64:67], v[160:163]
    ds_read_b128 v[112:115], v47 offset:0
    ds_read_b128 v[116:119], v47 offset:2048
    v_mfma_f32_16x16x32_bf16 v[164:167], v[72:75], v[68:71], v[164:167]
    ds_read_b64_tr_b16 v[120:121], v54 offset:9216
    ds_read_b64_tr_b16 v[122:123], v54 offset:11520
    v_mfma_f32_16x16x32_bf16 v[168:171], v[76:79], v[64:67], v[168:171]
    ds_read_b64_tr_b16 v[124:125], v54 offset:9248
    ds_read_b64_tr_b16 v[126:127], v54 offset:11552
    v_mfma_f32_16x16x32_bf16 v[172:175], v[76:79], v[68:71], v[172:175]
    ds_read_b64_tr_b16 v[128:129], v54 offset:9280
    ds_read_b64_tr_b16 v[130:131], v54 offset:11584
    v_mfma_f32_16x16x32_bf16 v[176:179], v[80:83], v[64:67], v[176:179]
    ds_read_b64_tr_b16 v[132:133], v54 offset:9312
    ds_read_b64_tr_b16 v[134:135], v54 offset:11616
    v_mfma_f32_16x16x32_bf16 v[180:183], v[80:83], v[68:71], v[180:183]
    ds_read_b64_tr_b16 v[136:137], v54 offset:9344
    ds_read_b64_tr_b16 v[138:139], v54 offset:11648
    v_mfma_f32_16x16x32_bf16 v[184:187], v[84:87], v[64:67], v[184:187]
    ds_read_b64_tr_b16 v[140:141], v54 offset:9376
    ds_read_b64_tr_b16 v[142:143], v54 offset:11680
    v_mfma_f32_16x16x32_bf16 v[188:191], v[84:87], v[68:71], v[188:191]
    ds_read_b64_tr_b16 v[144:145], v54 offset:9408
    ds_read_b64_tr_b16 v[146:147], v54 offset:11712
    v_mfma_f32_16x16x32_bf16 v[192:195], v[88:91], v[64:67], v[192:195]
    ds_read_b64_tr_b16 v[148:149], v54 offset:9440
    ds_read_b64_tr_b16 v[150:151], v54 offset:11744
    v_mfma_f32_16x16x32_bf16 v[196:199], v[88:91], v[68:71], v[196:199]
    ds_read_b64_tr_b16 v[152:153], v54 offset:9472
    ds_read_b64_tr_b16 v[154:155], v54 offset:11776
    v_mfma_f32_16x16x32_bf16 v[200:203], v[92:95], v[64:67], v[200:203]
    v_mfma_f32_16x16x32_bf16 v[204:207], v[92:95], v[68:71], v[204:207]
    v_mfma_f32_16x16x32_bf16 v[208:211], v[96:99], v[64:67], v[208:211]
    v_mfma_f32_16x16x32_bf16 v[212:215], v[96:99], v[68:71], v[212:215]
    v_mfma_f32_16x16x32_bf16 v[216:219], v[100:103], v[64:67], v[216:219]
    v_mfma_f32_16x16x32_bf16 v[220:223], v[100:103], v[68:71], v[220:223]
    v_mfma_f32_16x16x32_bf16 v[224:227], v[104:107], v[64:67], v[224:227]
    v_mfma_f32_16x16x32_bf16 v[228:231], v[104:107], v[68:71], v[228:231]
    s_waitcnt lgkmcnt(0)
    v_mfma_f32_16x16x32_bf16 v[160:163], v[120:123], v[112:115], v[160:163]
    v_mfma_f32_16x16x32_bf16 v[164:167], v[120:123], v[116:119], v[164:167]
    v_mfma_f32_16x16x32_bf16 v[168:171], v[124:127], v[112:115], v[168:171]
    v_mfma_f32_16x16x32_bf16 v[172:175], v[124:127], v[116:119], v[172:175]
    v_mfma_f32_16x16x32_bf16 v[176:179], v[128:131], v[112:115], v[176:179]
    v_mfma_f32_16x16x32_bf16 v[180:183], v[128:131], v[116:119], v[180:183]
    v_mfma_f32_16x16x32_bf16 v[184:187], v[132:135], v[112:115], v[184:187]
    v_mfma_f32_16x16x32_bf16 v[188:191], v[132:135], v[116:119], v[188:191]
    v_mfma_f32_16x16x32_bf16 v[192:195], v[136:139], v[112:115], v[192:195]
    v_mfma_f32_16x16x32_bf16 v[196:199], v[136:139], v[116:119], v[196:199]
    v_mfma_f32_16x16x32_bf16 v[200:203], v[140:143], v[112:115], v[200:203]
    v_mfma_f32_16x16x32_bf16 v[204:207], v[140:143], v[116:119], v[204:207]
    v_mfma_f32_16x16x32_bf16 v[208:211], v[144:147], v[112:115], v[208:211]
    v_mfma_f32_16x16x32_bf16 v[212:215], v[144:147], v[116:119], v[212:215]
    v_mfma_f32_16x16x32_bf16 v[216:219], v[148:151], v[112:115], v[216:219]
    v_mfma_f32_16x16x32_bf16 v[220:223], v[148:151], v[116:119], v[220:223]
    v_mfma_f32_16x16x32_bf16 v[224:227], v[152:155], v[112:115], v[224:227]
    v_mfma_f32_16x16x32_bf16 v[228:231], v[152:155], v[116:119], v[228:231]
    s_mov_b32 s20, s58
    s_mov_b32 s21, s59
    s_mov_b32 s22, 0x240000
    s_mov_b32 s23, 0x00020000
    s_add_u32 s40, s6, 0x2f00000
    s_addc_u32 s41, s7, 0
    s_mov_b32 s42, 0x2000
    s_mov_b32 s43, 0x00020000
    s_lshl_b32 s44, s26, 2
    s_add_u32 s44, s44, s27
    v_lshlrev_b32 v7, 4, v2
    v_lshlrev_b32 v14, 3, v2
    s_lshl_b32 s45, s44, 7
    v_mov_b32 v11, s45
    v_mov_b32 v12, 1
    s_mov_b32 s30, 0xffff0000
    s_mov_b32 s31, 0xbfb8aa3b
    s_lshl_b32 s46, s44, 4
    s_add_u32 s46, s46, s34
    s_mul_i32 s46, s46, 18432
    s_mul_i32 s45, s25, 73728
    s_add_u32 s48, s46, s45
    s_lshl_b32 s49, s25, 2
    s_and_b32 s45, s25, 1
    s_cmp_eq_u32 s45, 1
    s_cbranch_scc1 KB_EPI5
    s_add_u32 s47, s48, 0x0
    buffer_store_dwordx4 v[164:167], v7, s[16:19], s47 offen offset:1024 sc1
    s_add_u32 s47, s48, 0x0
    buffer_store_dwordx4 v[172:175], v7, s[16:19], s47 offen offset:3072 sc1
    s_add_u32 s47, s48, 0x1000
    buffer_store_dwordx4 v[180:183], v7, s[16:19], s47 offen offset:1024 sc1
    s_add_u32 s47, s48, 0x1000
    buffer_store_dwordx4 v[188:191], v7, s[16:19], s47 offen offset:3072 sc1
    s_add_u32 s47, s48, 0x2000
    buffer_store_dwordx4 v[196:199], v7, s[16:19], s47 offen offset:1024 sc1
    s_add_u32 s47, s48, 0x2000
    buffer_store_dwordx4 v[204:207], v7, s[16:19], s47 offen offset:3072 sc1
    s_add_u32 s47, s48, 0x3000
    buffer_store_dwordx4 v[212:215], v7, s[16:19], s47 offen offset:1024 sc1
    s_add_u32 s47, s48, 0x3000
    buffer_store_dwordx4 v[220:223], v7, s[16:19], s47 offen offset:3072 sc1
    s_add_u32 s47, s48, 0x4000
    buffer_store_dwordx4 v[228:231], v7, s[16:19], s47 offen offset:1024 sc1
    s_cmp_lg_u32 s34, 0
    s_cbranch_scc1 KB_W012
    s_mov_b64 exec, 1
KB_POLLA2:
    buffer_load_dwordx4 v[16:19], v11, s[40:43], 0 offen sc1
    s_waitcnt vmcnt(0)
    v_add_u32 v16, v16, v17
    s_nop 0
    v_readfirstlane_b32 s45, v16
    s_nop 3
    s_cmp_ge_u32 s45, 2
    s_cbranch_scc1 KB_POLLEDA2
    s_sleep 2
    s_branch KB_POLLA2
KB_POLLEDA2:
    s_mov_b64 exec, -1
KB_W012:
    s_barrier
    s_add_u32 s47, s46, 0x0
    buffer_load_dwordx2 v[100:101], v14, s[16:19], s47 offen offset:0 sc1
    s_add_u32 s47, s46, 0x0
    buffer_load_dwordx2 v[102:103], v14, s[16:19], s47 offen offset:2048 sc1
    s_add_u32 s47, s46, 0x1000
    buffer_load_dwordx2 v[104:105], v14, s[16:19], s47 offen offset:0 sc1
    s_add_u32 s47, s46, 0x1000
    buffer_load_dwordx2 v[106:107], v14, s[16:19], s47 offen offset:2048 sc1
    s_add_u32 s47, s46, 0x2000
    buffer_load_dwordx2 v[108:109], v14, s[16:19], s47 offen offset:0 sc1
    s_add_u32 s47, s46, 0x2000
    buffer_load_dwordx2 v[110:111], v14, s[16:19], s47 offen offset:2048 sc1
    s_add_u32 s47, s46, 0x3000
    buffer_load_dwordx2 v[112:113], v14, s[16:19], s47 offen offset:0 sc1
    s_add_u32 s47, s46, 0x3000
    buffer_load_dwordx2 v[114:115], v14, s[16:19], s47 offen offset:2048 sc1
    s_add_u32 s47, s46, 0x4000
    buffer_load_dwordx2 v[116:117], v14, s[16:19], s47 offen offset:0 sc1
    s_add_u32 s47, s46, 0x12000
    buffer_load_dwordx2 v[118:119], v14, s[16:19], s47 offen offset:0 sc1
    s_add_u32 s47, s46, 0x12000
    buffer_load_dwordx2 v[120:121], v14, s[16:19], s47 offen offset:2048 sc1
    s_add_u32 s47, s46, 0x13000
    buffer_load_dwordx2 v[122:123], v14, s[16:19], s47 offen offset:0 sc1
    s_add_u32 s47, s46, 0x13000
    buffer_load_dwordx2 v[124:125], v14, s[16:19], s47 offen offset:2048 sc1
    s_add_u32 s47, s46, 0x14000
    buffer_load_dwordx2 v[126:127], v14, s[16:19], s47 offen offset:0 sc1
    s_add_u32 s47, s46, 0x14000
    buffer_load_dwordx2 v[128:129], v14, s[16:19], s47 offen offset:2048 sc1
    s_add_u32 s47, s46, 0x15000
    buffer_load_dwordx2 v[130:131], v14, s[16:19], s47 offen offset:0 sc1
    s_add_u32 s47, s46, 0x15000
    buffer_load_dwordx2 v[132:133], v14, s[16:19], s47 offen offset:2048 sc1
    s_add_u32 s47, s46, 0x16000
    buffer_load_dwordx2 v[134:135], v14, s[16:19], s47 offen offset:0 sc1
    s_waitcnt vmcnt(18)
    s_barrier
    s_cmp_lg_u32 s34, 0
    s_cbranch_scc1 KB_WP2
    s_mov_b64 exec, 1
    buffer_store_dword v12, v11, s[40:43], s49 offen sc1
KB_POLLB2:
    buffer_load_dwordx4 v[16:19], v11, s[40:43], 0 offen sc1
    s_waitcnt vmcnt(0)
    v_mov_b32 v16, v19
    s_nop 0
    v_readfirstlane_b32 s45, v16
    s_nop 3
    s_cmp_ge_u32 s45, 1
    s_cbranch_scc1 KB_POLLEDB2
    s_sleep 2
    s_branch KB_POLLB2
KB_POLLEDB2:
    s_mov_b64 exec, -1
KB_WP2:
    s_barrier
    s_add_u32 s47, s46, 0x36000
    buffer_load_dwordx4 v[64:67], v7, s[16:19], s47 offen offset:0 sc1
    s_add_u32 s47, s46, 0x36000
    buffer_load_dwordx4 v[68:71], v7, s[16:19], s47 offen offset:2048 sc1
    s_add_u32 s47, s46, 0x37000
    buffer_load_dwordx4 v[72:75], v7, s[16:19], s47 offen offset:0 sc1
    s_add_u32 s47, s46, 0x37000
    buffer_load_dwordx4 v[76:79], v7, s[16:19], s47 offen offset:2048 sc1
    s_add_u32 s47, s46, 0x38000
    buffer_load_dwordx4 v[80:83], v7, s[16:19], s47 offen offset:0 sc1
    s_add_u32 s47, s46, 0x38000
    buffer_load_dwordx4 v[84:87], v7, s[16:19], s47 offen offset:2048 sc1
    s_add_u32 s47, s46, 0x39000
    buffer_load_dwordx4 v[88:91], v7, s[16:19], s47 offen offset:0 sc1
    s_add_u32 s47, s46, 0x39000
    buffer_load_dwordx4 v[92:95], v7, s[16:19], s47 offen offset:2048 sc1
    s_add_u32 s47, s46, 0x3a000
    buffer_load_dwordx4 v[96:99], v7, s[16:19], s47 offen offset:0 sc1
    s_waitcnt vmcnt(8)
    v_lshlrev_b32 v136, 16, v100
    v_and_b32 v137, s30, v100
    v_lshlrev_b32 v138, 16, v118
    v_and_b32 v139, s30, v118
    v_sub_f32 v136, v136, v138
    v_sub_f32 v137, v137, v139
    v_cvt_pk_bf16_f32 v144, v136, v137
    v_lshlrev_b32 v136, 16, v144
    v_and_b32 v137, s30, v144
    v_add_f32 v160, v160, v64
    v_add_f32 v161, v161, v65
    v_cvt_pk_bf16_f32 v144, v160, v161
    v_lshlrev_b32 v160, 16, v144
    v_and_b32 v161, s30, v144
    v_lshlrev_b32 v146, 16, v250
    v_and_b32 v147, s30, v250
    v_add_f32 v160, v160, v146
    v_add_f32 v161, v161, v147
    v_cvt_pk_bf16_f32 v144, v160, v161
    v_lshlrev_b32 v160, 16, v144
    v_and_b32 v161, s30, v144
    v_mul_f32 v146, s31, v160
    v_mul_f32 v147, s31, v161
    v_exp_f32 v146, v146
    v_exp_f32 v147, v147
    s_nop 0
    v_add_f32 v146, 1.0, v146
    v_add_f32 v147, 1.0, v147
    v_rcp_f32 v146, v146
    v_rcp_f32 v147, v147
    s_nop 0
    v_mul_f32 v160, v160, v146
    v_mul_f32 v161, v161, v147
    v_cvt_pk_bf16_f32 v144, v160, v161
    v_lshlrev_b32 v160, 16, v144
    v_and_b32 v161, s30, v144
    v_mul_f32 v136, v136, v160
    v_mul_f32 v137, v137, v161
    v_cvt_pk_bf16_f32 v144, v136, v137
    v_lshlrev_b32 v136, 16, v144
    v_and_b32 v137, s30, v144
    v_lshlrev_b32 v146, 16, v232
    v_and_b32 v147, s30, v232
    v_add_f32 v146, v146, v136
    v_add_f32 v147, v147, v137
    v_cvt_pk_bf16_f32 v64, v146, v147
    v_lshlrev_b32 v136, 16, v101
    v_and_b32 v137, s30, v101
    v_lshlrev_b32 v138, 16, v119
    v_and_b32 v139, s30, v119
    v_sub_f32 v136, v136, v138
    v_sub_f32 v137, v137, v139
    v_cvt_pk_bf16_f32 v144, v136, v137
    v_lshlrev_b32 v136, 16, v144
    v_and_b32 v137, s30, v144
    v_add_f32 v162, v162, v66
    v_add_f32 v163, v163, v67
    v_cvt_pk_bf16_f32 v144, v162, v163
    v_lshlrev_b32 v162, 16, v144
    v_and_b32 v163, s30, v144
    v_lshlrev_b32 v146, 16, v251
    v_and_b32 v147, s30, v251
    v_add_f32 v162, v162, v146
    v_add_f32 v163, v163, v147
    v_cvt_pk_bf16_f32 v144, v162, v163
    v_lshlrev_b32 v162, 16, v144
    v_and_b32 v163, s30, v144
    v_mul_f32 v146, s31, v162
    v_mul_f32 v147, s31, v163
    v_exp_f32 v146, v146
    v_exp_f32 v147, v147
    s_nop 0
    v_add_f32 v146, 1.0, v146
    v_add_f32 v147, 1.0, v147
    v_rcp_f32 v146, v146
    v_rcp_f32 v147, v147
    s_nop 0
    v_mul_f32 v162, v162, v146
    v_mul_f32 v163, v163, v147
    v_cvt_pk_bf16_f32 v144, v162, v163
    v_lshlrev_b32 v162, 16, v144
    v_and_b32 v163, s30, v144
    v_mul_f32 v136, v136, v162
    v_mul_f32 v137, v137, v163
    v_cvt_pk_bf16_f32 v144, v136, v137
    v_lshlrev_b32 v136, 16, v144
    v_and_b32 v137, s30, v144
    v_lshlrev_b32 v146, 16, v233
    v_and_b32 v147, s30, v233
    v_add_f32 v146, v146, v136
    v_add_f32 v147, v147, v137
    v_cvt_pk_bf16_f32 v65, v146, v147
    buffer_store_dwordx2 v[64:65], v8, s[20:23], 0 offen offset:0
    s_waitcnt vmcnt(8)
    v_lshlrev_b32 v136, 16, v102
    v_and_b32 v137, s30, v102
    v_lshlrev_b32 v138, 16, v120
    v_and_b32 v139, s30, v120
    v_sub_f32 v136, v136, v138
    v_sub_f32 v137, v137, v139
    v_cvt_pk_bf16_f32 v144, v136, v137
    v_lshlrev_b32 v136, 16, v144
    v_and_b32 v137, s30, v144
    v_add_f32 v168, v168, v68
    v_add_f32 v169, v169, v69
    v_cvt_pk_bf16_f32 v144, v168, v169
    v_lshlrev_b32 v168, 16, v144
    v_and_b32 v169, s30, v144
    v_lshlrev_b32 v146, 16, v252
    v_and_b32 v147, s30, v252
    v_add_f32 v168, v168, v146
    v_add_f32 v169, v169, v147
    v_cvt_pk_bf16_f32 v144, v168, v169
    v_lshlrev_b32 v168, 16, v144
    v_and_b32 v169, s30, v144
    v_mul_f32 v146, s31, v168
    v_mul_f32 v147, s31, v169
    v_exp_f32 v146, v146
    v_exp_f32 v147, v147
    s_nop 0
    v_add_f32 v146, 1.0, v146
    v_add_f32 v147, 1.0, v147
    v_rcp_f32 v146, v146
    v_rcp_f32 v147, v147
    s_nop 0
    v_mul_f32 v168, v168, v146
    v_mul_f32 v169, v169, v147
    v_cvt_pk_bf16_f32 v144, v168, v169
    v_lshlrev_b32 v168, 16, v144
    v_and_b32 v169, s30, v144
    v_mul_f32 v136, v136, v168
    v_mul_f32 v137, v137, v169
    v_cvt_pk_bf16_f32 v144, v136, v137
    v_lshlrev_b32 v136, 16, v144
    v_and_b32 v137, s30, v144
    v_lshlrev_b32 v146, 16, v234
    v_and_b32 v147, s30, v234
    v_add_f32 v146, v146, v136
    v_add_f32 v147, v147, v137
    v_cvt_pk_bf16_f32 v68, v146, v147
    v_lshlrev_b32 v136, 16, v103
    v_and_b32 v137, s30, v103
    v_lshlrev_b32 v138, 16, v121
    v_and_b32 v139, s30, v121
    v_sub_f32 v136, v136, v138
    v_sub_f32 v137, v137, v139
    v_cvt_pk_bf16_f32 v144, v136, v137
    v_lshlrev_b32 v136, 16, v144
    v_and_b32 v137, s30, v144
    v_add_f32 v170, v170, v70
    v_add_f32 v171, v171, v71
    v_cvt_pk_bf16_f32 v144, v170, v171
    v_lshlrev_b32 v170, 16, v144
    v_and_b32 v171, s30, v144
    v_lshlrev_b32 v146, 16, v253
    v_and_b32 v147, s30, v253
    v_add_f32 v170, v170, v146
    v_add_f32 v171, v171, v147
    v_cvt_pk_bf16_f32 v144, v170, v171
    v_lshlrev_b32 v170, 16, v144
    v_and_b32 v171, s30, v144
    v_mul_f32 v146, s31, v170
    v_mul_f32 v147, s31, v171
    v_exp_f32 v146, v146
    v_exp_f32 v147, v147
    s_nop 0
    v_add_f32 v146, 1.0, v146
    v_add_f32 v147, 1.0, v147
    v_rcp_f32 v146, v146
    v_rcp_f32 v147, v147
    s_nop 0
    v_mul_f32 v170, v170, v146
    v_mul_f32 v171, v171, v147
    v_cvt_pk_bf16_f32 v144, v170, v171
    v_lshlrev_b32 v170, 16, v144
    v_and_b32 v171, s30, v144
    v_mul_f32 v136, v136, v170
    v_mul_f32 v137, v137, v171
    v_cvt_pk_bf16_f32 v144, v136, v137
    v_lshlrev_b32 v136, 16, v144
    v_and_b32 v137, s30, v144
    v_lshlrev_b32 v146, 16, v235
    v_and_b32 v147, s30, v235
    v_add_f32 v146, v146, v136
    v_add_f32 v147, v147, v137
    v_cvt_pk_bf16_f32 v69, v146, v147
    buffer_store_dwordx2 v[68:69], v8, s[20:23], 0 offen offset:32
    s_waitcnt vmcnt(8)
    v_lshlrev_b32 v136, 16, v104
    v_and_b32 v137, s30, v104
    v_lshlrev_b32 v138, 16, v122
    v_and_b32 v139, s30, v122
    v_sub_f32 v136, v136, v138
    v_sub_f32 v137, v137, v139
    v_cvt_pk_bf16_f32 v144, v136, v137
    v_lshlrev_b32 v136, 16, v144
    v_and_b32 v137, s30, v144
    v_add_f32 v176, v176, v72
    v_add_f32 v177, v177, v73
    v_cvt_pk_bf16_f32 v144, v176, v177
    v_lshlrev_b32 v176, 16, v144
    v_and_b32 v177, s30, v144
    v_lshlrev_b32 v146, 16, v254
    v_and_b32 v147, s30, v254
    v_add_f32 v176, v176, v146
    v_add_f32 v177, v177, v147
    v_cvt_pk_bf16_f32 v144, v176, v177
    v_lshlrev_b32 v176, 16, v144
    v_and_b32 v177, s30, v144
    v_mul_f32 v146, s31, v176
    v_mul_f32 v147, s31, v177
    v_exp_f32 v146, v146
    v_exp_f32 v147, v147
    s_nop 0
    v_add_f32 v146, 1.0, v146
    v_add_f32 v147, 1.0, v147
    v_rcp_f32 v146, v146
    v_rcp_f32 v147, v147
    s_nop 0
    v_mul_f32 v176, v176, v146
    v_mul_f32 v177, v177, v147
    v_cvt_pk_bf16_f32 v144, v176, v177
    v_lshlrev_b32 v176, 16, v144
    v_and_b32 v177, s30, v144
    v_mul_f32 v136, v136, v176
    v_mul_f32 v137, v137, v177
    v_cvt_pk_bf16_f32 v144, v136, v137
    v_lshlrev_b32 v136, 16, v144
    v_and_b32 v137, s30, v144
    v_lshlrev_b32 v146, 16, v236
    v_and_b32 v147, s30, v236
    v_add_f32 v146, v146, v136
    v_add_f32 v147, v147, v137
    v_cvt_pk_bf16_f32 v72, v146, v147
    v_lshlrev_b32 v136, 16, v105
    v_and_b32 v137, s30, v105
    v_lshlrev_b32 v138, 16, v123
    v_and_b32 v139, s30, v123
    v_sub_f32 v136, v136, v138
    v_sub_f32 v137, v137, v139
    v_cvt_pk_bf16_f32 v144, v136, v137
    v_lshlrev_b32 v136, 16, v144
    v_and_b32 v137, s30, v144
    v_add_f32 v178, v178, v74
    v_add_f32 v179, v179, v75
    v_cvt_pk_bf16_f32 v144, v178, v179
    v_lshlrev_b32 v178, 16, v144
    v_and_b32 v179, s30, v144
    v_lshlrev_b32 v146, 16, v255
    v_and_b32 v147, s30, v255
    v_add_f32 v178, v178, v146
    v_add_f32 v179, v179, v147
    v_cvt_pk_bf16_f32 v144, v178, v179
    v_lshlrev_b32 v178, 16, v144
    v_and_b32 v179, s30, v144
    v_mul_f32 v146, s31, v178
    v_mul_f32 v147, s31, v179
    v_exp_f32 v146, v146
    v_exp_f32 v147, v147
    s_nop 0
    v_add_f32 v146, 1.0, v146
    v_add_f32 v147, 1.0, v147
    v_rcp_f32 v146, v146
    v_rcp_f32 v147, v147
    s_nop 0
    v_mul_f32 v178, v178, v146
    v_mul_f32 v179, v179, v147
    v_cvt_pk_bf16_f32 v144, v178, v179
    v_lshlrev_b32 v178, 16, v144
    v_and_b32 v179, s30, v144
    v_mul_f32 v136, v136, v178
    v_mul_f32 v137, v137, v179
    v_cvt_pk_bf16_f32 v144, v136, v137
    v_lshlrev_b32 v136, 16, v144
    v_and_b32 v137, s30, v144
    v_lshlrev_b32 v146, 16, v237
    v_and_b32 v147, s30, v237
    v_add_f32 v146, v146, v136
    v_add_f32 v147, v147, v137
    v_cvt_pk_bf16_f32 v73, v146, v147
    buffer_store_dwordx2 v[72:73], v8, s[20:23], 0 offen offset:64
    s_waitcnt vmcnt(8)
    v_lshlrev_b32 v136, 16, v106
    v_and_b32 v137, s30, v106
    v_lshlrev_b32 v138, 16, v124
    v_and_b32 v139, s30, v124
    v_sub_f32 v136, v136, v138
    v_sub_f32 v137, v137, v139
    v_cvt_pk_bf16_f32 v144, v136, v137
    v_lshlrev_b32 v136, 16, v144
    v_and_b32 v137, s30, v144
    v_add_f32 v184, v184, v76
    v_add_f32 v185, v185, v77
    v_cvt_pk_bf16_f32 v144, v184, v185
    v_lshlrev_b32 v184, 16, v144
    v_and_b32 v185, s30, v144
    v_lshlrev_b32 v146, 16, v56
    v_and_b32 v147, s30, v56
    v_add_f32 v184, v184, v146
    v_add_f32 v185, v185, v147
    v_cvt_pk_bf16_f32 v144, v184, v185
    v_lshlrev_b32 v184, 16, v144
    v_and_b32 v185, s30, v144
    v_mul_f32 v146, s31, v184
    v_mul_f32 v147, s31, v185
    v_exp_f32 v146, v146
    v_exp_f32 v147, v147
    s_nop 0
    v_add_f32 v146, 1.0, v146
    v_add_f32 v147, 1.0, v147
    v_rcp_f32 v146, v146
    v_rcp_f32 v147, v147
    s_nop 0
    v_mul_f32 v184, v184, v146
    v_mul_f32 v185, v185, v147
    v_cvt_pk_bf16_f32 v144, v184, v185
    v_lshlrev_b32 v184, 16, v144
    v_and_b32 v185, s30, v144
    v_mul_f32 v136, v136, v184
    v_mul_f32 v137, v137, v185
    v_cvt_pk_bf16_f32 v144, v136, v137
    v_lshlrev_b32 v136, 16, v144
    v_and_b32 v137, s30, v144
    v_lshlrev_b32 v146, 16, v238
    v_and_b32 v147, s30, v238
    v_add_f32 v146, v146, v136
    v_add_f32 v147, v147, v137
    v_cvt_pk_bf16_f32 v76, v146, v147
    v_lshlrev_b32 v136, 16, v107
    v_and_b32 v137, s30, v107
    v_lshlrev_b32 v138, 16, v125
    v_and_b32 v139, s30, v125
    v_sub_f32 v136, v136, v138
    v_sub_f32 v137, v137, v139
    v_cvt_pk_bf16_f32 v144, v136, v137
    v_lshlrev_b32 v136, 16, v144
    v_and_b32 v137, s30, v144
    v_add_f32 v186, v186, v78
    v_add_f32 v187, v187, v79
    v_cvt_pk_bf16_f32 v144, v186, v187
    v_lshlrev_b32 v186, 16, v144
    v_and_b32 v187, s30, v144
    v_lshlrev_b32 v146, 16, v57
    v_and_b32 v147, s30, v57
    v_add_f32 v186, v186, v146
    v_add_f32 v187, v187, v147
    v_cvt_pk_bf16_f32 v144, v186, v187
    v_lshlrev_b32 v186, 16, v144
    v_and_b32 v187, s30, v144
    v_mul_f32 v146, s31, v186
    v_mul_f32 v147, s31, v187
    v_exp_f32 v146, v146
    v_exp_f32 v147, v147
    s_nop 0
    v_add_f32 v146, 1.0, v146
    v_add_f32 v147, 1.0, v147
    v_rcp_f32 v146, v146
    v_rcp_f32 v147, v147
    s_nop 0
    v_mul_f32 v186, v186, v146
    v_mul_f32 v187, v187, v147
    v_cvt_pk_bf16_f32 v144, v186, v187
    v_lshlrev_b32 v186, 16, v144
    v_and_b32 v187, s30, v144
    v_mul_f32 v136, v136, v186
    v_mul_f32 v137, v137, v187
    v_cvt_pk_bf16_f32 v144, v136, v137
    v_lshlrev_b32 v136, 16, v144
    v_and_b32 v137, s30, v144
    v_lshlrev_b32 v146, 16, v239
    v_and_b32 v147, s30, v239
    v_add_f32 v146, v146, v136
    v_add_f32 v147, v147, v137
    v_cvt_pk_bf16_f32 v77, v146, v147
    buffer_store_dwordx2 v[76:77], v8, s[20:23], 0 offen offset:96
    s_waitcnt vmcnt(8)
    v_lshlrev_b32 v136, 16, v108
    v_and_b32 v137, s30, v108
    v_lshlrev_b32 v138, 16, v126
    v_and_b32 v139, s30, v126
    v_sub_f32 v136, v136, v138
    v_sub_f32 v137, v137, v139
    v_cvt_pk_bf16_f32 v144, v136, v137
    v_lshlrev_b32 v136, 16, v144
    v_and_b32 v137, s30, v144
    v_add_f32 v192, v192, v80
    v_add_f32 v193, v193, v81
    v_cvt_pk_bf16_f32 v144, v192, v193
    v_lshlrev_b32 v192, 16, v144
    v_and_b32 v193, s30, v144
    v_lshlrev_b32 v146, 16, v58
    v_and_b32 v147, s30, v58
    v_add_f32 v192, v192, v146
    v_add_f32 v193, v193, v147
    v_cvt_pk_bf16_f32 v144, v192, v193
    v_lshlrev_b32 v192, 16, v144
    v_and_b32 v193, s30, v144
    v_mul_f32 v146, s31, v192
    v_mul_f32 v147, s31, v193
    v_exp_f32 v146, v146
    v_exp_f32 v147, v147
    s_nop 0
    v_add_f32 v146, 1.0, v146
    v_add_f32 v147, 1.0, v147
    v_rcp_f32 v146, v146
    v_rcp_f32 v147, v147
    s_nop 0
    v_mul_f32 v192, v192, v146
    v_mul_f32 v193, v193, v147
    v_cvt_pk_bf16_f32 v144, v192, v193
    v_lshlrev_b32 v192, 16, v144
    v_and_b32 v193, s30, v144
    v_mul_f32 v136, v136, v192
    v_mul_f32 v137, v137, v193
    v_cvt_pk_bf16_f32 v144, v136, v137
    v_lshlrev_b32 v136, 16, v144
    v_and_b32 v137, s30, v144
    v_lshlrev_b32 v146, 16, v240
    v_and_b32 v147, s30, v240
    v_add_f32 v146, v146, v136
    v_add_f32 v147, v147, v137
    v_cvt_pk_bf16_f32 v80, v146, v147
    v_lshlrev_b32 v136, 16, v109
    v_and_b32 v137, s30, v109
    v_lshlrev_b32 v138, 16, v127
    v_and_b32 v139, s30, v127
    v_sub_f32 v136, v136, v138
    v_sub_f32 v137, v137, v139
    v_cvt_pk_bf16_f32 v144, v136, v137
    v_lshlrev_b32 v136, 16, v144
    v_and_b32 v137, s30, v144
    v_add_f32 v194, v194, v82
    v_add_f32 v195, v195, v83
    v_cvt_pk_bf16_f32 v144, v194, v195
    v_lshlrev_b32 v194, 16, v144
    v_and_b32 v195, s30, v144
    v_lshlrev_b32 v146, 16, v59
    v_and_b32 v147, s30, v59
    v_add_f32 v194, v194, v146
    v_add_f32 v195, v195, v147
    v_cvt_pk_bf16_f32 v144, v194, v195
    v_lshlrev_b32 v194, 16, v144
    v_and_b32 v195, s30, v144
    v_mul_f32 v146, s31, v194
    v_mul_f32 v147, s31, v195
    v_exp_f32 v146, v146
    v_exp_f32 v147, v147
    s_nop 0
    v_add_f32 v146, 1.0, v146
    v_add_f32 v147, 1.0, v147
    v_rcp_f32 v146, v146
    v_rcp_f32 v147, v147
    s_nop 0
    v_mul_f32 v194, v194, v146
    v_mul_f32 v195, v195, v147
    v_cvt_pk_bf16_f32 v144, v194, v195
    v_lshlrev_b32 v194, 16, v144
    v_and_b32 v195, s30, v144
    v_mul_f32 v136, v136, v194
    v_mul_f32 v137, v137, v195
    v_cvt_pk_bf16_f32 v144, v136, v137
    v_lshlrev_b32 v136, 16, v144
    v_and_b32 v137, s30, v144
    v_lshlrev_b32 v146, 16, v241
    v_and_b32 v147, s30, v241
    v_add_f32 v146, v146, v136
    v_add_f32 v147, v147, v137
    v_cvt_pk_bf16_f32 v81, v146, v147
    buffer_store_dwordx2 v[80:81], v8, s[20:23], 0 offen offset:128
    s_waitcnt vmcnt(8)
    v_lshlrev_b32 v136, 16, v110
    v_and_b32 v137, s30, v110
    v_lshlrev_b32 v138, 16, v128
    v_and_b32 v139, s30, v128
    v_sub_f32 v136, v136, v138
    v_sub_f32 v137, v137, v139
    v_cvt_pk_bf16_f32 v144, v136, v137
    v_lshlrev_b32 v136, 16, v144
    v_and_b32 v137, s30, v144
    v_add_f32 v200, v200, v84
    v_add_f32 v201, v201, v85
    v_cvt_pk_bf16_f32 v144, v200, v201
    v_lshlrev_b32 v200, 16, v144
    v_and_b32 v201, s30, v144
    v_lshlrev_b32 v146, 16, v60
    v_and_b32 v147, s30, v60
    v_add_f32 v200, v200, v146
    v_add_f32 v201, v201, v147
    v_cvt_pk_bf16_f32 v144, v200, v201
    v_lshlrev_b32 v200, 16, v144
    v_and_b32 v201, s30, v144
    v_mul_f32 v146, s31, v200
    v_mul_f32 v147, s31, v201
    v_exp_f32 v146, v146
    v_exp_f32 v147, v147
    s_nop 0
    v_add_f32 v146, 1.0, v146
    v_add_f32 v147, 1.0, v147
    v_rcp_f32 v146, v146
    v_rcp_f32 v147, v147
    s_nop 0
    v_mul_f32 v200, v200, v146
    v_mul_f32 v201, v201, v147
    v_cvt_pk_bf16_f32 v144, v200, v201
    v_lshlrev_b32 v200, 16, v144
    v_and_b32 v201, s30, v144
    v_mul_f32 v136, v136, v200
    v_mul_f32 v137, v137, v201
    v_cvt_pk_bf16_f32 v144, v136, v137
    v_lshlrev_b32 v136, 16, v144
    v_and_b32 v137, s30, v144
    v_lshlrev_b32 v146, 16, v242
    v_and_b32 v147, s30, v242
    v_add_f32 v146, v146, v136
    v_add_f32 v147, v147, v137
    v_cvt_pk_bf16_f32 v84, v146, v147
    v_lshlrev_b32 v136, 16, v111
    v_and_b32 v137, s30, v111
    v_lshlrev_b32 v138, 16, v129
    v_and_b32 v139, s30, v129
    v_sub_f32 v136, v136, v138
    v_sub_f32 v137, v137, v139
    v_cvt_pk_bf16_f32 v144, v136, v137
    v_lshlrev_b32 v136, 16, v144
    v_and_b32 v137, s30, v144
    v_add_f32 v202, v202, v86
    v_add_f32 v203, v203, v87
    v_cvt_pk_bf16_f32 v144, v202, v203
    v_lshlrev_b32 v202, 16, v144
    v_and_b32 v203, s30, v144
    v_lshlrev_b32 v146, 16, v61
    v_and_b32 v147, s30, v61
    v_add_f32 v202, v202, v146
    v_add_f32 v203, v203, v147
    v_cvt_pk_bf16_f32 v144, v202, v203
    v_lshlrev_b32 v202, 16, v144
    v_and_b32 v203, s30, v144
    v_mul_f32 v146, s31, v202
    v_mul_f32 v147, s31, v203
    v_exp_f32 v146, v146
    v_exp_f32 v147, v147
    s_nop 0
    v_add_f32 v146, 1.0, v146
    v_add_f32 v147, 1.0, v147
    v_rcp_f32 v146, v146
    v_rcp_f32 v147, v147
    s_nop 0
    v_mul_f32 v202, v202, v146
    v_mul_f32 v203, v203, v147
    v_cvt_pk_bf16_f32 v144, v202, v203
    v_lshlrev_b32 v202, 16, v144
    v_and_b32 v203, s30, v144
    v_mul_f32 v136, v136, v202
    v_mul_f32 v137, v137, v203
    v_cvt_pk_bf16_f32 v144, v136, v137
    v_lshlrev_b32 v136, 16, v144
    v_and_b32 v137, s30, v144
    v_lshlrev_b32 v146, 16, v243
    v_and_b32 v147, s30, v243
    v_add_f32 v146, v146, v136
    v_add_f32 v147, v147, v137
    v_cvt_pk_bf16_f32 v85, v146, v147
    buffer_store_dwordx2 v[84:85], v8, s[20:23], 0 offen offset:160
    s_waitcnt vmcnt(8)
    v_lshlrev_b32 v136, 16, v112
    v_and_b32 v137, s30, v112
    v_lshlrev_b32 v138, 16, v130
    v_and_b32 v139, s30, v130
    v_sub_f32 v136, v136, v138
    v_sub_f32 v137, v137, v139
    v_cvt_pk_bf16_f32 v144, v136, v137
    v_lshlrev_b32 v136, 16, v144
    v_and_b32 v137, s30, v144
    v_add_f32 v208, v208, v88
    v_add_f32 v209, v209, v89
    v_cvt_pk_bf16_f32 v144, v208, v209
    v_lshlrev_b32 v208, 16, v144
    v_and_b32 v209, s30, v144
    v_lshlrev_b32 v146, 16, v62
    v_and_b32 v147, s30, v62
    v_add_f32 v208, v208, v146
    v_add_f32 v209, v209, v147
    v_cvt_pk_bf16_f32 v144, v208, v209
    v_lshlrev_b32 v208, 16, v144
    v_and_b32 v209, s30, v144
    v_mul_f32 v146, s31, v208
    v_mul_f32 v147, s31, v209
    v_exp_f32 v146, v146
    v_exp_f32 v147, v147
    s_nop 0
    v_add_f32 v146, 1.0, v146
    v_add_f32 v147, 1.0, v147
    v_rcp_f32 v146, v146
    v_rcp_f32 v147, v147
    s_nop 0
    v_mul_f32 v208, v208, v146
    v_mul_f32 v209, v209, v147
    v_cvt_pk_bf16_f32 v144, v208, v209
    v_lshlrev_b32 v208, 16, v144
    v_and_b32 v209, s30, v144
    v_mul_f32 v136, v136, v208
    v_mul_f32 v137, v137, v209
    v_cvt_pk_bf16_f32 v144, v136, v137
    v_lshlrev_b32 v136, 16, v144
    v_and_b32 v137, s30, v144
    v_lshlrev_b32 v146, 16, v244
    v_and_b32 v147, s30, v244
    v_add_f32 v146, v146, v136
    v_add_f32 v147, v147, v137
    v_cvt_pk_bf16_f32 v88, v146, v147
    v_lshlrev_b32 v136, 16, v113
    v_and_b32 v137, s30, v113
    v_lshlrev_b32 v138, 16, v131
    v_and_b32 v139, s30, v131
    v_sub_f32 v136, v136, v138
    v_sub_f32 v137, v137, v139
    v_cvt_pk_bf16_f32 v144, v136, v137
    v_lshlrev_b32 v136, 16, v144
    v_and_b32 v137, s30, v144
    v_add_f32 v210, v210, v90
    v_add_f32 v211, v211, v91
    v_cvt_pk_bf16_f32 v144, v210, v211
    v_lshlrev_b32 v210, 16, v144
    v_and_b32 v211, s30, v144
    v_lshlrev_b32 v146, 16, v63
    v_and_b32 v147, s30, v63
    v_add_f32 v210, v210, v146
    v_add_f32 v211, v211, v147
    v_cvt_pk_bf16_f32 v144, v210, v211
    v_lshlrev_b32 v210, 16, v144
    v_and_b32 v211, s30, v144
    v_mul_f32 v146, s31, v210
    v_mul_f32 v147, s31, v211
    v_exp_f32 v146, v146
    v_exp_f32 v147, v147
    s_nop 0
    v_add_f32 v146, 1.0, v146
    v_add_f32 v147, 1.0, v147
    v_rcp_f32 v146, v146
    v_rcp_f32 v147, v147
    s_nop 0
    v_mul_f32 v210, v210, v146
    v_mul_f32 v211, v211, v147
    v_cvt_pk_bf16_f32 v144, v210, v211
    v_lshlrev_b32 v210, 16, v144
    v_and_b32 v211, s30, v144
    v_mul_f32 v136, v136, v210
    v_mul_f32 v137, v137, v211
    v_cvt_pk_bf16_f32 v144, v136, v137
    v_lshlrev_b32 v136, 16, v144
    v_and_b32 v137, s30, v144
    v_lshlrev_b32 v146, 16, v245
    v_and_b32 v147, s30, v245
    v_add_f32 v146, v146, v136
    v_add_f32 v147, v147, v137
    v_cvt_pk_bf16_f32 v89, v146, v147
    buffer_store_dwordx2 v[88:89], v8, s[20:23], 0 offen offset:192
    s_waitcnt vmcnt(8)
    v_lshlrev_b32 v136, 16, v114
    v_and_b32 v137, s30, v114
    v_lshlrev_b32 v138, 16, v132
    v_and_b32 v139, s30, v132
    v_sub_f32 v136, v136, v138
    v_sub_f32 v137, v137, v139
    v_cvt_pk_bf16_f32 v144, v136, v137
    v_lshlrev_b32 v136, 16, v144
    v_and_b32 v137, s30, v144
    v_add_f32 v216, v216, v92
    v_add_f32 v217, v217, v93
    v_cvt_pk_bf16_f32 v144, v216, v217
    v_lshlrev_b32 v216, 16, v144
    v_and_b32 v217, s30, v144
    v_lshlrev_b32 v146, 16, v30
    v_and_b32 v147, s30, v30
    v_add_f32 v216, v216, v146
    v_add_f32 v217, v217, v147
    v_cvt_pk_bf16_f32 v144, v216, v217
    v_lshlrev_b32 v216, 16, v144
    v_and_b32 v217, s30, v144
    v_mul_f32 v146, s31, v216
    v_mul_f32 v147, s31, v217
    v_exp_f32 v146, v146
    v_exp_f32 v147, v147
    s_nop 0
    v_add_f32 v146, 1.0, v146
    v_add_f32 v147, 1.0, v147
    v_rcp_f32 v146, v146
    v_rcp_f32 v147, v147
    s_nop 0
    v_mul_f32 v216, v216, v146
    v_mul_f32 v217, v217, v147
    v_cvt_pk_bf16_f32 v144, v216, v217
    v_lshlrev_b32 v216, 16, v144
    v_and_b32 v217, s30, v144
    v_mul_f32 v136, v136, v216
    v_mul_f32 v137, v137, v217
    v_cvt_pk_bf16_f32 v144, v136, v137
    v_lshlrev_b32 v136, 16, v144
    v_and_b32 v137, s30, v144
    v_lshlrev_b32 v146, 16, v246
    v_and_b32 v147, s30, v246
    v_add_f32 v146, v146, v136
    v_add_f32 v147, v147, v137
    v_cvt_pk_bf16_f32 v92, v146, v147
    v_lshlrev_b32 v136, 16, v115
    v_and_b32 v137, s30, v115
    v_lshlrev_b32 v138, 16, v133
    v_and_b32 v139, s30, v133
    v_sub_f32 v136, v136, v138
    v_sub_f32 v137, v137, v139
    v_cvt_pk_bf16_f32 v144, v136, v137
    v_lshlrev_b32 v136, 16, v144
    v_and_b32 v137, s30, v144
    v_add_f32 v218, v218, v94
    v_add_f32 v219, v219, v95
    v_cvt_pk_bf16_f32 v144, v218, v219
    v_lshlrev_b32 v218, 16, v144
    v_and_b32 v219, s30, v144
    v_lshlrev_b32 v146, 16, v31
    v_and_b32 v147, s30, v31
    v_add_f32 v218, v218, v146
    v_add_f32 v219, v219, v147
    v_cvt_pk_bf16_f32 v144, v218, v219
    v_lshlrev_b32 v218, 16, v144
    v_and_b32 v219, s30, v144
    v_mul_f32 v146, s31, v218
    v_mul_f32 v147, s31, v219
    v_exp_f32 v146, v146
    v_exp_f32 v147, v147
    s_nop 0
    v_add_f32 v146, 1.0, v146
    v_add_f32 v147, 1.0, v147
    v_rcp_f32 v146, v146
    v_rcp_f32 v147, v147
    s_nop 0
    v_mul_f32 v218, v218, v146
    v_mul_f32 v219, v219, v147
    v_cvt_pk_bf16_f32 v144, v218, v219
    v_lshlrev_b32 v218, 16, v144
    v_and_b32 v219, s30, v144
    v_mul_f32 v136, v136, v218
    v_mul_f32 v137, v137, v219
    v_cvt_pk_bf16_f32 v144, v136, v137
    v_lshlrev_b32 v136, 16, v144
    v_and_b32 v137, s30, v144
    v_lshlrev_b32 v146, 16, v247
    v_and_b32 v147, s30, v247
    v_add_f32 v146, v146, v136
    v_add_f32 v147, v147, v137
    v_cvt_pk_bf16_f32 v93, v146, v147
    buffer_store_dwordx2 v[92:93], v8, s[20:23], 0 offen offset:224
    s_waitcnt vmcnt(8)
    v_lshlrev_b32 v136, 16, v116
    v_and_b32 v137, s30, v116
    v_lshlrev_b32 v138, 16, v134
    v_and_b32 v139, s30, v134
    v_sub_f32 v136, v136, v138
    v_sub_f32 v137, v137, v139
    v_cvt_pk_bf16_f32 v144, v136, v137
    v_lshlrev_b32 v136, 16, v144
    v_and_b32 v137, s30, v144
    v_add_f32 v224, v224, v96
    v_add_f32 v225, v225, v97
    v_cvt_pk_bf16_f32 v144, v224, v225
    v_lshlrev_b32 v224, 16, v144
    v_and_b32 v225, s30, v144
    v_lshlrev_b32 v146, 16, v32
    v_and_b32 v147, s30, v32
    v_add_f32 v224, v224, v146
    v_add_f32 v225, v225, v147
    v_cvt_pk_bf16_f32 v144, v224, v225
    v_lshlrev_b32 v224, 16, v144
    v_and_b32 v225, s30, v144
    v_mul_f32 v146, s31, v224
    v_mul_f32 v147, s31, v225
    v_exp_f32 v146, v146
    v_exp_f32 v147, v147
    s_nop 0
    v_add_f32 v146, 1.0, v146
    v_add_f32 v147, 1.0, v147
    v_rcp_f32 v146, v146
    v_rcp_f32 v147, v147
    s_nop 0
    v_mul_f32 v224, v224, v146
    v_mul_f32 v225, v225, v147
    v_cvt_pk_bf16_f32 v144, v224, v225
    v_lshlrev_b32 v224, 16, v144
    v_and_b32 v225, s30, v144
    v_mul_f32 v136, v136, v224
    v_mul_f32 v137, v137, v225
    v_cvt_pk_bf16_f32 v144, v136, v137
    v_lshlrev_b32 v136, 16, v144
    v_and_b32 v137, s30, v144
    v_lshlrev_b32 v146, 16, v248
    v_and_b32 v147, s30, v248
    v_add_f32 v146, v146, v136
    v_add_f32 v147, v147, v137
    v_cvt_pk_bf16_f32 v96, v146, v147
    v_lshlrev_b32 v136, 16, v117
    v_and_b32 v137, s30, v117
    v_lshlrev_b32 v138, 16, v135
    v_and_b32 v139, s30, v135
    v_sub_f32 v136, v136, v138
    v_sub_f32 v137, v137, v139
    v_cvt_pk_bf16_f32 v144, v136, v137
    v_lshlrev_b32 v136, 16, v144
    v_and_b32 v137, s30, v144
    v_add_f32 v226, v226, v98
    v_add_f32 v227, v227, v99
    v_cvt_pk_bf16_f32 v144, v226, v227
    v_lshlrev_b32 v226, 16, v144
    v_and_b32 v227, s30, v144
    v_lshlrev_b32 v146, 16, v33
    v_and_b32 v147, s30, v33
    v_add_f32 v226, v226, v146
    v_add_f32 v227, v227, v147
    v_cvt_pk_bf16_f32 v144, v226, v227
    v_lshlrev_b32 v226, 16, v144
    v_and_b32 v227, s30, v144
    v_mul_f32 v146, s31, v226
    v_mul_f32 v147, s31, v227
    v_exp_f32 v146, v146
    v_exp_f32 v147, v147
    s_nop 0
    v_add_f32 v146, 1.0, v146
    v_add_f32 v147, 1.0, v147
    v_rcp_f32 v146, v146
    v_rcp_f32 v147, v147
    s_nop 0
    v_mul_f32 v226, v226, v146
    v_mul_f32 v227, v227, v147
    v_cvt_pk_bf16_f32 v144, v226, v227
    v_lshlrev_b32 v226, 16, v144
    v_and_b32 v227, s30, v144
    v_mul_f32 v136, v136, v226
    v_mul_f32 v137, v137, v227
    v_cvt_pk_bf16_f32 v144, v136, v137
    v_lshlrev_b32 v136, 16, v144
    v_and_b32 v137, s30, v144
    v_lshlrev_b32 v146, 16, v249
    v_and_b32 v147, s30, v249
    v_add_f32 v146, v146, v136
    v_add_f32 v147, v147, v137
    v_cvt_pk_bf16_f32 v97, v146, v147
    buffer_store_dwordx2 v[96:97], v8, s[20:23], 0 offen offset:256
    s_endpgm
KB_EPI5:
    s_add_u32 s47, s48, 0x0
    buffer_store_dwordx4 v[160:163], v7, s[16:19], s47 offen offset:0 sc1
    s_add_u32 s47, s48, 0x0
    buffer_store_dwordx4 v[168:171], v7, s[16:19], s47 offen offset:2048 sc1
    s_add_u32 s47, s48, 0x1000
    buffer_store_dwordx4 v[176:179], v7, s[16:19], s47 offen offset:0 sc1
    s_add_u32 s47, s48, 0x1000
    buffer_store_dwordx4 v[184:187], v7, s[16:19], s47 offen offset:2048 sc1
    s_add_u32 s47, s48, 0x2000
    buffer_store_dwordx4 v[192:195], v7, s[16:19], s47 offen offset:0 sc1
    s_add_u32 s47, s48, 0x2000
    buffer_store_dwordx4 v[200:203], v7, s[16:19], s47 offen offset:2048 sc1
    s_add_u32 s47, s48, 0x3000
    buffer_store_dwordx4 v[208:211], v7, s[16:19], s47 offen offset:0 sc1
    s_add_u32 s47, s48, 0x3000
    buffer_store_dwordx4 v[216:219], v7, s[16:19], s47 offen offset:2048 sc1
    s_add_u32 s47, s48, 0x4000
    buffer_store_dwordx4 v[224:227], v7, s[16:19], s47 offen offset:0 sc1
    s_cmp_lg_u32 s34, 0
    s_cbranch_scc1 KB_W013
    s_mov_b64 exec, 1
KB_POLLA3:
    buffer_load_dwordx4 v[16:19], v11, s[40:43], 0 offen sc1
    s_waitcnt vmcnt(0)
    v_add_u32 v16, v16, v17
    s_nop 0
    v_readfirstlane_b32 s45, v16
    s_nop 3
    s_cmp_ge_u32 s45, 2
    s_cbranch_scc1 KB_POLLEDA3
    s_sleep 2
    s_branch KB_POLLA3
KB_POLLEDA3:
    s_mov_b64 exec, -1
KB_W013:
    s_barrier
    s_add_u32 s47, s46, 0x0
    buffer_load_dwordx2 v[100:101], v14, s[16:19], s47 offen offset:1024 sc1
    s_add_u32 s47, s46, 0x0
    buffer_load_dwordx2 v[102:103], v14, s[16:19], s47 offen offset:3072 sc1
    s_add_u32 s47, s46, 0x1000
    buffer_load_dwordx2 v[104:105], v14, s[16:19], s47 offen offset:1024 sc1
    s_add_u32 s47, s46, 0x1000
    buffer_load_dwordx2 v[106:107], v14, s[16:19], s47 offen offset:3072 sc1
    s_add_u32 s47, s46, 0x2000
    buffer_load_dwordx2 v[108:109], v14, s[16:19], s47 offen offset:1024 sc1
    s_add_u32 s47, s46, 0x2000
    buffer_load_dwordx2 v[110:111], v14, s[16:19], s47 offen offset:3072 sc1
    s_add_u32 s47, s46, 0x3000
    buffer_load_dwordx2 v[112:113], v14, s[16:19], s47 offen offset:1024 sc1
    s_add_u32 s47, s46, 0x3000
    buffer_load_dwordx2 v[114:115], v14, s[16:19], s47 offen offset:3072 sc1
    s_add_u32 s47, s46, 0x4000
    buffer_load_dwordx2 v[116:117], v14, s[16:19], s47 offen offset:1024 sc1
    s_add_u32 s47, s46, 0x12000
    buffer_load_dwordx2 v[118:119], v14, s[16:19], s47 offen offset:1024 sc1
    s_add_u32 s47, s46, 0x12000
    buffer_load_dwordx2 v[120:121], v14, s[16:19], s47 offen offset:3072 sc1
    s_add_u32 s47, s46, 0x13000
    buffer_load_dwordx2 v[122:123], v14, s[16:19], s47 offen offset:1024 sc1
    s_add_u32 s47, s46, 0x13000
    buffer_load_dwordx2 v[124:125], v14, s[16:19], s47 offen offset:3072 sc1
    s_add_u32 s47, s46, 0x14000
    buffer_load_dwordx2 v[126:127], v14, s[16:19], s47 offen offset:1024 sc1
    s_add_u32 s47, s46, 0x14000
    buffer_load_dwordx2 v[128:129], v14, s[16:19], s47 offen offset:3072 sc1
    s_add_u32 s47, s46, 0x15000
    buffer_load_dwordx2 v[130:131], v14, s[16:19], s47 offen offset:1024 sc1
    s_add_u32 s47, s46, 0x15000
    buffer_load_dwordx2 v[132:133], v14, s[16:19], s47 offen offset:3072 sc1
    s_add_u32 s47, s46, 0x16000
    buffer_load_dwordx2 v[134:135], v14, s[16:19], s47 offen offset:1024 sc1
    s_waitcnt vmcnt(18)
    s_barrier
    s_cmp_lg_u32 s34, 0
    s_cbranch_scc1 KB_WP3
    s_mov_b64 exec, 1
    buffer_store_dword v12, v11, s[40:43], s49 offen sc1
KB_POLLB3:
    buffer_load_dwordx4 v[16:19], v11, s[40:43], 0 offen sc1
    s_waitcnt vmcnt(0)
    v_mov_b32 v16, v18
    s_nop 0
    v_readfirstlane_b32 s45, v16
    s_nop 3
    s_cmp_ge_u32 s45, 1
    s_cbranch_scc1 KB_POLLEDB3
    s_sleep 2
    s_branch KB_POLLB3
KB_POLLEDB3:
    s_mov_b64 exec, -1
KB_WP3:
    s_barrier
    s_add_u32 s47, s46, 0x24000
    buffer_load_dwordx4 v[64:67], v7, s[16:19], s47 offen offset:1024 sc1
    s_add_u32 s47, s46, 0x24000
    buffer_load_dwordx4 v[68:71], v7, s[16:19], s47 offen offset:3072 sc1
    s_add_u32 s47, s46, 0x25000
    buffer_load_dwordx4 v[72:75], v7, s[16:19], s47 offen offset:1024 sc1
    s_add_u32 s47, s46, 0x25000
    buffer_load_dwordx4 v[76:79], v7, s[16:19], s47 offen offset:3072 sc1
    s_add_u32 s47, s46, 0x26000
    buffer_load_dwordx4 v[80:83], v7, s[16:19], s47 offen offset:1024 sc1
    s_add_u32 s47, s46, 0x26000
    buffer_load_dwordx4 v[84:87], v7, s[16:19], s47 offen offset:3072 sc1
    s_add_u32 s47, s46, 0x27000
    buffer_load_dwordx4 v[88:91], v7, s[16:19], s47 offen offset:1024 sc1
    s_add_u32 s47, s46, 0x27000
    buffer_load_dwordx4 v[92:95], v7, s[16:19], s47 offen offset:3072 sc1
    s_add_u32 s47, s46, 0x28000
    buffer_load_dwordx4 v[96:99], v7, s[16:19], s47 offen offset:1024 sc1
    s_waitcnt vmcnt(8)
    v_lshlrev_b32 v136, 16, v100
    v_and_b32 v137, s30, v100
    v_lshlrev_b32 v138, 16, v118
    v_and_b32 v139, s30, v118
    v_sub_f32 v136, v136, v138
    v_sub_f32 v137, v137, v139
    v_cvt_pk_bf16_f32 v144, v136, v137
    v_lshlrev_b32 v136, 16, v144
    v_and_b32 v137, s30, v144
    v_add_f32 v164, v164, v64
    v_add_f32 v165, v165, v65
    v_cvt_pk_bf16_f32 v144, v164, v165
    v_lshlrev_b32 v164, 16, v144
    v_and_b32 v165, s30, v144
    v_lshlrev_b32 v146, 16, v250
    v_and_b32 v147, s30, v250
    v_add_f32 v164, v164, v146
    v_add_f32 v165, v165, v147
    v_cvt_pk_bf16_f32 v144, v164, v165
    v_lshlrev_b32 v164, 16, v144
    v_and_b32 v165, s30, v144
    v_mul_f32 v146, s31, v164
    v_mul_f32 v147, s31, v165
    v_exp_f32 v146, v146
    v_exp_f32 v147, v147
    s_nop 0
    v_add_f32 v146, 1.0, v146
    v_add_f32 v147, 1.0, v147
    v_rcp_f32 v146, v146
    v_rcp_f32 v147, v147
    s_nop 0
    v_mul_f32 v164, v164, v146
    v_mul_f32 v165, v165, v147
    v_cvt_pk_bf16_f32 v144, v164, v165
    v_lshlrev_b32 v164, 16, v144
    v_and_b32 v165, s30, v144
    v_mul_f32 v136, v136, v164
    v_mul_f32 v137, v137, v165
    v_cvt_pk_bf16_f32 v144, v136, v137
    v_lshlrev_b32 v136, 16, v144
    v_and_b32 v137, s30, v144
    v_lshlrev_b32 v146, 16, v232
    v_and_b32 v147, s30, v232
    v_add_f32 v146, v146, v136
    v_add_f32 v147, v147, v137
    v_cvt_pk_bf16_f32 v64, v146, v147
    v_lshlrev_b32 v136, 16, v101
    v_and_b32 v137, s30, v101
    v_lshlrev_b32 v138, 16, v119
    v_and_b32 v139, s30, v119
    v_sub_f32 v136, v136, v138
    v_sub_f32 v137, v137, v139
    v_cvt_pk_bf16_f32 v144, v136, v137
    v_lshlrev_b32 v136, 16, v144
    v_and_b32 v137, s30, v144
    v_add_f32 v166, v166, v66
    v_add_f32 v167, v167, v67
    v_cvt_pk_bf16_f32 v144, v166, v167
    v_lshlrev_b32 v166, 16, v144
    v_and_b32 v167, s30, v144
    v_lshlrev_b32 v146, 16, v251
    v_and_b32 v147, s30, v251
    v_add_f32 v166, v166, v146
    v_add_f32 v167, v167, v147
    v_cvt_pk_bf16_f32 v144, v166, v167
    v_lshlrev_b32 v166, 16, v144
    v_and_b32 v167, s30, v144
    v_mul_f32 v146, s31, v166
    v_mul_f32 v147, s31, v167
    v_exp_f32 v146, v146
    v_exp_f32 v147, v147
    s_nop 0
    v_add_f32 v146, 1.0, v146
    v_add_f32 v147, 1.0, v147
    v_rcp_f32 v146, v146
    v_rcp_f32 v147, v147
    s_nop 0
    v_mul_f32 v166, v166, v146
    v_mul_f32 v167, v167, v147
    v_cvt_pk_bf16_f32 v144, v166, v167
    v_lshlrev_b32 v166, 16, v144
    v_and_b32 v167, s30, v144
    v_mul_f32 v136, v136, v166
    v_mul_f32 v137, v137, v167
    v_cvt_pk_bf16_f32 v144, v136, v137
    v_lshlrev_b32 v136, 16, v144
    v_and_b32 v137, s30, v144
    v_lshlrev_b32 v146, 16, v233
    v_and_b32 v147, s30, v233
    v_add_f32 v146, v146, v136
    v_add_f32 v147, v147, v137
    v_cvt_pk_bf16_f32 v65, v146, v147
    buffer_store_dwordx2 v[64:65], v8, s[20:23], 0 offen offset:0
    s_waitcnt vmcnt(8)
    v_lshlrev_b32 v136, 16, v102
    v_and_b32 v137, s30, v102
    v_lshlrev_b32 v138, 16, v120
    v_and_b32 v139, s30, v120
    v_sub_f32 v136, v136, v138
    v_sub_f32 v137, v137, v139
    v_cvt_pk_bf16_f32 v144, v136, v137
    v_lshlrev_b32 v136, 16, v144
    v_and_b32 v137, s30, v144
    v_add_f32 v172, v172, v68
    v_add_f32 v173, v173, v69
    v_cvt_pk_bf16_f32 v144, v172, v173
    v_lshlrev_b32 v172, 16, v144
    v_and_b32 v173, s30, v144
    v_lshlrev_b32 v146, 16, v252
    v_and_b32 v147, s30, v252
    v_add_f32 v172, v172, v146
    v_add_f32 v173, v173, v147
    v_cvt_pk_bf16_f32 v144, v172, v173
    v_lshlrev_b32 v172, 16, v144
    v_and_b32 v173, s30, v144
    v_mul_f32 v146, s31, v172
    v_mul_f32 v147, s31, v173
    v_exp_f32 v146, v146
    v_exp_f32 v147, v147
    s_nop 0
    v_add_f32 v146, 1.0, v146
    v_add_f32 v147, 1.0, v147
    v_rcp_f32 v146, v146
    v_rcp_f32 v147, v147
    s_nop 0
    v_mul_f32 v172, v172, v146
    v_mul_f32 v173, v173, v147
    v_cvt_pk_bf16_f32 v144, v172, v173
    v_lshlrev_b32 v172, 16, v144
    v_and_b32 v173, s30, v144
    v_mul_f32 v136, v136, v172
    v_mul_f32 v137, v137, v173
    v_cvt_pk_bf16_f32 v144, v136, v137
    v_lshlrev_b32 v136, 16, v144
    v_and_b32 v137, s30, v144
    v_lshlrev_b32 v146, 16, v234
    v_and_b32 v147, s30, v234
    v_add_f32 v146, v146, v136
    v_add_f32 v147, v147, v137
    v_cvt_pk_bf16_f32 v68, v146, v147
    v_lshlrev_b32 v136, 16, v103
    v_and_b32 v137, s30, v103
    v_lshlrev_b32 v138, 16, v121
    v_and_b32 v139, s30, v121
    v_sub_f32 v136, v136, v138
    v_sub_f32 v137, v137, v139
    v_cvt_pk_bf16_f32 v144, v136, v137
    v_lshlrev_b32 v136, 16, v144
    v_and_b32 v137, s30, v144
    v_add_f32 v174, v174, v70
    v_add_f32 v175, v175, v71
    v_cvt_pk_bf16_f32 v144, v174, v175
    v_lshlrev_b32 v174, 16, v144
    v_and_b32 v175, s30, v144
    v_lshlrev_b32 v146, 16, v253
    v_and_b32 v147, s30, v253
    v_add_f32 v174, v174, v146
    v_add_f32 v175, v175, v147
    v_cvt_pk_bf16_f32 v144, v174, v175
    v_lshlrev_b32 v174, 16, v144
    v_and_b32 v175, s30, v144
    v_mul_f32 v146, s31, v174
    v_mul_f32 v147, s31, v175
    v_exp_f32 v146, v146
    v_exp_f32 v147, v147
    s_nop 0
    v_add_f32 v146, 1.0, v146
    v_add_f32 v147, 1.0, v147
    v_rcp_f32 v146, v146
    v_rcp_f32 v147, v147
    s_nop 0
    v_mul_f32 v174, v174, v146
    v_mul_f32 v175, v175, v147
    v_cvt_pk_bf16_f32 v144, v174, v175
    v_lshlrev_b32 v174, 16, v144
    v_and_b32 v175, s30, v144
    v_mul_f32 v136, v136, v174
    v_mul_f32 v137, v137, v175
    v_cvt_pk_bf16_f32 v144, v136, v137
    v_lshlrev_b32 v136, 16, v144
    v_and_b32 v137, s30, v144
    v_lshlrev_b32 v146, 16, v235
    v_and_b32 v147, s30, v235
    v_add_f32 v146, v146, v136
    v_add_f32 v147, v147, v137
    v_cvt_pk_bf16_f32 v69, v146, v147
    buffer_store_dwordx2 v[68:69], v8, s[20:23], 0 offen offset:32
    s_waitcnt vmcnt(8)
    v_lshlrev_b32 v136, 16, v104
    v_and_b32 v137, s30, v104
    v_lshlrev_b32 v138, 16, v122
    v_and_b32 v139, s30, v122
    v_sub_f32 v136, v136, v138
    v_sub_f32 v137, v137, v139
    v_cvt_pk_bf16_f32 v144, v136, v137
    v_lshlrev_b32 v136, 16, v144
    v_and_b32 v137, s30, v144
    v_add_f32 v180, v180, v72
    v_add_f32 v181, v181, v73
    v_cvt_pk_bf16_f32 v144, v180, v181
    v_lshlrev_b32 v180, 16, v144
    v_and_b32 v181, s30, v144
    v_lshlrev_b32 v146, 16, v254
    v_and_b32 v147, s30, v254
    v_add_f32 v180, v180, v146
    v_add_f32 v181, v181, v147
    v_cvt_pk_bf16_f32 v144, v180, v181
    v_lshlrev_b32 v180, 16, v144
    v_and_b32 v181, s30, v144
    v_mul_f32 v146, s31, v180
    v_mul_f32 v147, s31, v181
    v_exp_f32 v146, v146
    v_exp_f32 v147, v147
    s_nop 0
    v_add_f32 v146, 1.0, v146
    v_add_f32 v147, 1.0, v147
    v_rcp_f32 v146, v146
    v_rcp_f32 v147, v147
    s_nop 0
    v_mul_f32 v180, v180, v146
    v_mul_f32 v181, v181, v147
    v_cvt_pk_bf16_f32 v144, v180, v181
    v_lshlrev_b32 v180, 16, v144
    v_and_b32 v181, s30, v144
    v_mul_f32 v136, v136, v180
    v_mul_f32 v137, v137, v181
    v_cvt_pk_bf16_f32 v144, v136, v137
    v_lshlrev_b32 v136, 16, v144
    v_and_b32 v137, s30, v144
    v_lshlrev_b32 v146, 16, v236
    v_and_b32 v147, s30, v236
    v_add_f32 v146, v146, v136
    v_add_f32 v147, v147, v137
    v_cvt_pk_bf16_f32 v72, v146, v147
    v_lshlrev_b32 v136, 16, v105
    v_and_b32 v137, s30, v105
    v_lshlrev_b32 v138, 16, v123
    v_and_b32 v139, s30, v123
    v_sub_f32 v136, v136, v138
    v_sub_f32 v137, v137, v139
    v_cvt_pk_bf16_f32 v144, v136, v137
    v_lshlrev_b32 v136, 16, v144
    v_and_b32 v137, s30, v144
    v_add_f32 v182, v182, v74
    v_add_f32 v183, v183, v75
    v_cvt_pk_bf16_f32 v144, v182, v183
    v_lshlrev_b32 v182, 16, v144
    v_and_b32 v183, s30, v144
    v_lshlrev_b32 v146, 16, v255
    v_and_b32 v147, s30, v255
    v_add_f32 v182, v182, v146
    v_add_f32 v183, v183, v147
    v_cvt_pk_bf16_f32 v144, v182, v183
    v_lshlrev_b32 v182, 16, v144
    v_and_b32 v183, s30, v144
    v_mul_f32 v146, s31, v182
    v_mul_f32 v147, s31, v183
    v_exp_f32 v146, v146
    v_exp_f32 v147, v147
    s_nop 0
    v_add_f32 v146, 1.0, v146
    v_add_f32 v147, 1.0, v147
    v_rcp_f32 v146, v146
    v_rcp_f32 v147, v147
    s_nop 0
    v_mul_f32 v182, v182, v146
    v_mul_f32 v183, v183, v147
    v_cvt_pk_bf16_f32 v144, v182, v183
    v_lshlrev_b32 v182, 16, v144
    v_and_b32 v183, s30, v144
    v_mul_f32 v136, v136, v182
    v_mul_f32 v137, v137, v183
    v_cvt_pk_bf16_f32 v144, v136, v137
    v_lshlrev_b32 v136, 16, v144
    v_and_b32 v137, s30, v144
    v_lshlrev_b32 v146, 16, v237
    v_and_b32 v147, s30, v237
    v_add_f32 v146, v146, v136
    v_add_f32 v147, v147, v137
    v_cvt_pk_bf16_f32 v73, v146, v147
    buffer_store_dwordx2 v[72:73], v8, s[20:23], 0 offen offset:64
    s_waitcnt vmcnt(8)
    v_lshlrev_b32 v136, 16, v106
    v_and_b32 v137, s30, v106
    v_lshlrev_b32 v138, 16, v124
    v_and_b32 v139, s30, v124
    v_sub_f32 v136, v136, v138
    v_sub_f32 v137, v137, v139
    v_cvt_pk_bf16_f32 v144, v136, v137
    v_lshlrev_b32 v136, 16, v144
    v_and_b32 v137, s30, v144
    v_add_f32 v188, v188, v76
    v_add_f32 v189, v189, v77
    v_cvt_pk_bf16_f32 v144, v188, v189
    v_lshlrev_b32 v188, 16, v144
    v_and_b32 v189, s30, v144
    v_lshlrev_b32 v146, 16, v56
    v_and_b32 v147, s30, v56
    v_add_f32 v188, v188, v146
    v_add_f32 v189, v189, v147
    v_cvt_pk_bf16_f32 v144, v188, v189
    v_lshlrev_b32 v188, 16, v144
    v_and_b32 v189, s30, v144
    v_mul_f32 v146, s31, v188
    v_mul_f32 v147, s31, v189
    v_exp_f32 v146, v146
    v_exp_f32 v147, v147
    s_nop 0
    v_add_f32 v146, 1.0, v146
    v_add_f32 v147, 1.0, v147
    v_rcp_f32 v146, v146
    v_rcp_f32 v147, v147
    s_nop 0
    v_mul_f32 v188, v188, v146
    v_mul_f32 v189, v189, v147
    v_cvt_pk_bf16_f32 v144, v188, v189
    v_lshlrev_b32 v188, 16, v144
    v_and_b32 v189, s30, v144
    v_mul_f32 v136, v136, v188
    v_mul_f32 v137, v137, v189
    v_cvt_pk_bf16_f32 v144, v136, v137
    v_lshlrev_b32 v136, 16, v144
    v_and_b32 v137, s30, v144
    v_lshlrev_b32 v146, 16, v238
    v_and_b32 v147, s30, v238
    v_add_f32 v146, v146, v136
    v_add_f32 v147, v147, v137
    v_cvt_pk_bf16_f32 v76, v146, v147
    v_lshlrev_b32 v136, 16, v107
    v_and_b32 v137, s30, v107
    v_lshlrev_b32 v138, 16, v125
    v_and_b32 v139, s30, v125
    v_sub_f32 v136, v136, v138
    v_sub_f32 v137, v137, v139
    v_cvt_pk_bf16_f32 v144, v136, v137
    v_lshlrev_b32 v136, 16, v144
    v_and_b32 v137, s30, v144
    v_add_f32 v190, v190, v78
    v_add_f32 v191, v191, v79
    v_cvt_pk_bf16_f32 v144, v190, v191
    v_lshlrev_b32 v190, 16, v144
    v_and_b32 v191, s30, v144
    v_lshlrev_b32 v146, 16, v57
    v_and_b32 v147, s30, v57
    v_add_f32 v190, v190, v146
    v_add_f32 v191, v191, v147
    v_cvt_pk_bf16_f32 v144, v190, v191
    v_lshlrev_b32 v190, 16, v144
    v_and_b32 v191, s30, v144
    v_mul_f32 v146, s31, v190
    v_mul_f32 v147, s31, v191
    v_exp_f32 v146, v146
    v_exp_f32 v147, v147
    s_nop 0
    v_add_f32 v146, 1.0, v146
    v_add_f32 v147, 1.0, v147
    v_rcp_f32 v146, v146
    v_rcp_f32 v147, v147
    s_nop 0
    v_mul_f32 v190, v190, v146
    v_mul_f32 v191, v191, v147
    v_cvt_pk_bf16_f32 v144, v190, v191
    v_lshlrev_b32 v190, 16, v144
    v_and_b32 v191, s30, v144
    v_mul_f32 v136, v136, v190
    v_mul_f32 v137, v137, v191
    v_cvt_pk_bf16_f32 v144, v136, v137
    v_lshlrev_b32 v136, 16, v144
    v_and_b32 v137, s30, v144
    v_lshlrev_b32 v146, 16, v239
    v_and_b32 v147, s30, v239
    v_add_f32 v146, v146, v136
    v_add_f32 v147, v147, v137
    v_cvt_pk_bf16_f32 v77, v146, v147
    buffer_store_dwordx2 v[76:77], v8, s[20:23], 0 offen offset:96
    s_waitcnt vmcnt(8)
    v_lshlrev_b32 v136, 16, v108
    v_and_b32 v137, s30, v108
    v_lshlrev_b32 v138, 16, v126
    v_and_b32 v139, s30, v126
    v_sub_f32 v136, v136, v138
    v_sub_f32 v137, v137, v139
    v_cvt_pk_bf16_f32 v144, v136, v137
    v_lshlrev_b32 v136, 16, v144
    v_and_b32 v137, s30, v144
    v_add_f32 v196, v196, v80
    v_add_f32 v197, v197, v81
    v_cvt_pk_bf16_f32 v144, v196, v197
    v_lshlrev_b32 v196, 16, v144
    v_and_b32 v197, s30, v144
    v_lshlrev_b32 v146, 16, v58
    v_and_b32 v147, s30, v58
    v_add_f32 v196, v196, v146
    v_add_f32 v197, v197, v147
    v_cvt_pk_bf16_f32 v144, v196, v197
    v_lshlrev_b32 v196, 16, v144
    v_and_b32 v197, s30, v144
    v_mul_f32 v146, s31, v196
    v_mul_f32 v147, s31, v197
    v_exp_f32 v146, v146
    v_exp_f32 v147, v147
    s_nop 0
    v_add_f32 v146, 1.0, v146
    v_add_f32 v147, 1.0, v147
    v_rcp_f32 v146, v146
    v_rcp_f32 v147, v147
    s_nop 0
    v_mul_f32 v196, v196, v146
    v_mul_f32 v197, v197, v147
    v_cvt_pk_bf16_f32 v144, v196, v197
    v_lshlrev_b32 v196, 16, v144
    v_and_b32 v197, s30, v144
    v_mul_f32 v136, v136, v196
    v_mul_f32 v137, v137, v197
    v_cvt_pk_bf16_f32 v144, v136, v137
    v_lshlrev_b32 v136, 16, v144
    v_and_b32 v137, s30, v144
    v_lshlrev_b32 v146, 16, v240
    v_and_b32 v147, s30, v240
    v_add_f32 v146, v146, v136
    v_add_f32 v147, v147, v137
    v_cvt_pk_bf16_f32 v80, v146, v147
    v_lshlrev_b32 v136, 16, v109
    v_and_b32 v137, s30, v109
    v_lshlrev_b32 v138, 16, v127
    v_and_b32 v139, s30, v127
    v_sub_f32 v136, v136, v138
    v_sub_f32 v137, v137, v139
    v_cvt_pk_bf16_f32 v144, v136, v137
    v_lshlrev_b32 v136, 16, v144
    v_and_b32 v137, s30, v144
    v_add_f32 v198, v198, v82
    v_add_f32 v199, v199, v83
    v_cvt_pk_bf16_f32 v144, v198, v199
    v_lshlrev_b32 v198, 16, v144
    v_and_b32 v199, s30, v144
    v_lshlrev_b32 v146, 16, v59
    v_and_b32 v147, s30, v59
    v_add_f32 v198, v198, v146
    v_add_f32 v199, v199, v147
    v_cvt_pk_bf16_f32 v144, v198, v199
    v_lshlrev_b32 v198, 16, v144
    v_and_b32 v199, s30, v144
    v_mul_f32 v146, s31, v198
    v_mul_f32 v147, s31, v199
    v_exp_f32 v146, v146
    v_exp_f32 v147, v147
    s_nop 0
    v_add_f32 v146, 1.0, v146
    v_add_f32 v147, 1.0, v147
    v_rcp_f32 v146, v146
    v_rcp_f32 v147, v147
    s_nop 0
    v_mul_f32 v198, v198, v146
    v_mul_f32 v199, v199, v147
    v_cvt_pk_bf16_f32 v144, v198, v199
    v_lshlrev_b32 v198, 16, v144
    v_and_b32 v199, s30, v144
    v_mul_f32 v136, v136, v198
    v_mul_f32 v137, v137, v199
    v_cvt_pk_bf16_f32 v144, v136, v137
    v_lshlrev_b32 v136, 16, v144
    v_and_b32 v137, s30, v144
    v_lshlrev_b32 v146, 16, v241
    v_and_b32 v147, s30, v241
    v_add_f32 v146, v146, v136
    v_add_f32 v147, v147, v137
    v_cvt_pk_bf16_f32 v81, v146, v147
    buffer_store_dwordx2 v[80:81], v8, s[20:23], 0 offen offset:128
    s_waitcnt vmcnt(8)
    v_lshlrev_b32 v136, 16, v110
    v_and_b32 v137, s30, v110
    v_lshlrev_b32 v138, 16, v128
    v_and_b32 v139, s30, v128
    v_sub_f32 v136, v136, v138
    v_sub_f32 v137, v137, v139
    v_cvt_pk_bf16_f32 v144, v136, v137
    v_lshlrev_b32 v136, 16, v144
    v_and_b32 v137, s30, v144
    v_add_f32 v204, v204, v84
    v_add_f32 v205, v205, v85
    v_cvt_pk_bf16_f32 v144, v204, v205
    v_lshlrev_b32 v204, 16, v144
    v_and_b32 v205, s30, v144
    v_lshlrev_b32 v146, 16, v60
    v_and_b32 v147, s30, v60
    v_add_f32 v204, v204, v146
    v_add_f32 v205, v205, v147
    v_cvt_pk_bf16_f32 v144, v204, v205
    v_lshlrev_b32 v204, 16, v144
    v_and_b32 v205, s30, v144
    v_mul_f32 v146, s31, v204
    v_mul_f32 v147, s31, v205
    v_exp_f32 v146, v146
    v_exp_f32 v147, v147
    s_nop 0
    v_add_f32 v146, 1.0, v146
    v_add_f32 v147, 1.0, v147
    v_rcp_f32 v146, v146
    v_rcp_f32 v147, v147
    s_nop 0
    v_mul_f32 v204, v204, v146
    v_mul_f32 v205, v205, v147
    v_cvt_pk_bf16_f32 v144, v204, v205
    v_lshlrev_b32 v204, 16, v144
    v_and_b32 v205, s30, v144
    v_mul_f32 v136, v136, v204
    v_mul_f32 v137, v137, v205
    v_cvt_pk_bf16_f32 v144, v136, v137
    v_lshlrev_b32 v136, 16, v144
    v_and_b32 v137, s30, v144
    v_lshlrev_b32 v146, 16, v242
    v_and_b32 v147, s30, v242
    v_add_f32 v146, v146, v136
    v_add_f32 v147, v147, v137
    v_cvt_pk_bf16_f32 v84, v146, v147
    v_lshlrev_b32 v136, 16, v111
    v_and_b32 v137, s30, v111
    v_lshlrev_b32 v138, 16, v129
    v_and_b32 v139, s30, v129
    v_sub_f32 v136, v136, v138
    v_sub_f32 v137, v137, v139
    v_cvt_pk_bf16_f32 v144, v136, v137
    v_lshlrev_b32 v136, 16, v144
    v_and_b32 v137, s30, v144
    v_add_f32 v206, v206, v86
    v_add_f32 v207, v207, v87
    v_cvt_pk_bf16_f32 v144, v206, v207
    v_lshlrev_b32 v206, 16, v144
    v_and_b32 v207, s30, v144
    v_lshlrev_b32 v146, 16, v61
    v_and_b32 v147, s30, v61
    v_add_f32 v206, v206, v146
    v_add_f32 v207, v207, v147
    v_cvt_pk_bf16_f32 v144, v206, v207
    v_lshlrev_b32 v206, 16, v144
    v_and_b32 v207, s30, v144
    v_mul_f32 v146, s31, v206
    v_mul_f32 v147, s31, v207
    v_exp_f32 v146, v146
    v_exp_f32 v147, v147
    s_nop 0
    v_add_f32 v146, 1.0, v146
    v_add_f32 v147, 1.0, v147
    v_rcp_f32 v146, v146
    v_rcp_f32 v147, v147
    s_nop 0
    v_mul_f32 v206, v206, v146
    v_mul_f32 v207, v207, v147
    v_cvt_pk_bf16_f32 v144, v206, v207
    v_lshlrev_b32 v206, 16, v144
    v_and_b32 v207, s30, v144
    v_mul_f32 v136, v136, v206
    v_mul_f32 v137, v137, v207
    v_cvt_pk_bf16_f32 v144, v136, v137
    v_lshlrev_b32 v136, 16, v144
    v_and_b32 v137, s30, v144
    v_lshlrev_b32 v146, 16, v243
    v_and_b32 v147, s30, v243
    v_add_f32 v146, v146, v136
    v_add_f32 v147, v147, v137
    v_cvt_pk_bf16_f32 v85, v146, v147
    buffer_store_dwordx2 v[84:85], v8, s[20:23], 0 offen offset:160
    s_waitcnt vmcnt(8)
    v_lshlrev_b32 v136, 16, v112
    v_and_b32 v137, s30, v112
    v_lshlrev_b32 v138, 16, v130
    v_and_b32 v139, s30, v130
    v_sub_f32 v136, v136, v138
    v_sub_f32 v137, v137, v139
    v_cvt_pk_bf16_f32 v144, v136, v137
    v_lshlrev_b32 v136, 16, v144
    v_and_b32 v137, s30, v144
    v_add_f32 v212, v212, v88
    v_add_f32 v213, v213, v89
    v_cvt_pk_bf16_f32 v144, v212, v213
    v_lshlrev_b32 v212, 16, v144
    v_and_b32 v213, s30, v144
    v_lshlrev_b32 v146, 16, v62
    v_and_b32 v147, s30, v62
    v_add_f32 v212, v212, v146
    v_add_f32 v213, v213, v147
    v_cvt_pk_bf16_f32 v144, v212, v213
    v_lshlrev_b32 v212, 16, v144
    v_and_b32 v213, s30, v144
    v_mul_f32 v146, s31, v212
    v_mul_f32 v147, s31, v213
    v_exp_f32 v146, v146
    v_exp_f32 v147, v147
    s_nop 0
    v_add_f32 v146, 1.0, v146
    v_add_f32 v147, 1.0, v147
    v_rcp_f32 v146, v146
    v_rcp_f32 v147, v147
    s_nop 0
    v_mul_f32 v212, v212, v146
    v_mul_f32 v213, v213, v147
    v_cvt_pk_bf16_f32 v144, v212, v213
    v_lshlrev_b32 v212, 16, v144
    v_and_b32 v213, s30, v144
    v_mul_f32 v136, v136, v212
    v_mul_f32 v137, v137, v213
    v_cvt_pk_bf16_f32 v144, v136, v137
    v_lshlrev_b32 v136, 16, v144
    v_and_b32 v137, s30, v144
    v_lshlrev_b32 v146, 16, v244
    v_and_b32 v147, s30, v244
    v_add_f32 v146, v146, v136
    v_add_f32 v147, v147, v137
    v_cvt_pk_bf16_f32 v88, v146, v147
    v_lshlrev_b32 v136, 16, v113
    v_and_b32 v137, s30, v113
    v_lshlrev_b32 v138, 16, v131
    v_and_b32 v139, s30, v131
    v_sub_f32 v136, v136, v138
    v_sub_f32 v137, v137, v139
    v_cvt_pk_bf16_f32 v144, v136, v137
    v_lshlrev_b32 v136, 16, v144
    v_and_b32 v137, s30, v144
    v_add_f32 v214, v214, v90
    v_add_f32 v215, v215, v91
    v_cvt_pk_bf16_f32 v144, v214, v215
    v_lshlrev_b32 v214, 16, v144
    v_and_b32 v215, s30, v144
    v_lshlrev_b32 v146, 16, v63
    v_and_b32 v147, s30, v63
    v_add_f32 v214, v214, v146
    v_add_f32 v215, v215, v147
    v_cvt_pk_bf16_f32 v144, v214, v215
    v_lshlrev_b32 v214, 16, v144
    v_and_b32 v215, s30, v144
    v_mul_f32 v146, s31, v214
    v_mul_f32 v147, s31, v215
    v_exp_f32 v146, v146
    v_exp_f32 v147, v147
    s_nop 0
    v_add_f32 v146, 1.0, v146
    v_add_f32 v147, 1.0, v147
    v_rcp_f32 v146, v146
    v_rcp_f32 v147, v147
    s_nop 0
    v_mul_f32 v214, v214, v146
    v_mul_f32 v215, v215, v147
    v_cvt_pk_bf16_f32 v144, v214, v215
    v_lshlrev_b32 v214, 16, v144
    v_and_b32 v215, s30, v144
    v_mul_f32 v136, v136, v214
    v_mul_f32 v137, v137, v215
    v_cvt_pk_bf16_f32 v144, v136, v137
    v_lshlrev_b32 v136, 16, v144
    v_and_b32 v137, s30, v144
    v_lshlrev_b32 v146, 16, v245
    v_and_b32 v147, s30, v245
    v_add_f32 v146, v146, v136
    v_add_f32 v147, v147, v137
    v_cvt_pk_bf16_f32 v89, v146, v147
    buffer_store_dwordx2 v[88:89], v8, s[20:23], 0 offen offset:192
    s_waitcnt vmcnt(8)
    v_lshlrev_b32 v136, 16, v114
    v_and_b32 v137, s30, v114
    v_lshlrev_b32 v138, 16, v132
    v_and_b32 v139, s30, v132
    v_sub_f32 v136, v136, v138
    v_sub_f32 v137, v137, v139
    v_cvt_pk_bf16_f32 v144, v136, v137
    v_lshlrev_b32 v136, 16, v144
    v_and_b32 v137, s30, v144
    v_add_f32 v220, v220, v92
    v_add_f32 v221, v221, v93
    v_cvt_pk_bf16_f32 v144, v220, v221
    v_lshlrev_b32 v220, 16, v144
    v_and_b32 v221, s30, v144
    v_lshlrev_b32 v146, 16, v30
    v_and_b32 v147, s30, v30
    v_add_f32 v220, v220, v146
    v_add_f32 v221, v221, v147
    v_cvt_pk_bf16_f32 v144, v220, v221
    v_lshlrev_b32 v220, 16, v144
    v_and_b32 v221, s30, v144
    v_mul_f32 v146, s31, v220
    v_mul_f32 v147, s31, v221
    v_exp_f32 v146, v146
    v_exp_f32 v147, v147
    s_nop 0
    v_add_f32 v146, 1.0, v146
    v_add_f32 v147, 1.0, v147
    v_rcp_f32 v146, v146
    v_rcp_f32 v147, v147
    s_nop 0
    v_mul_f32 v220, v220, v146
    v_mul_f32 v221, v221, v147
    v_cvt_pk_bf16_f32 v144, v220, v221
    v_lshlrev_b32 v220, 16, v144
    v_and_b32 v221, s30, v144
    v_mul_f32 v136, v136, v220
    v_mul_f32 v137, v137, v221
    v_cvt_pk_bf16_f32 v144, v136, v137
    v_lshlrev_b32 v136, 16, v144
    v_and_b32 v137, s30, v144
    v_lshlrev_b32 v146, 16, v246
    v_and_b32 v147, s30, v246
    v_add_f32 v146, v146, v136
    v_add_f32 v147, v147, v137
    v_cvt_pk_bf16_f32 v92, v146, v147
    v_lshlrev_b32 v136, 16, v115
    v_and_b32 v137, s30, v115
    v_lshlrev_b32 v138, 16, v133
    v_and_b32 v139, s30, v133
    v_sub_f32 v136, v136, v138
    v_sub_f32 v137, v137, v139
    v_cvt_pk_bf16_f32 v144, v136, v137
    v_lshlrev_b32 v136, 16, v144
    v_and_b32 v137, s30, v144
    v_add_f32 v222, v222, v94
    v_add_f32 v223, v223, v95
    v_cvt_pk_bf16_f32 v144, v222, v223
    v_lshlrev_b32 v222, 16, v144
    v_and_b32 v223, s30, v144
    v_lshlrev_b32 v146, 16, v31
    v_and_b32 v147, s30, v31
    v_add_f32 v222, v222, v146
    v_add_f32 v223, v223, v147
    v_cvt_pk_bf16_f32 v144, v222, v223
    v_lshlrev_b32 v222, 16, v144
    v_and_b32 v223, s30, v144
    v_mul_f32 v146, s31, v222
    v_mul_f32 v147, s31, v223
    v_exp_f32 v146, v146
    v_exp_f32 v147, v147
    s_nop 0
    v_add_f32 v146, 1.0, v146
    v_add_f32 v147, 1.0, v147
    v_rcp_f32 v146, v146
    v_rcp_f32 v147, v147
    s_nop 0
    v_mul_f32 v222, v222, v146
    v_mul_f32 v223, v223, v147
    v_cvt_pk_bf16_f32 v144, v222, v223
    v_lshlrev_b32 v222, 16, v144
    v_and_b32 v223, s30, v144
    v_mul_f32 v136, v136, v222
    v_mul_f32 v137, v137, v223
    v_cvt_pk_bf16_f32 v144, v136, v137
    v_lshlrev_b32 v136, 16, v144
    v_and_b32 v137, s30, v144
    v_lshlrev_b32 v146, 16, v247
    v_and_b32 v147, s30, v247
    v_add_f32 v146, v146, v136
    v_add_f32 v147, v147, v137
    v_cvt_pk_bf16_f32 v93, v146, v147
    buffer_store_dwordx2 v[92:93], v8, s[20:23], 0 offen offset:224
    s_waitcnt vmcnt(8)
    v_lshlrev_b32 v136, 16, v116
    v_and_b32 v137, s30, v116
    v_lshlrev_b32 v138, 16, v134
    v_and_b32 v139, s30, v134
    v_sub_f32 v136, v136, v138
    v_sub_f32 v137, v137, v139
    v_cvt_pk_bf16_f32 v144, v136, v137
    v_lshlrev_b32 v136, 16, v144
    v_and_b32 v137, s30, v144
    v_add_f32 v228, v228, v96
    v_add_f32 v229, v229, v97
    v_cvt_pk_bf16_f32 v144, v228, v229
    v_lshlrev_b32 v228, 16, v144
    v_and_b32 v229, s30, v144
    v_lshlrev_b32 v146, 16, v32
    v_and_b32 v147, s30, v32
    v_add_f32 v228, v228, v146
    v_add_f32 v229, v229, v147
    v_cvt_pk_bf16_f32 v144, v228, v229
    v_lshlrev_b32 v228, 16, v144
    v_and_b32 v229, s30, v144
    v_mul_f32 v146, s31, v228
    v_mul_f32 v147, s31, v229
    v_exp_f32 v146, v146
    v_exp_f32 v147, v147
    s_nop 0
    v_add_f32 v146, 1.0, v146
    v_add_f32 v147, 1.0, v147
    v_rcp_f32 v146, v146
    v_rcp_f32 v147, v147
    s_nop 0
    v_mul_f32 v228, v228, v146
    v_mul_f32 v229, v229, v147
    v_cvt_pk_bf16_f32 v144, v228, v229
    v_lshlrev_b32 v228, 16, v144
    v_and_b32 v229, s30, v144
    v_mul_f32 v136, v136, v228
    v_mul_f32 v137, v137, v229
    v_cvt_pk_bf16_f32 v144, v136, v137
    v_lshlrev_b32 v136, 16, v144
    v_and_b32 v137, s30, v144
    v_lshlrev_b32 v146, 16, v248
    v_and_b32 v147, s30, v248
    v_add_f32 v146, v146, v136
    v_add_f32 v147, v147, v137
    v_cvt_pk_bf16_f32 v96, v146, v147
    v_lshlrev_b32 v136, 16, v117
    v_and_b32 v137, s30, v117
    v_lshlrev_b32 v138, 16, v135
    v_and_b32 v139, s30, v135
    v_sub_f32 v136, v136, v138
    v_sub_f32 v137, v137, v139
    v_cvt_pk_bf16_f32 v144, v136, v137
    v_lshlrev_b32 v136, 16, v144
    v_and_b32 v137, s30, v144
    v_add_f32 v230, v230, v98
    v_add_f32 v231, v231, v99
    v_cvt_pk_bf16_f32 v144, v230, v231
    v_lshlrev_b32 v230, 16, v144
    v_and_b32 v231, s30, v144
    v_lshlrev_b32 v146, 16, v33
    v_and_b32 v147, s30, v33
    v_add_f32 v230, v230, v146
    v_add_f32 v231, v231, v147
    v_cvt_pk_bf16_f32 v144, v230, v231
    v_lshlrev_b32 v230, 16, v144
    v_and_b32 v231, s30, v144
    v_mul_f32 v146, s31, v230
    v_mul_f32 v147, s31, v231
    v_exp_f32 v146, v146
    v_exp_f32 v147, v147
    s_nop 0
    v_add_f32 v146, 1.0, v146
    v_add_f32 v147, 1.0, v147
    v_rcp_f32 v146, v146
    v_rcp_f32 v147, v147
    s_nop 0
    v_mul_f32 v230, v230, v146
    v_mul_f32 v231, v231, v147
    v_cvt_pk_bf16_f32 v144, v230, v231
    v_lshlrev_b32 v230, 16, v144
    v_and_b32 v231, s30, v144
    v_mul_f32 v136, v136, v230
    v_mul_f32 v137, v137, v231
    v_cvt_pk_bf16_f32 v144, v136, v137
    v_lshlrev_b32 v136, 16, v144
    v_and_b32 v137, s30, v144
    v_lshlrev_b32 v146, 16, v249
    v_and_b32 v147, s30, v249
    v_add_f32 v146, v146, v136
    v_add_f32 v147, v147, v137
    v_cvt_pk_bf16_f32 v97, v146, v147
    buffer_store_dwordx2 v[96:97], v8, s[20:23], 0 offen offset:256
    s_endpgm
KB_END:
    s_endpgm
.section .rodata,"a"
.p2align 6
.amdhsa_kernel ka_kernel
  .amdhsa_next_free_vgpr 256
  .amdhsa_next_free_sgpr 102
  .amdhsa_accum_offset 256
  .amdhsa_group_segment_fixed_size 0
  .amdhsa_kernarg_size 104
  .amdhsa_user_sgpr_count 2
  .amdhsa_user_sgpr_kernarg_segment_ptr 1
  .amdhsa_system_sgpr_workgroup_id_x 1
.end_amdhsa_kernel
.p2align 6
.amdhsa_kernel kb_kernel
  .amdhsa_next_free_vgpr 256
  .amdhsa_next_free_sgpr 102
  .amdhsa_accum_offset 256
  .amdhsa_group_segment_fixed_size 0
  .amdhsa_kernarg_size 104
  .amdhsa_user_sgpr_count 2
  .amdhsa_user_sgpr_kernarg_segment_ptr 1
  .amdhsa_system_sgpr_workgroup_id_x 1
.end_amdhsa_kernel
```
